```python
import torch

def _softmax(x, axis=-1):
    return torch.softmax(x, dim=axis)
def _gelu(x):
    return torch.nn.functional.gelu(x, approximate="tanh")
def _silu(x):
    return torch.nn.functional.silu(x)
def _sigmoid(x):
    return torch.sigmoid(x)
def _layernorm(x, axis=-1, eps=1e-5):
    m = x.mean(dim=axis, keepdim=True)
    v = x.var(dim=axis, keepdim=True, unbiased=False)
    return (x - m) / torch.sqrt(v + eps)
def _scatter_add(tgt, idx, src, axis=0):
    return tgt.clone().index_add_(axis, idx, src)
def _segment_sum(src, seg, n):
    out = torch.zeros((n,) + src.shape[1:], dtype=src.dtype)
    return out.index_add_(0, seg, src)
def _pad(x, pw):
    flat = tuple(v for pair in reversed(pw) for v in pair)
    return torch.nn.functional.pad(x, flat)

kernel_name = 'gated_mix__spectral_gfnet__swiglu_ffn__prompt'

def setup_inputs():

    _w = (lambda a: (lambda t: t.to(torch.bfloat16) if t.is_floating_point() else t)(torch.as_tensor(a)))
    def _A_setup():
        B, S, D = 1, 2048, 640
        Df = D // 2 + 1
        return {
            "x": _w((lambda *s: torch.randn(*s, dtype=torch.bfloat16) * 0.05)(B, S, D)),
            "w_r": _w((lambda *s: torch.randn(*s, dtype=torch.bfloat16) * 0.8)(S, Df) * 0.02),
            "w_i": _w((lambda *s: torch.randn(*s, dtype=torch.bfloat16) * 0.8)(S, Df) * 0.02),
        }
    _A_in = _A_setup()

    def _B_setup():
        B, S, D, F = 1, 2048, 640, 1536
        return {
            "x": _w((lambda *s: torch.randn(*s, dtype=torch.bfloat16) * 0.05)(B, S, D)),
            "w_gate": _w((lambda *s: torch.randn(*s, dtype=torch.bfloat16) * 0.05)(D, F)),
            "w_up": _w((lambda *s: torch.randn(*s, dtype=torch.bfloat16) * 0.05)(D, F)),
            "w_down": _w((lambda *s: torch.randn(*s, dtype=torch.bfloat16) * 0.05)(F, D)),
        }
    _B_in = _B_setup()

    return {
        "A_x": _A_in["x"],
        "A_w_r": _A_in["w_r"],
        "A_w_i": _A_in["w_i"],
        "B_x": _B_in["x"],
        "B_w_gate": _B_in["w_gate"],
        "B_w_up": _B_in["w_up"],
        "B_w_down": _B_in["w_down"],
        "gate_w": _w((lambda *s: torch.randn(*s, dtype=torch.bfloat16) * 0.05)(640) * 16.0),
    }

def reference(A_x, A_w_r, A_w_i, B_x, B_w_gate, B_w_up, B_w_down, gate_w):
    def _A_ref(x, w_r, w_i):
        B, S, D = x.shape
        X = (lambda x, axes=(-2,-1): torch.fft.rfft2(x.float(), dim=axes))(x, axes=(-2, -1))
        W = w_r + 1j * w_i
        X = X * W
        y = (lambda x, s, axes=(-2,-1): torch.fft.irfft2(x, s=s, dim=axes).to(torch.bfloat16))(X, (S, D), axes=(-2, -1))
        return y

    def _B_ref(x, w_gate, w_up, w_down):
        g = _silu(x @ w_gate)
        u = x @ w_up
        return (g * u) @ w_down

    x = A_x
    g = _sigmoid((x * gate_w).sum(-1, keepdims=True))
    a = _A_ref(x, A_w_r, A_w_i)
    b = _B_ref(x, B_w_gate, B_w_up, B_w_down)
    return g * a + (1 - g) * b
```

```asm
; @launch grid=(256,1,1) block=(512,1,1) lds=163840
.amdgcn_target "amdgcn-amd-amdhsa--gfx950"
.text
.globl gated_mix__spectral_gfnet__swiglu_ffn__prompt_kernel
.p2align 8
.type gated_mix__spectral_gfnet__swiglu_ffn__prompt_kernel,@function
gated_mix__spectral_gfnet__swiglu_ffn__prompt_kernel:
    s_cmp_ge_u32 s2, 256
    s_cbranch_scc1 L_end_1
    s_load_dwordx4 s[56:59], s[0:1], 0
    s_load_dwordx2 s[60:61], s[0:1], 16
    s_load_dwordx8 s[64:71], s[0:1], 32
    s_load_dwordx4 s[72:75], s[0:1], 64
    s_load_dwordx2 s[76:77], s[0:1], 80
    v_lshrrev_b32 v1, 6, v0
    s_and_b32 s31, s2, 7
    v_readfirstlane_b32 s28, v1
    s_lshr_b32 s32, s2, 3
    s_nop 1
    s_cmp_lg_u32 s28, 7
    s_cbranch_scc1 L_nopf_6
    s_getpc_b64 s[4:5]
    s_add_u32 s4, s4, gated_mix__spectral_gfnet__swiglu_ffn__prompt_kernel@rel32@lo+4
    s_addc_u32 s5, s5, gated_mix__spectral_gfnet__swiglu_ffn__prompt_kernel@rel32@hi+12
    s_mov_b32 s6, code_end_label-gated_mix__spectral_gfnet__swiglu_ffn__prompt_kernel
    s_mov_b32 s7, 0x20000
    s_getpc_b64 s[8:9]
    s_add_u32 s8, s8, tbl_p2@rel32@lo+4
    s_addc_u32 s9, s9, tbl_p2@rel32@hi+12
    s_mov_b32 s10, tbl_end-tbl_p2
    s_mov_b32 s11, 0x20000
    v_and_b32 v2, 63, v0
    s_lshl_b32 s33, s32, 4
    v_add_u32 v3, s33, v2
    v_lshlrev_b32 v3, 7, v3
    s_mul_i32 s33, s32, 48
    v_add_u32 v4, s33, v2
    v_lshlrev_b32 v4, 7, v4
    s_mov_b32 exec_lo, 0xffff
    s_mov_b32 exec_hi, 0
    buffer_load_dword v254, v3, s[4:7], 0 offen
    s_mov_b32 exec_lo, -1
    s_mov_b32 exec_hi, 0xffff
    buffer_load_dword v255, v4, s[8:11], 0 offen
    s_mov_b64 exec, -1
L_nopf_6:
    s_cmp_lg_u32 s2, 0
    s_cbranch_scc1 L_nonoce_7
    s_cmp_lg_u32 s28, 6
    s_cbranch_scc1 L_nonoce_7
    s_memrealtime s[4:5]
    s_waitcnt lgkmcnt(0)
    s_or_b32 s4, s4, 1
    v_mov_b32 v4, s4
    v_mov_b32 v5, s5
    v_mov_b32 v6, 0
    v_mov_b32 v7, 0
    v_mov_b32 v2, 8
    s_mov_b32 s8, s74
    s_mov_b32 s9, s75
    s_mov_b32 s10, 256
    s_mov_b32 s11, 0x20000
    s_mov_b64 exec, 1
    buffer_atomic_cmpswap_x2 v[4:7], v2, s[8:11], 0 offen
    s_mov_b64 exec, -1
L_nonoce_7:
    s_cmp_lt_u32 s32, 8
    s_cbranch_scc1 L_roleF_2
    s_mov_b32 s54, 0
    s_mov_b32 s62, 0
    s_sub_u32 s32, s32, 8
    s_and_b32 s29, s31, 1
    s_lshl_b32 s29, s29, 3
    s_and_b32 s33, s32, 7
    s_add_u32 s29, s29, s33
    s_lshr_b32 s30, s31, 1
    s_mul_i32 s30, s30, 3
    s_lshr_b32 s33, s32, 3
    s_add_u32 s30, s30, s33
    s_lshl_b32 s53, s29, 7
    s_lshl_b32 s33, s30, 3
    s_add_u32 s53, s53, s33
    s_waitcnt lgkmcnt(0)
    s_cmp_ge_u32 s28, 4
    s_cbranch_scc1 L_mload_8
    v_mov_b32 v2, 147456
    v_mov_b32 v3, 0
    ds_write_b32 v2, v3
    s_mov_b32 s12, s74
    s_mov_b32 s13, s75
    s_mov_b32 s14, 256
    s_mov_b32 s15, 0x20000
    v_mov_b32 v4, 8
    buffer_load_dwordx2 v[2:3], v4, s[12:15], 0 offen sc1
    s_waitcnt vmcnt(0) lgkmcnt(0)
    s_mov_b32 s37, 65536
L_nt_9:
    v_readfirstlane_b32 s78, v2
    v_readfirstlane_b32 s79, v3
    s_sub_u32 s37, s37, 1
    s_cmp_eq_u32 s37, 0
    s_cbranch_scc1 L_ntd_10
    s_cmp_lg_u32 s78, 0
    s_cbranch_scc1 L_ntd_10
    s_sleep 2
    buffer_load_dwordx2 v[2:3], v4, s[12:15], 0 offen sc1
    s_waitcnt vmcnt(0)
    s_branch L_nt_9
L_ntd_10:
    v_mbcnt_lo_u32_b32 v0, -1, 0
    v_mbcnt_hi_u32_b32 v0, -1, v0
    s_mov_b32 s24, s76
    s_mov_b32 s25, s77
    s_mov_b32 s26, 6553600
    s_mov_b32 s27, 0x20000
    s_and_b32 s35, s28, 1
    s_lshr_b32 s36, s28, 1
    v_and_b32 v1, 15, v0
    v_lshrrev_b32 v2, 4, v0
    v_lshrrev_b32 v3, 1, v1
    s_lshl_b32 s37, s35, 13
    v_lshlrev_b32 v4, 7, v1
    v_add_u32 v4, s37, v4
    v_or_b32 v5, 0, v2
    v_xor_b32 v5, v5, v3
    v_lshl_add_u32 v112, v5, 4, v4
    v_or_b32 v5, 4, v2
    v_xor_b32 v5, v5, v3
    v_lshl_add_u32 v113, v5, 4, v4
    v_bfe_u32 v6, v0, 2, 2
    v_and_b32 v7, 3, v0
    v_lshl_add_u32 v8, v2, 3, v6
    v_lshlrev_b32 v8, 8, v8
    v_lshl_add_u32 v8, v7, 3, v8
    v_add_u32 v8, 49152, v8
    v_and_b32 v9, 1, v2
    v_lshl_add_u32 v9, v9, 2, v6
    s_lshl_b32 s37, s36, 2
    s_add_u32 s37, s37, 0
    v_xor_b32 v10, s37, v9
    v_lshl_add_u32 v114, v10, 5, v8
    s_lshl_b32 s37, s36, 2
    s_add_u32 s37, s37, 1
    v_xor_b32 v10, s37, v9
    v_lshl_add_u32 v115, v10, 5, v8
    s_lshl_b32 s37, s36, 2
    s_add_u32 s37, s37, 2
    v_xor_b32 v10, s37, v9
    v_lshl_add_u32 v116, v10, 5, v8
    s_lshl_b32 s37, s36, 2
    s_add_u32 s37, s37, 3
    v_xor_b32 v10, s37, v9
    v_lshl_add_u32 v117, v10, 5, v8
    s_mul_i32 s46, s29, 12
    s_add_u32 s46, s46, s30
    s_cmp_ge_u32 s28, 2
    s_cbranch_scc1 L_tf_13
    s_cmp_eq_u32 s28, 1
    s_cbranch_scc1 L_tu_11
    s_mov_b32 s12, s64
    s_mov_b32 s13, s65
    s_mov_b32 s14, 1966080
    s_mov_b32 s15, 0x20000
    s_branch L_tw_12
L_tu_11:
    s_mov_b32 s12, s66
    s_mov_b32 s13, s67
    s_mov_b32 s14, 1966080
    s_mov_b32 s15, 0x20000
L_tw_12:
    v_mul_u32_u24 v12, 192, v0
    v_add_u32 v12, s46, v12
    s_mov_b32 s48, 0xaaab
    v_mul_lo_u32 v13, v12, s48
    v_lshrrev_b32 v13, 20, v13
    v_mul_u32_u24 v14, 24, v13
    v_sub_u32 v14, v12, v14
    v_add_u32 v13, 192, v13
    v_mul_u32_u24 v13, 3072, v13
    v_lshl_add_u32 v121, v14, 7, v13
    v_cmp_gt_u32 vcc, 56, v0
    v_mov_b32 v12, 0x7f000000
    s_nop 1
    v_cndmask_b32 v121, v12, v121, vcc
    s_branch L_tall_16
L_tf_13:
    s_cmp_eq_u32 s28, 3
    s_cbranch_scc1 L_tf_14
    s_mov_b32 s12, s58
    s_mov_b32 s13, s59
    s_mov_b32 s14, 1314816
    s_mov_b32 s15, 0x20000
    s_branch L_tfd_15
L_tf_14:
    s_mov_b32 s12, s60
    s_mov_b32 s13, s61
    s_mov_b32 s14, 1314816
    s_mov_b32 s15, 0x20000
L_tfd_15:
    v_mul_u32_u24 v12, 192, v0
    v_add_u32 v12, s46, v12
    v_lshlrev_b32 v121, 7, v12
L_tall_16:
    s_mov_b32 s8, s68
    s_mov_b32 s9, s69
    s_mov_b32 s10, 1966080
    s_mov_b32 s11, 0x20000
    s_sub_u32 s48, s28, 2
    s_mul_i32 s48, s48, 40
    v_add_u32 v12, s48, v0
    v_mul_u32_u24 v12, 192, v12
    v_add_u32 v12, s46, v12
    v_lshlrev_b32 v122, 7, v12
    v_cmp_gt_u32 vcc, 40, v0
    v_mov_b32 v12, 0x7f000000
    s_nop 1
    v_cndmask_b32 v122, v12, v122, vcc
    s_mov_b32 s41, 0
    v_mov_b32 v128, 0
    v_mov_b32 v129, 0
    v_mov_b32 v130, 0
    v_mov_b32 v131, 0
    v_mov_b32 v132, 0
    v_mov_b32 v133, 0
    v_mov_b32 v134, 0
    v_mov_b32 v135, 0
    v_mov_b32 v136, 0
    v_mov_b32 v137, 0
    v_mov_b32 v138, 0
    v_mov_b32 v139, 0
    v_mov_b32 v140, 0
    v_mov_b32 v141, 0
    v_mov_b32 v142, 0
    v_mov_b32 v143, 0
    v_mov_b32 v144, 0
    v_mov_b32 v145, 0
    v_mov_b32 v146, 0
    v_mov_b32 v147, 0
    v_mov_b32 v148, 0
    v_mov_b32 v149, 0
    v_mov_b32 v150, 0
    v_mov_b32 v151, 0
    v_mov_b32 v152, 0
    v_mov_b32 v153, 0
    v_mov_b32 v154, 0
    v_mov_b32 v155, 0
    v_mov_b32 v156, 0
    v_mov_b32 v157, 0
    v_mov_b32 v158, 0
    v_mov_b32 v159, 0
    v_mov_b32 v160, 0
    v_mov_b32 v161, 0
    v_mov_b32 v162, 0
    v_mov_b32 v163, 0
    v_mov_b32 v164, 0
    v_mov_b32 v165, 0
    v_mov_b32 v166, 0
    v_mov_b32 v167, 0
    v_mov_b32 v168, 0
    v_mov_b32 v169, 0
    v_mov_b32 v170, 0
    v_mov_b32 v171, 0
    v_mov_b32 v172, 0
    v_mov_b32 v173, 0
    v_mov_b32 v174, 0
    v_mov_b32 v175, 0
    v_mov_b32 v176, 0
    v_mov_b32 v177, 0
    v_mov_b32 v178, 0
    v_mov_b32 v179, 0
    v_mov_b32 v180, 0
    v_mov_b32 v181, 0
    v_mov_b32 v182, 0
    v_mov_b32 v183, 0
    v_mov_b32 v184, 0
    v_mov_b32 v185, 0
    v_mov_b32 v186, 0
    v_mov_b32 v187, 0
    v_mov_b32 v188, 0
    v_mov_b32 v189, 0
    v_mov_b32 v190, 0
    v_mov_b32 v191, 0
    v_mov_b32 v192, 0
    v_mov_b32 v193, 0
    v_mov_b32 v194, 0
    v_mov_b32 v195, 0
    v_mov_b32 v196, 0
    v_mov_b32 v197, 0
    v_mov_b32 v198, 0
    v_mov_b32 v199, 0
    v_mov_b32 v200, 0
    v_mov_b32 v201, 0
    v_mov_b32 v202, 0
    v_mov_b32 v203, 0
    v_mov_b32 v204, 0
    v_mov_b32 v205, 0
    v_mov_b32 v206, 0
    v_mov_b32 v207, 0
    v_mov_b32 v208, 0
    v_mov_b32 v209, 0
    v_mov_b32 v210, 0
    v_mov_b32 v211, 0
    v_mov_b32 v212, 0
    v_mov_b32 v213, 0
    v_mov_b32 v214, 0
    v_mov_b32 v215, 0
    v_mov_b32 v216, 0
    v_mov_b32 v217, 0
    v_mov_b32 v218, 0
    v_mov_b32 v219, 0
    v_mov_b32 v220, 0
    v_mov_b32 v221, 0
    v_mov_b32 v222, 0
    v_mov_b32 v223, 0
    v_mov_b32 v224, 0
    v_mov_b32 v225, 0
    v_mov_b32 v226, 0
    v_mov_b32 v227, 0
    v_mov_b32 v228, 0
    v_mov_b32 v229, 0
    v_mov_b32 v230, 0
    v_mov_b32 v231, 0
    v_mov_b32 v232, 0
    v_mov_b32 v233, 0
    v_mov_b32 v234, 0
    v_mov_b32 v235, 0
    v_mov_b32 v236, 0
    v_mov_b32 v237, 0
    v_mov_b32 v238, 0
    v_mov_b32 v239, 0
    v_mov_b32 v240, 0
    v_mov_b32 v241, 0
    v_mov_b32 v242, 0
    v_mov_b32 v243, 0
    v_mov_b32 v244, 0
    v_mov_b32 v245, 0
    v_mov_b32 v246, 0
    v_mov_b32 v247, 0
    v_mov_b32 v248, 0
    v_mov_b32 v249, 0
    v_mov_b32 v250, 0
    v_mov_b32 v251, 0
    v_mov_b32 v252, 0
    v_mov_b32 v253, 0
    v_mov_b32 v254, 0
    v_mov_b32 v255, 0
    s_mov_b32 s40, 0
    s_mov_b32 s41, 0
    s_movk_i32 s50, 16384
    s_mov_b32 s51, 32768
    s_barrier
    buffer_load_dword v120, v121, s[12:15], 0 offen
L_nt_17:
    ds_read_b128 v[48:51], v112 offset:0
    ds_read_b128 v[52:55], v112 offset:2048
    ds_read_b128 v[56:59], v112 offset:4096
    ds_read_b128 v[60:63], v112 offset:6144
    ds_read_b64_tr_b16 v[16:17], v114 offset:0
    ds_read_b64_tr_b16 v[18:19], v114 offset:1024
    ds_read_b64_tr_b16 v[32:33], v114 offset:16384
    ds_read_b64_tr_b16 v[34:35], v114 offset:17408
    ds_read_b64_tr_b16 v[20:21], v115 offset:0
    ds_read_b64_tr_b16 v[22:23], v115 offset:1024
    ds_read_b64_tr_b16 v[36:37], v115 offset:16384
    ds_read_b64_tr_b16 v[38:39], v115 offset:17408
    ds_read_b64_tr_b16 v[24:25], v116 offset:0
    ds_read_b64_tr_b16 v[26:27], v116 offset:1024
    ds_read_b64_tr_b16 v[40:41], v116 offset:16384
    ds_read_b64_tr_b16 v[42:43], v116 offset:17408
    ds_read_b64_tr_b16 v[28:29], v117 offset:0
    ds_read_b64_tr_b16 v[30:31], v117 offset:1024
    ds_read_b64_tr_b16 v[44:45], v117 offset:16384
    ds_read_b64_tr_b16 v[46:47], v117 offset:17408
    s_waitcnt lgkmcnt(0)
L_cloop_18:
    v_mfma_f32_16x16x32_bf16 v[128:131], v[16:19], v[48:51], v[128:131]
    ds_read_b128 v[96:99], v113 offset:0
    v_mfma_f32_16x16x32_bf16 v[132:135], v[16:19], v[52:55], v[132:135]
    ds_read_b128 v[100:103], v113 offset:2048
    v_mfma_f32_16x16x32_bf16 v[136:139], v[16:19], v[56:59], v[136:139]
    ds_read_b128 v[104:107], v113 offset:4096
    v_mfma_f32_16x16x32_bf16 v[140:143], v[16:19], v[60:63], v[140:143]
    ds_read_b128 v[108:111], v113 offset:6144
    v_mfma_f32_16x16x32_bf16 v[192:195], v[32:35], v[48:51], v[192:195]
    ds_read_b64_tr_b16 v[64:65], v114 offset:8192
    v_mfma_f32_16x16x32_bf16 v[196:199], v[32:35], v[52:55], v[196:199]
    ds_read_b64_tr_b16 v[66:67], v114 offset:9216
    v_mfma_f32_16x16x32_bf16 v[200:203], v[32:35], v[56:59], v[200:203]
    ds_read_b64_tr_b16 v[80:81], v114 offset:24576
    v_mfma_f32_16x16x32_bf16 v[204:207], v[32:35], v[60:63], v[204:207]
    ds_read_b64_tr_b16 v[82:83], v114 offset:25600
    v_mfma_f32_16x16x32_bf16 v[144:147], v[20:23], v[48:51], v[144:147]
    ds_read_b64_tr_b16 v[68:69], v115 offset:8192
    v_mfma_f32_16x16x32_bf16 v[148:151], v[20:23], v[52:55], v[148:151]
    ds_read_b64_tr_b16 v[70:71], v115 offset:9216
    v_mfma_f32_16x16x32_bf16 v[152:155], v[20:23], v[56:59], v[152:155]
    ds_read_b64_tr_b16 v[84:85], v115 offset:24576
    v_mfma_f32_16x16x32_bf16 v[156:159], v[20:23], v[60:63], v[156:159]
    ds_read_b64_tr_b16 v[86:87], v115 offset:25600
    v_mfma_f32_16x16x32_bf16 v[208:211], v[36:39], v[48:51], v[208:211]
    ds_read_b64_tr_b16 v[72:73], v116 offset:8192
    v_mfma_f32_16x16x32_bf16 v[212:215], v[36:39], v[52:55], v[212:215]
    ds_read_b64_tr_b16 v[74:75], v116 offset:9216
    v_mfma_f32_16x16x32_bf16 v[216:219], v[36:39], v[56:59], v[216:219]
    ds_read_b64_tr_b16 v[88:89], v116 offset:24576
    v_mfma_f32_16x16x32_bf16 v[220:223], v[36:39], v[60:63], v[220:223]
    ds_read_b64_tr_b16 v[90:91], v116 offset:25600
    v_mfma_f32_16x16x32_bf16 v[160:163], v[24:27], v[48:51], v[160:163]
    ds_read_b64_tr_b16 v[76:77], v117 offset:8192
    v_mfma_f32_16x16x32_bf16 v[164:167], v[24:27], v[52:55], v[164:167]
    ds_read_b64_tr_b16 v[78:79], v117 offset:9216
    v_mfma_f32_16x16x32_bf16 v[168:171], v[24:27], v[56:59], v[168:171]
    ds_read_b64_tr_b16 v[92:93], v117 offset:24576
    v_mfma_f32_16x16x32_bf16 v[172:175], v[24:27], v[60:63], v[172:175]
    ds_read_b64_tr_b16 v[94:95], v117 offset:25600
    v_mfma_f32_16x16x32_bf16 v[224:227], v[40:43], v[48:51], v[224:227]
    s_add_u32 s41, s41, 1
    v_mfma_f32_16x16x32_bf16 v[228:231], v[40:43], v[52:55], v[228:231]
    s_add_u32 s40, s40, 1
    v_mfma_f32_16x16x32_bf16 v[232:235], v[40:43], v[56:59], v[232:235]
    s_cmp_eq_u32 s40, 3
    v_mfma_f32_16x16x32_bf16 v[236:239], v[40:43], v[60:63], v[236:239]
    s_cselect_b32 s42, 0xffff8000, s50
    v_mfma_f32_16x16x32_bf16 v[176:179], v[28:31], v[48:51], v[176:179]
    s_cselect_b32 s43, 0xffff0000, s51
    v_mfma_f32_16x16x32_bf16 v[180:183], v[28:31], v[52:55], v[180:183]
    s_cselect_b32 s40, 0, s40
    v_mfma_f32_16x16x32_bf16 v[184:187], v[28:31], v[56:59], v[184:187]
    v_add_u32 v112, s42, v112
    v_mfma_f32_16x16x32_bf16 v[188:191], v[28:31], v[60:63], v[188:191]
    v_add_u32 v113, s42, v113
    v_mfma_f32_16x16x32_bf16 v[240:243], v[44:47], v[48:51], v[240:243]
    v_add_u32 v114, s43, v114
    v_mfma_f32_16x16x32_bf16 v[244:247], v[44:47], v[52:55], v[244:247]
    v_add_u32 v115, s43, v115
    v_mfma_f32_16x16x32_bf16 v[248:251], v[44:47], v[56:59], v[248:251]
    v_add_u32 v116, s43, v116
    v_mfma_f32_16x16x32_bf16 v[252:255], v[44:47], v[60:63], v[252:255]
    v_add_u32 v117, s43, v117
    s_cmp_eq_u32 s41, 10
    s_waitcnt lgkmcnt(0)
    s_cbranch_scc1 L_cdone_19
    s_barrier
    v_mfma_f32_16x16x32_bf16 v[128:131], v[64:67], v[96:99], v[128:131]
    ds_read_b128 v[48:51], v112 offset:0
    v_mfma_f32_16x16x32_bf16 v[132:135], v[64:67], v[100:103], v[132:135]
    ds_read_b128 v[52:55], v112 offset:2048
    v_mfma_f32_16x16x32_bf16 v[136:139], v[64:67], v[104:107], v[136:139]
    ds_read_b128 v[56:59], v112 offset:4096
    v_mfma_f32_16x16x32_bf16 v[140:143], v[64:67], v[108:111], v[140:143]
    ds_read_b128 v[60:63], v112 offset:6144
    v_mfma_f32_16x16x32_bf16 v[192:195], v[80:83], v[96:99], v[192:195]
    ds_read_b64_tr_b16 v[16:17], v114 offset:0
    v_mfma_f32_16x16x32_bf16 v[196:199], v[80:83], v[100:103], v[196:199]
    ds_read_b64_tr_b16 v[18:19], v114 offset:1024
    v_mfma_f32_16x16x32_bf16 v[200:203], v[80:83], v[104:107], v[200:203]
    ds_read_b64_tr_b16 v[32:33], v114 offset:16384
    v_mfma_f32_16x16x32_bf16 v[204:207], v[80:83], v[108:111], v[204:207]
    ds_read_b64_tr_b16 v[34:35], v114 offset:17408
    v_mfma_f32_16x16x32_bf16 v[144:147], v[68:71], v[96:99], v[144:147]
    ds_read_b64_tr_b16 v[20:21], v115 offset:0
    v_mfma_f32_16x16x32_bf16 v[148:151], v[68:71], v[100:103], v[148:151]
    ds_read_b64_tr_b16 v[22:23], v115 offset:1024
    v_mfma_f32_16x16x32_bf16 v[152:155], v[68:71], v[104:107], v[152:155]
    ds_read_b64_tr_b16 v[36:37], v115 offset:16384
    v_mfma_f32_16x16x32_bf16 v[156:159], v[68:71], v[108:111], v[156:159]
    ds_read_b64_tr_b16 v[38:39], v115 offset:17408
    v_mfma_f32_16x16x32_bf16 v[208:211], v[84:87], v[96:99], v[208:211]
    ds_read_b64_tr_b16 v[24:25], v116 offset:0
    v_mfma_f32_16x16x32_bf16 v[212:215], v[84:87], v[100:103], v[212:215]
    ds_read_b64_tr_b16 v[26:27], v116 offset:1024
    v_mfma_f32_16x16x32_bf16 v[216:219], v[84:87], v[104:107], v[216:219]
    ds_read_b64_tr_b16 v[40:41], v116 offset:16384
    v_mfma_f32_16x16x32_bf16 v[220:223], v[84:87], v[108:111], v[220:223]
    ds_read_b64_tr_b16 v[42:43], v116 offset:17408
    v_mfma_f32_16x16x32_bf16 v[160:163], v[72:75], v[96:99], v[160:163]
    ds_read_b64_tr_b16 v[28:29], v117 offset:0
    v_mfma_f32_16x16x32_bf16 v[164:167], v[72:75], v[100:103], v[164:167]
    ds_read_b64_tr_b16 v[30:31], v117 offset:1024
    v_mfma_f32_16x16x32_bf16 v[168:171], v[72:75], v[104:107], v[168:171]
    ds_read_b64_tr_b16 v[44:45], v117 offset:16384
    v_mfma_f32_16x16x32_bf16 v[172:175], v[72:75], v[108:111], v[172:175]
    ds_read_b64_tr_b16 v[46:47], v117 offset:17408
    v_mfma_f32_16x16x32_bf16 v[224:227], v[88:91], v[96:99], v[224:227]
    v_mfma_f32_16x16x32_bf16 v[228:231], v[88:91], v[100:103], v[228:231]
    v_mfma_f32_16x16x32_bf16 v[232:235], v[88:91], v[104:107], v[232:235]
    v_mfma_f32_16x16x32_bf16 v[236:239], v[88:91], v[108:111], v[236:239]
    v_mfma_f32_16x16x32_bf16 v[176:179], v[76:79], v[96:99], v[176:179]
    v_mfma_f32_16x16x32_bf16 v[180:183], v[76:79], v[100:103], v[180:183]
    v_mfma_f32_16x16x32_bf16 v[184:187], v[76:79], v[104:107], v[184:187]
    v_mfma_f32_16x16x32_bf16 v[188:191], v[76:79], v[108:111], v[188:191]
    v_mfma_f32_16x16x32_bf16 v[240:243], v[92:95], v[96:99], v[240:243]
    v_mfma_f32_16x16x32_bf16 v[244:247], v[92:95], v[100:103], v[244:247]
    v_mfma_f32_16x16x32_bf16 v[248:251], v[92:95], v[104:107], v[248:251]
    v_mfma_f32_16x16x32_bf16 v[252:255], v[92:95], v[108:111], v[252:255]
    s_cmp_lg_u32 s41, 3
    s_cbranch_scc1 L_nwd_20
    s_cmp_lt_u32 s28, 2
    s_cbranch_scc1 L_nwd_20
    buffer_load_dword v120, v122, s[8:11], 0 offen
L_nwd_20:
    s_waitcnt lgkmcnt(0)
    s_branch L_cloop_18
L_cdone_19:
    s_barrier
    v_mfma_f32_16x16x32_bf16 v[128:131], v[64:67], v[96:99], v[128:131]
    v_mfma_f32_16x16x32_bf16 v[132:135], v[64:67], v[100:103], v[132:135]
    v_mfma_f32_16x16x32_bf16 v[136:139], v[64:67], v[104:107], v[136:139]
    v_mfma_f32_16x16x32_bf16 v[140:143], v[64:67], v[108:111], v[140:143]
    v_mfma_f32_16x16x32_bf16 v[192:195], v[80:83], v[96:99], v[192:195]
    v_mfma_f32_16x16x32_bf16 v[196:199], v[80:83], v[100:103], v[196:199]
    v_mfma_f32_16x16x32_bf16 v[200:203], v[80:83], v[104:107], v[200:203]
    v_mfma_f32_16x16x32_bf16 v[204:207], v[80:83], v[108:111], v[204:207]
    v_mfma_f32_16x16x32_bf16 v[144:147], v[68:71], v[96:99], v[144:147]
    v_mfma_f32_16x16x32_bf16 v[148:151], v[68:71], v[100:103], v[148:151]
    v_mfma_f32_16x16x32_bf16 v[152:155], v[68:71], v[104:107], v[152:155]
    v_mfma_f32_16x16x32_bf16 v[156:159], v[68:71], v[108:111], v[156:159]
    v_mfma_f32_16x16x32_bf16 v[208:211], v[84:87], v[96:99], v[208:211]
    v_mfma_f32_16x16x32_bf16 v[212:215], v[84:87], v[100:103], v[212:215]
    v_mfma_f32_16x16x32_bf16 v[216:219], v[84:87], v[104:107], v[216:219]
    v_mfma_f32_16x16x32_bf16 v[220:223], v[84:87], v[108:111], v[220:223]
    v_mfma_f32_16x16x32_bf16 v[160:163], v[72:75], v[96:99], v[160:163]
    v_mfma_f32_16x16x32_bf16 v[164:167], v[72:75], v[100:103], v[164:167]
    v_mfma_f32_16x16x32_bf16 v[168:171], v[72:75], v[104:107], v[168:171]
    v_mfma_f32_16x16x32_bf16 v[172:175], v[72:75], v[108:111], v[172:175]
    v_mfma_f32_16x16x32_bf16 v[224:227], v[88:91], v[96:99], v[224:227]
    v_mfma_f32_16x16x32_bf16 v[228:231], v[88:91], v[100:103], v[228:231]
    v_mfma_f32_16x16x32_bf16 v[232:235], v[88:91], v[104:107], v[232:235]
    v_mfma_f32_16x16x32_bf16 v[236:239], v[88:91], v[108:111], v[236:239]
    v_mfma_f32_16x16x32_bf16 v[176:179], v[76:79], v[96:99], v[176:179]
    v_mfma_f32_16x16x32_bf16 v[180:183], v[76:79], v[100:103], v[180:183]
    v_mfma_f32_16x16x32_bf16 v[184:187], v[76:79], v[104:107], v[184:187]
    v_mfma_f32_16x16x32_bf16 v[188:191], v[76:79], v[108:111], v[188:191]
    v_mfma_f32_16x16x32_bf16 v[240:243], v[92:95], v[96:99], v[240:243]
    v_mfma_f32_16x16x32_bf16 v[244:247], v[92:95], v[100:103], v[244:247]
    v_mfma_f32_16x16x32_bf16 v[248:251], v[92:95], v[104:107], v[248:251]
    v_mfma_f32_16x16x32_bf16 v[252:255], v[92:95], v[108:111], v[252:255]
    s_mov_b32 s44, 0xbfb8aa3b
    s_mov_b32 s45, s44
    v_mbcnt_lo_u32_b32 v0, -1, 0
    v_mbcnt_hi_u32_b32 v0, -1, v0
    s_mul_i32 s37, s28, 36864
    s_add_u32 s37, s37, 20480
    v_and_b32 v1, 15, v0
    v_lshrrev_b32 v2, 4, v0
    v_lshlrev_b32 v3, 7, v1
    v_add_u32 v3, s37, v3
    v_lshrrev_b32 v4, 1, v2
    v_lshl_add_u32 v3, v4, 3, v3
    v_and_b32 v4, 1, v2
    v_and_b32 v5, 7, v0
    v_xor_b32 v4, v4, v5
    v_xor_b32 v5, 0, v4
    v_lshl_add_u32 v114, v5, 4, v3
    v_xor_b32 v5, 2, v4
    v_lshl_add_u32 v115, v5, 4, v3
    v_xor_b32 v5, 4, v4
    v_lshl_add_u32 v116, v5, 4, v3
    v_xor_b32 v5, 6, v4
    v_lshl_add_u32 v117, v5, 4, v3
    v_lshlrev_b32 v61, 4, v0
    v_add_u32 v61, s37, v61
    v_lshrrev_b32 v62, 3, v0
    v_xor_b32 v63, v62, v0
    v_and_b32 v63, 7, v63
    s_lshl_b32 s38, s29, 7
    s_lshl_b32 s39, s35, 6
    s_add_u32 s38, s38, s39
    v_add_u32 v62, s38, v62
    v_mul_u32_u24 v62, 3200, v62
    s_lshl_b32 s38, s30, 8
    s_lshl_b32 s39, s36, 7
    s_add_u32 s38, s38, s39
    v_lshlrev_b32 v63, 4, v63
    v_add3_u32 v62, v62, v63, s38
    v_pk_mul_f32 v[16:17], v[128:129], s[44:45]
    v_pk_mul_f32 v[18:19], v[130:131], s[44:45]
    v_pk_mul_f32 v[20:21], v[144:145], s[44:45]
    v_pk_mul_f32 v[22:23], v[146:147], s[44:45]
    v_pk_mul_f32 v[24:25], v[160:161], s[44:45]
    v_pk_mul_f32 v[26:27], v[162:163], s[44:45]
    v_pk_mul_f32 v[28:29], v[176:177], s[44:45]
    v_pk_mul_f32 v[30:31], v[178:179], s[44:45]
    v_exp_f32 v16, v16
    v_exp_f32 v17, v17
    v_exp_f32 v18, v18
    v_exp_f32 v19, v19
    v_exp_f32 v20, v20
    v_exp_f32 v21, v21
    v_exp_f32 v22, v22
    v_exp_f32 v23, v23
    v_exp_f32 v24, v24
    v_exp_f32 v25, v25
    v_exp_f32 v26, v26
    v_exp_f32 v27, v27
    v_exp_f32 v28, v28
    v_exp_f32 v29, v29
    v_exp_f32 v30, v30
    v_exp_f32 v31, v31
    v_pk_add_f32 v[16:17], v[16:17], 1.0 op_sel_hi:[1,0]
    v_pk_add_f32 v[18:19], v[18:19], 1.0 op_sel_hi:[1,0]
    v_pk_add_f32 v[20:21], v[20:21], 1.0 op_sel_hi:[1,0]
    v_pk_add_f32 v[22:23], v[22:23], 1.0 op_sel_hi:[1,0]
    v_pk_add_f32 v[24:25], v[24:25], 1.0 op_sel_hi:[1,0]
    v_pk_add_f32 v[26:27], v[26:27], 1.0 op_sel_hi:[1,0]
    v_pk_add_f32 v[28:29], v[28:29], 1.0 op_sel_hi:[1,0]
    v_pk_add_f32 v[30:31], v[30:31], 1.0 op_sel_hi:[1,0]
    v_rcp_f32 v16, v16
    v_rcp_f32 v17, v17
    v_rcp_f32 v18, v18
    v_rcp_f32 v19, v19
    v_rcp_f32 v20, v20
    v_rcp_f32 v21, v21
    v_rcp_f32 v22, v22
    v_rcp_f32 v23, v23
    v_rcp_f32 v24, v24
    v_rcp_f32 v25, v25
    v_rcp_f32 v26, v26
    v_rcp_f32 v27, v27
    v_rcp_f32 v28, v28
    v_rcp_f32 v29, v29
    v_rcp_f32 v30, v30
    v_rcp_f32 v31, v31
    v_pk_mul_f32 v[16:17], v[16:17], v[128:129]
    v_pk_mul_f32 v[18:19], v[18:19], v[130:131]
    v_pk_mul_f32 v[20:21], v[20:21], v[144:145]
    v_pk_mul_f32 v[22:23], v[22:23], v[146:147]
    v_pk_mul_f32 v[24:25], v[24:25], v[160:161]
    v_pk_mul_f32 v[26:27], v[26:27], v[162:163]
    v_pk_mul_f32 v[28:29], v[28:29], v[176:177]
    v_pk_mul_f32 v[30:31], v[30:31], v[178:179]
    v_pk_mul_f32 v[16:17], v[16:17], v[192:193]
    v_pk_mul_f32 v[18:19], v[18:19], v[194:195]
    v_pk_mul_f32 v[20:21], v[20:21], v[208:209]
    v_pk_mul_f32 v[22:23], v[22:23], v[210:211]
    v_pk_mul_f32 v[24:25], v[24:25], v[224:225]
    v_pk_mul_f32 v[26:27], v[26:27], v[226:227]
    v_pk_mul_f32 v[28:29], v[28:29], v[240:241]
    v_pk_mul_f32 v[30:31], v[30:31], v[242:243]
    v_cvt_pk_bf16_f32 v32, v16, v17
    v_cvt_pk_bf16_f32 v33, v18, v19
    ds_write_b64 v114, v[32:33] offset:0
    v_cvt_pk_bf16_f32 v34, v20, v21
    v_cvt_pk_bf16_f32 v35, v22, v23
    ds_write_b64 v115, v[34:35] offset:0
    v_cvt_pk_bf16_f32 v36, v24, v25
    v_cvt_pk_bf16_f32 v37, v26, v27
    ds_write_b64 v116, v[36:37] offset:0
    v_cvt_pk_bf16_f32 v38, v28, v29
    v_cvt_pk_bf16_f32 v39, v30, v31
    ds_write_b64 v117, v[38:39] offset:0
    v_pk_mul_f32 v[16:17], v[132:133], s[44:45]
    v_pk_mul_f32 v[18:19], v[134:135], s[44:45]
    v_pk_mul_f32 v[20:21], v[148:149], s[44:45]
    v_pk_mul_f32 v[22:23], v[150:151], s[44:45]
    v_pk_mul_f32 v[24:25], v[164:165], s[44:45]
    v_pk_mul_f32 v[26:27], v[166:167], s[44:45]
    v_pk_mul_f32 v[28:29], v[180:181], s[44:45]
    v_pk_mul_f32 v[30:31], v[182:183], s[44:45]
    v_exp_f32 v16, v16
    v_exp_f32 v17, v17
    v_exp_f32 v18, v18
    v_exp_f32 v19, v19
    v_exp_f32 v20, v20
    v_exp_f32 v21, v21
    v_exp_f32 v22, v22
    v_exp_f32 v23, v23
    v_exp_f32 v24, v24
    v_exp_f32 v25, v25
    v_exp_f32 v26, v26
    v_exp_f32 v27, v27
    v_exp_f32 v28, v28
    v_exp_f32 v29, v29
    v_exp_f32 v30, v30
    v_exp_f32 v31, v31
    v_pk_add_f32 v[16:17], v[16:17], 1.0 op_sel_hi:[1,0]
    v_pk_add_f32 v[18:19], v[18:19], 1.0 op_sel_hi:[1,0]
    v_pk_add_f32 v[20:21], v[20:21], 1.0 op_sel_hi:[1,0]
    v_pk_add_f32 v[22:23], v[22:23], 1.0 op_sel_hi:[1,0]
    v_pk_add_f32 v[24:25], v[24:25], 1.0 op_sel_hi:[1,0]
    v_pk_add_f32 v[26:27], v[26:27], 1.0 op_sel_hi:[1,0]
    v_pk_add_f32 v[28:29], v[28:29], 1.0 op_sel_hi:[1,0]
    v_pk_add_f32 v[30:31], v[30:31], 1.0 op_sel_hi:[1,0]
    v_rcp_f32 v16, v16
    v_rcp_f32 v17, v17
    v_rcp_f32 v18, v18
    v_rcp_f32 v19, v19
    v_rcp_f32 v20, v20
    v_rcp_f32 v21, v21
    v_rcp_f32 v22, v22
    v_rcp_f32 v23, v23
    v_rcp_f32 v24, v24
    v_rcp_f32 v25, v25
    v_rcp_f32 v26, v26
    v_rcp_f32 v27, v27
    v_rcp_f32 v28, v28
    v_rcp_f32 v29, v29
    v_rcp_f32 v30, v30
    v_rcp_f32 v31, v31
    v_pk_mul_f32 v[16:17], v[16:17], v[132:133]
    v_pk_mul_f32 v[18:19], v[18:19], v[134:135]
    v_pk_mul_f32 v[20:21], v[20:21], v[148:149]
    v_pk_mul_f32 v[22:23], v[22:23], v[150:151]
    v_pk_mul_f32 v[24:25], v[24:25], v[164:165]
    v_pk_mul_f32 v[26:27], v[26:27], v[166:167]
    v_pk_mul_f32 v[28:29], v[28:29], v[180:181]
    v_pk_mul_f32 v[30:31], v[30:31], v[182:183]
    v_pk_mul_f32 v[16:17], v[16:17], v[196:197]
    v_pk_mul_f32 v[18:19], v[18:19], v[198:199]
    v_pk_mul_f32 v[20:21], v[20:21], v[212:213]
    v_pk_mul_f32 v[22:23], v[22:23], v[214:215]
    v_pk_mul_f32 v[24:25], v[24:25], v[228:229]
    v_pk_mul_f32 v[26:27], v[26:27], v[230:231]
    v_pk_mul_f32 v[28:29], v[28:29], v[244:245]
    v_pk_mul_f32 v[30:31], v[30:31], v[246:247]
    v_cvt_pk_bf16_f32 v40, v16, v17
    v_cvt_pk_bf16_f32 v41, v18, v19
    ds_write_b64 v114, v[40:41] offset:2048
    v_cvt_pk_bf16_f32 v42, v20, v21
    v_cvt_pk_bf16_f32 v43, v22, v23
    ds_write_b64 v115, v[42:43] offset:2048
    v_cvt_pk_bf16_f32 v44, v24, v25
    v_cvt_pk_bf16_f32 v45, v26, v27
    ds_write_b64 v116, v[44:45] offset:2048
    v_cvt_pk_bf16_f32 v46, v28, v29
    v_cvt_pk_bf16_f32 v47, v30, v31
    ds_write_b64 v117, v[46:47] offset:2048
    s_waitcnt lgkmcnt(0)
    ds_read_b128 v[80:83], v61 offset:0
    ds_read_b128 v[84:87], v61 offset:1024
    ds_read_b128 v[88:91], v61 offset:2048
    ds_read_b128 v[92:95], v61 offset:3072
    s_waitcnt lgkmcnt(3)
    s_mov_b32 s38, 0
    buffer_store_dwordx4 v[80:83], v62, s[24:27], s38 offen sc1
    s_waitcnt lgkmcnt(2)
    s_mov_b32 s38, 25600
    buffer_store_dwordx4 v[84:87], v62, s[24:27], s38 offen sc1
    s_waitcnt lgkmcnt(1)
    s_mov_b32 s38, 51200
    buffer_store_dwordx4 v[88:91], v62, s[24:27], s38 offen sc1
    s_waitcnt lgkmcnt(0)
    s_mov_b32 s38, 76800
    buffer_store_dwordx4 v[92:95], v62, s[24:27], s38 offen sc1
    v_pk_mul_f32 v[16:17], v[136:137], s[44:45]
    v_pk_mul_f32 v[18:19], v[138:139], s[44:45]
    v_pk_mul_f32 v[20:21], v[152:153], s[44:45]
    v_pk_mul_f32 v[22:23], v[154:155], s[44:45]
    v_pk_mul_f32 v[24:25], v[168:169], s[44:45]
    v_pk_mul_f32 v[26:27], v[170:171], s[44:45]
    v_pk_mul_f32 v[28:29], v[184:185], s[44:45]
    v_pk_mul_f32 v[30:31], v[186:187], s[44:45]
    v_exp_f32 v16, v16
    v_exp_f32 v17, v17
    v_exp_f32 v18, v18
    v_exp_f32 v19, v19
    v_exp_f32 v20, v20
    v_exp_f32 v21, v21
    v_exp_f32 v22, v22
    v_exp_f32 v23, v23
    v_exp_f32 v24, v24
    v_exp_f32 v25, v25
    v_exp_f32 v26, v26
    v_exp_f32 v27, v27
    v_exp_f32 v28, v28
    v_exp_f32 v29, v29
    v_exp_f32 v30, v30
    v_exp_f32 v31, v31
    v_pk_add_f32 v[16:17], v[16:17], 1.0 op_sel_hi:[1,0]
    v_pk_add_f32 v[18:19], v[18:19], 1.0 op_sel_hi:[1,0]
    v_pk_add_f32 v[20:21], v[20:21], 1.0 op_sel_hi:[1,0]
    v_pk_add_f32 v[22:23], v[22:23], 1.0 op_sel_hi:[1,0]
    v_pk_add_f32 v[24:25], v[24:25], 1.0 op_sel_hi:[1,0]
    v_pk_add_f32 v[26:27], v[26:27], 1.0 op_sel_hi:[1,0]
    v_pk_add_f32 v[28:29], v[28:29], 1.0 op_sel_hi:[1,0]
    v_pk_add_f32 v[30:31], v[30:31], 1.0 op_sel_hi:[1,0]
    v_rcp_f32 v16, v16
    v_rcp_f32 v17, v17
    v_rcp_f32 v18, v18
    v_rcp_f32 v19, v19
    v_rcp_f32 v20, v20
    v_rcp_f32 v21, v21
    v_rcp_f32 v22, v22
    v_rcp_f32 v23, v23
    v_rcp_f32 v24, v24
    v_rcp_f32 v25, v25
    v_rcp_f32 v26, v26
    v_rcp_f32 v27, v27
    v_rcp_f32 v28, v28
    v_rcp_f32 v29, v29
    v_rcp_f32 v30, v30
    v_rcp_f32 v31, v31
    v_pk_mul_f32 v[16:17], v[16:17], v[136:137]
    v_pk_mul_f32 v[18:19], v[18:19], v[138:139]
    v_pk_mul_f32 v[20:21], v[20:21], v[152:153]
    v_pk_mul_f32 v[22:23], v[22:23], v[154:155]
    v_pk_mul_f32 v[24:25], v[24:25], v[168:169]
    v_pk_mul_f32 v[26:27], v[26:27], v[170:171]
    v_pk_mul_f32 v[28:29], v[28:29], v[184:185]
    v_pk_mul_f32 v[30:31], v[30:31], v[186:187]
    v_pk_mul_f32 v[16:17], v[16:17], v[200:201]
    v_pk_mul_f32 v[18:19], v[18:19], v[202:203]
    v_pk_mul_f32 v[20:21], v[20:21], v[216:217]
    v_pk_mul_f32 v[22:23], v[22:23], v[218:219]
    v_pk_mul_f32 v[24:25], v[24:25], v[232:233]
    v_pk_mul_f32 v[26:27], v[26:27], v[234:235]
    v_pk_mul_f32 v[28:29], v[28:29], v[248:249]
    v_pk_mul_f32 v[30:31], v[30:31], v[250:251]
    v_cvt_pk_bf16_f32 v32, v16, v17
    v_cvt_pk_bf16_f32 v33, v18, v19
    ds_write_b64 v114, v[32:33] offset:4096
    v_cvt_pk_bf16_f32 v34, v20, v21
    v_cvt_pk_bf16_f32 v35, v22, v23
    ds_write_b64 v115, v[34:35] offset:4096
    v_cvt_pk_bf16_f32 v36, v24, v25
    v_cvt_pk_bf16_f32 v37, v26, v27
    ds_write_b64 v116, v[36:37] offset:4096
    v_cvt_pk_bf16_f32 v38, v28, v29
    v_cvt_pk_bf16_f32 v39, v30, v31
    ds_write_b64 v117, v[38:39] offset:4096
    v_pk_mul_f32 v[16:17], v[140:141], s[44:45]
    v_pk_mul_f32 v[18:19], v[142:143], s[44:45]
    v_pk_mul_f32 v[20:21], v[156:157], s[44:45]
    v_pk_mul_f32 v[22:23], v[158:159], s[44:45]
    v_pk_mul_f32 v[24:25], v[172:173], s[44:45]
    v_pk_mul_f32 v[26:27], v[174:175], s[44:45]
    v_pk_mul_f32 v[28:29], v[188:189], s[44:45]
    v_pk_mul_f32 v[30:31], v[190:191], s[44:45]
    v_exp_f32 v16, v16
    v_exp_f32 v17, v17
    v_exp_f32 v18, v18
    v_exp_f32 v19, v19
    v_exp_f32 v20, v20
    v_exp_f32 v21, v21
    v_exp_f32 v22, v22
    v_exp_f32 v23, v23
    v_exp_f32 v24, v24
    v_exp_f32 v25, v25
    v_exp_f32 v26, v26
    v_exp_f32 v27, v27
    v_exp_f32 v28, v28
    v_exp_f32 v29, v29
    v_exp_f32 v30, v30
    v_exp_f32 v31, v31
    v_pk_add_f32 v[16:17], v[16:17], 1.0 op_sel_hi:[1,0]
    v_pk_add_f32 v[18:19], v[18:19], 1.0 op_sel_hi:[1,0]
    v_pk_add_f32 v[20:21], v[20:21], 1.0 op_sel_hi:[1,0]
    v_pk_add_f32 v[22:23], v[22:23], 1.0 op_sel_hi:[1,0]
    v_pk_add_f32 v[24:25], v[24:25], 1.0 op_sel_hi:[1,0]
    v_pk_add_f32 v[26:27], v[26:27], 1.0 op_sel_hi:[1,0]
    v_pk_add_f32 v[28:29], v[28:29], 1.0 op_sel_hi:[1,0]
    v_pk_add_f32 v[30:31], v[30:31], 1.0 op_sel_hi:[1,0]
    v_rcp_f32 v16, v16
    v_rcp_f32 v17, v17
    v_rcp_f32 v18, v18
    v_rcp_f32 v19, v19
    v_rcp_f32 v20, v20
    v_rcp_f32 v21, v21
    v_rcp_f32 v22, v22
    v_rcp_f32 v23, v23
    v_rcp_f32 v24, v24
    v_rcp_f32 v25, v25
    v_rcp_f32 v26, v26
    v_rcp_f32 v27, v27
    v_rcp_f32 v28, v28
    v_rcp_f32 v29, v29
    v_rcp_f32 v30, v30
    v_rcp_f32 v31, v31
    v_pk_mul_f32 v[16:17], v[16:17], v[140:141]
    v_pk_mul_f32 v[18:19], v[18:19], v[142:143]
    v_pk_mul_f32 v[20:21], v[20:21], v[156:157]
    v_pk_mul_f32 v[22:23], v[22:23], v[158:159]
    v_pk_mul_f32 v[24:25], v[24:25], v[172:173]
    v_pk_mul_f32 v[26:27], v[26:27], v[174:175]
    v_pk_mul_f32 v[28:29], v[28:29], v[188:189]
    v_pk_mul_f32 v[30:31], v[30:31], v[190:191]
    v_pk_mul_f32 v[16:17], v[16:17], v[204:205]
    v_pk_mul_f32 v[18:19], v[18:19], v[206:207]
    v_pk_mul_f32 v[20:21], v[20:21], v[220:221]
    v_pk_mul_f32 v[22:23], v[22:23], v[222:223]
    v_pk_mul_f32 v[24:25], v[24:25], v[236:237]
    v_pk_mul_f32 v[26:27], v[26:27], v[238:239]
    v_pk_mul_f32 v[28:29], v[28:29], v[252:253]
    v_pk_mul_f32 v[30:31], v[30:31], v[254:255]
    v_cvt_pk_bf16_f32 v40, v16, v17
    v_cvt_pk_bf16_f32 v41, v18, v19
    ds_write_b64 v114, v[40:41] offset:6144
    v_cvt_pk_bf16_f32 v42, v20, v21
    v_cvt_pk_bf16_f32 v43, v22, v23
    ds_write_b64 v115, v[42:43] offset:6144
    v_cvt_pk_bf16_f32 v44, v24, v25
    v_cvt_pk_bf16_f32 v45, v26, v27
    ds_write_b64 v116, v[44:45] offset:6144
    v_cvt_pk_bf16_f32 v46, v28, v29
    v_cvt_pk_bf16_f32 v47, v30, v31
    ds_write_b64 v117, v[46:47] offset:6144
    s_waitcnt lgkmcnt(0)
    ds_read_b128 v[80:83], v61 offset:4096
    ds_read_b128 v[84:87], v61 offset:5120
    ds_read_b128 v[88:91], v61 offset:6144
    ds_read_b128 v[92:95], v61 offset:7168
    s_waitcnt lgkmcnt(3)
    s_mov_b32 s38, 102400
    buffer_store_dwordx4 v[80:83], v62, s[24:27], s38 offen sc1
    s_waitcnt lgkmcnt(2)
    s_mov_b32 s38, 128000
    buffer_store_dwordx4 v[84:87], v62, s[24:27], s38 offen sc1
    s_waitcnt lgkmcnt(1)
    s_mov_b32 s38, 153600
    buffer_store_dwordx4 v[88:91], v62, s[24:27], s38 offen sc1
    s_waitcnt lgkmcnt(0)
    s_mov_b32 s38, 179200
    buffer_store_dwordx4 v[92:95], v62, s[24:27], s38 offen sc1
    s_branch L_final_3
L_mload_8:
    v_mbcnt_lo_u32_b32 v0, -1, 0
    v_mbcnt_hi_u32_b32 v0, -1, v0
    s_mov_b32 s12, s56
    s_mov_b32 s13, s57
    s_mov_b32 s14, 2621440
    s_mov_b32 s15, 0x20000
    s_mov_b32 s16, s64
    s_mov_b32 s17, s65
    s_mov_b32 s18, 1966080
    s_mov_b32 s19, 0x20000
    s_mov_b32 s20, s66
    s_mov_b32 s21, s67
    s_mov_b32 s22, 1966080
    s_mov_b32 s23, 0x20000
    s_sub_u32 s35, s28, 4
    v_lshrrev_b32 v2, 3, v0
    v_and_b32 v3, 7, v0
    v_lshrrev_b32 v4, 4, v0
    v_xor_b32 v5, v3, v4
    v_lshlrev_b32 v5, 4, v5
    v_xor_b32 v6, 64, v5
    v_mul_u32_u24 v2, 1280, v2
    s_lshl_b32 s37, s29, 7
    s_lshl_b32 s38, s35, 5
    s_add_u32 s37, s37, s38
    s_mul_i32 s37, s37, 1280
    s_add_u32 s38, s37, 0
    v_add3_u32 v8, v2, v5, s38
    s_add_u32 s38, s37, 9216
    v_add3_u32 v9, v2, v6, s38
    s_add_u32 s38, s37, 18432
    v_add3_u32 v10, v2, v5, s38
    s_add_u32 s38, s37, 27648
    v_add3_u32 v11, v2, v6, s38
    v_and_b32 v3, 15, v0
    v_lshlrev_b32 v5, 1, v4
    v_xor_b32 v3, v3, v5
    v_xor_b32 v7, 8, v3
    v_lshlrev_b32 v3, 4, v3
    v_lshlrev_b32 v7, 4, v7
    v_mul_u32_u24 v4, 3072, v4
    s_mul_i32 s37, s35, 16*3072
    s_lshl_b32 s38, s30, 8
    s_add_u32 s37, s37, s38
    s_add_u32 s38, s37, 0
    v_add3_u32 v12, v4, v3, s38
    s_add_u32 s38, s37, 11264
    v_add3_u32 v13, v4, v3, s38
    s_add_u32 s38, s37, 22528
    v_add3_u32 v14, v4, v7, s38
    s_add_u32 s38, s37, 33792
    v_add3_u32 v15, v4, v7, s38
    s_lshl_b32 s40, s35, 12
    s_add_u32 s41, s40, 49152
    s_mov_b32 s42, 0
    s_mov_b32 s43, 0
    s_mov_b32 s44, 0
    s_movk_i32 s50, 16384
    s_mov_b32 s51, 32768
    s_mov_b32 m0, s40
    s_nop 0
    buffer_load_dwordx4 v8, s[12:15], s42 offen offset:0 lds
    buffer_load_dwordx4 v9, s[12:15], s42 offen offset:1024 lds
    buffer_load_dwordx4 v10, s[12:15], s42 offen offset:2048 lds
    buffer_load_dwordx4 v11, s[12:15], s42 offen offset:3072 lds
    s_mov_b32 m0, s41
    s_add_u32 s45, s41, 16384
    buffer_load_dwordx4 v12, s[16:19], s43 offen offset:0 lds
    buffer_load_dwordx4 v13, s[16:19], s43 offen offset:1024 lds
    buffer_load_dwordx4 v14, s[16:19], s43 offen offset:2048 lds
    buffer_load_dwordx4 v15, s[16:19], s43 offen offset:3072 lds
    s_mov_b32 m0, s45
    s_add_u32 s42, s42, 128
    buffer_load_dwordx4 v12, s[20:23], s43 offen offset:0 lds
    buffer_load_dwordx4 v13, s[20:23], s43 offen offset:1024 lds
    buffer_load_dwordx4 v14, s[20:23], s43 offen offset:2048 lds
    buffer_load_dwordx4 v15, s[20:23], s43 offen offset:3072 lds
    s_add_u32 s43, s43, 196608
    s_add_u32 s44, s44, 1
    s_cmp_eq_u32 s44, 3
    s_cselect_b32 s46, 0xffff8000, s50
    s_cselect_b32 s47, 0xffff0000, s51
    s_cselect_b32 s44, 0, s44
    s_add_u32 s40, s40, s46
    s_add_u32 s41, s41, s47
    s_mov_b32 m0, s40
    s_nop 0
    buffer_load_dwordx4 v8, s[12:15], s42 offen offset:0 lds
    buffer_load_dwordx4 v9, s[12:15], s42 offen offset:1024 lds
    buffer_load_dwordx4 v10, s[12:15], s42 offen offset:2048 lds
    buffer_load_dwordx4 v11, s[12:15], s42 offen offset:3072 lds
    s_mov_b32 m0, s41
    s_add_u32 s45, s41, 16384
    buffer_load_dwordx4 v12, s[16:19], s43 offen offset:0 lds
    buffer_load_dwordx4 v13, s[16:19], s43 offen offset:1024 lds
    buffer_load_dwordx4 v14, s[16:19], s43 offen offset:2048 lds
    buffer_load_dwordx4 v15, s[16:19], s43 offen offset:3072 lds
    s_mov_b32 m0, s45
    s_add_u32 s42, s42, 128
    buffer_load_dwordx4 v12, s[20:23], s43 offen offset:0 lds
    buffer_load_dwordx4 v13, s[20:23], s43 offen offset:1024 lds
    buffer_load_dwordx4 v14, s[20:23], s43 offen offset:2048 lds
    buffer_load_dwordx4 v15, s[20:23], s43 offen offset:3072 lds
    s_add_u32 s43, s43, 196608
    s_add_u32 s44, s44, 1
    s_cmp_eq_u32 s44, 3
    s_cselect_b32 s46, 0xffff8000, s50
    s_cselect_b32 s47, 0xffff0000, s51
    s_cselect_b32 s44, 0, s44
    s_add_u32 s40, s40, s46
    s_add_u32 s41, s41, s47
    s_mov_b32 s24, s74
    s_mov_b32 s25, s75
    s_mov_b32 s26, 256
    s_mov_b32 s27, 0x20000
    v_mov_b32 v22, 8
    buffer_load_dwordx2 v[20:21], v22, s[24:27], 0 offen sc1
    s_waitcnt vmcnt(13)
    s_barrier
    s_mov_b32 m0, s40
    s_nop 0
    buffer_load_dwordx4 v8, s[12:15], s42 offen offset:0 lds
    buffer_load_dwordx4 v9, s[12:15], s42 offen offset:1024 lds
    buffer_load_dwordx4 v10, s[12:15], s42 offen offset:2048 lds
    buffer_load_dwordx4 v11, s[12:15], s42 offen offset:3072 lds
    s_mov_b32 m0, s41
    s_add_u32 s45, s41, 16384
    buffer_load_dwordx4 v12, s[16:19], s43 offen offset:0 lds
    buffer_load_dwordx4 v13, s[16:19], s43 offen offset:1024 lds
    buffer_load_dwordx4 v14, s[16:19], s43 offen offset:2048 lds
    buffer_load_dwordx4 v15, s[16:19], s43 offen offset:3072 lds
    s_mov_b32 m0, s45
    s_add_u32 s42, s42, 128
    buffer_load_dwordx4 v12, s[20:23], s43 offen offset:0 lds
    buffer_load_dwordx4 v13, s[20:23], s43 offen offset:1024 lds
    buffer_load_dwordx4 v14, s[20:23], s43 offen offset:2048 lds
    buffer_load_dwordx4 v15, s[20:23], s43 offen offset:3072 lds
    s_add_u32 s43, s43, 196608
    s_add_u32 s44, s44, 1
    s_cmp_eq_u32 s44, 3
    s_cselect_b32 s46, 0xffff8000, s50
    s_cselect_b32 s47, 0xffff0000, s51
    s_cselect_b32 s44, 0, s44
    s_add_u32 s40, s40, s46
    s_add_u32 s41, s41, s47
    s_mov_b32 s48, 7
L_lloop_21:
    s_waitcnt vmcnt(12)
    s_barrier
    s_mov_b32 m0, s40
    s_nop 0
    buffer_load_dwordx4 v8, s[12:15], s42 offen offset:0 lds
    buffer_load_dwordx4 v9, s[12:15], s42 offen offset:1024 lds
    buffer_load_dwordx4 v10, s[12:15], s42 offen offset:2048 lds
    buffer_load_dwordx4 v11, s[12:15], s42 offen offset:3072 lds
    s_mov_b32 m0, s41
    s_add_u32 s45, s41, 16384
    buffer_load_dwordx4 v12, s[16:19], s43 offen offset:0 lds
    buffer_load_dwordx4 v13, s[16:19], s43 offen offset:1024 lds
    buffer_load_dwordx4 v14, s[16:19], s43 offen offset:2048 lds
    buffer_load_dwordx4 v15, s[16:19], s43 offen offset:3072 lds
    s_mov_b32 m0, s45
    s_add_u32 s42, s42, 128
    buffer_load_dwordx4 v12, s[20:23], s43 offen offset:0 lds
    buffer_load_dwordx4 v13, s[20:23], s43 offen offset:1024 lds
    buffer_load_dwordx4 v14, s[20:23], s43 offen offset:2048 lds
    buffer_load_dwordx4 v15, s[20:23], s43 offen offset:3072 lds
    s_add_u32 s43, s43, 196608
    s_add_u32 s44, s44, 1
    s_cmp_eq_u32 s44, 3
    s_cselect_b32 s46, 0xffff8000, s50
    s_cselect_b32 s47, 0xffff0000, s51
    s_cselect_b32 s44, 0, s44
    s_add_u32 s40, s40, s46
    s_add_u32 s41, s41, s47
    s_sub_u32 s48, s48, 1
    s_cmp_lg_u32 s48, 0
    s_cbranch_scc1 L_lloop_21
    s_waitcnt vmcnt(12)
    s_barrier
    s_waitcnt vmcnt(0)
    s_barrier
    s_mov_b32 s50, 65536
L_nt_22:
    v_readfirstlane_b32 s78, v20
    v_readfirstlane_b32 s79, v21
    s_sub_u32 s50, s50, 1
    s_cmp_eq_u32 s50, 0
    s_cbranch_scc1 L_ntd_23
    s_cmp_lg_u32 s78, 0
    s_cbranch_scc1 L_ntd_23
    s_sleep 2
    buffer_load_dwordx2 v[20:21], v22, s[24:27], 0 offen sc1
    s_waitcnt vmcnt(0)
    s_branch L_nt_22
L_ntd_23:
    s_barrier
    s_branch L_final_3
L_roleF_2:
    s_mov_b32 s54, 1
    s_mov_b32 s53, 0
    s_mov_b32 s62, 0
    s_lshl_b32 s55, s32, 3
    s_add_u32 s55, s55, s31
    s_waitcnt lgkmcnt(0)
    v_mbcnt_lo_u32_b32 v0, -1, 0
    v_mbcnt_hi_u32_b32 v0, -1, v0
    v_mov_b32 v2, 147456
    v_mov_b32 v4, 0
    v_mov_b32 v5, 0
    v_mov_b32 v6, 0
    v_mov_b32 v7, 0
    ds_write_b128 v2, v[4:7]
    ds_write_b128 v2, v[4:7] offset:16
    s_mov_b32 s12, s56
    s_mov_b32 s13, s57
    s_mov_b32 s14, 2621440
    s_mov_b32 s15, 0x20000
    s_getpc_b64 s[16:17]
    s_add_u32 s16, s16, tbl_t160f@rel32@lo+4
    s_addc_u32 s17, s17, tbl_t160f@rel32@hi+12
    s_mov_b32 s18, 61440
    s_mov_b32 s19, 0x20000
    s_lshl_b32 s29, s28, 2
    v_lshrrev_b32 v2, 5, v0
    v_add_u32 v2, s29, v2
    v_and_b32 v3, 7, v2
    v_lshlrev_b32 v3, 1, v3
    v_and_b32 v4, 31, v0
    v_xor_b32 v4, v4, v3
    v_and_b32 v6, 24, v2
    v_and_b32 v7, 1, v2
    v_lshl_add_u32 v6, v7, 2, v6
    v_bfe_u32 v7, v2, 1, 2
    v_add_u32 v6, v6, v7
    v_lshlrev_b32 v6, 6, v6
    v_add_u32 v5, s55, v6
    v_mul_u32_u24 v5, 1280, v5
    v_lshl_add_u32 v8, v4, 4, v5
    v_lshrrev_b32 v2, 5, v0
    v_add_u32 v2, s29, v2
    v_add_u32 v2, 2, v2
    v_and_b32 v3, 7, v2
    v_lshlrev_b32 v3, 1, v3
    v_and_b32 v4, 31, v0
    v_xor_b32 v4, v4, v3
    v_and_b32 v6, 24, v2
    v_and_b32 v7, 1, v2
    v_lshl_add_u32 v6, v7, 2, v6
    v_bfe_u32 v7, v2, 1, 2
    v_add_u32 v6, v6, v7
    v_lshlrev_b32 v6, 6, v6
    v_add_u32 v5, s55, v6
    v_mul_u32_u24 v5, 1280, v5
    v_lshl_add_u32 v9, v4, 4, v5
    v_lshrrev_b32 v2, 4, v0
    v_add_u32 v2, s29, v2
    v_and_b32 v3, 7, v2
    v_lshlrev_b32 v3, 1, v3
    v_and_b32 v4, 15, v0
    v_xor_b32 v4, v4, v3
    v_and_b32 v6, 24, v2
    v_and_b32 v7, 1, v2
    v_lshl_add_u32 v6, v7, 2, v6
    v_bfe_u32 v7, v2, 1, 2
    v_add_u32 v6, v6, v7
    v_lshlrev_b32 v6, 6, v6
    v_add_u32 v5, s55, v6
    v_mul_u32_u24 v5, 1280, v5
    v_lshl_add_u32 v10, v4, 4, v5
    v_lshlrev_b32 v1, 4, v0
    s_lshl_b32 s30, s28, 11
    s_mul_i32 s31, s28, 3
    s_add_u32 m0, s30, 0
    s_movk_i32 s33, 0
    buffer_load_dwordx4 v8, s[12:15], s33 offen lds
    s_add_u32 m0, s30, 1024
    s_movk_i32 s33, 0
    buffer_load_dwordx4 v9, s[12:15], s33 offen lds
    s_add_u32 s32, s31, 0
    s_lshr_b32 s33, s32, 2
    s_mul_i32 s33, s33, 10
    s_and_b32 s32, s32, 3
    s_add_u32 s33, s33, s32
    s_add_u32 s33, s33, 0
    s_lshl_b32 s33, s33, 10
    s_add_u32 m0, s33, 40960
    s_nop 0
    buffer_load_dwordx4 v1, s[16:19], s33 offen lds
    s_add_u32 s32, s31, 1
    s_lshr_b32 s33, s32, 2
    s_mul_i32 s33, s33, 10
    s_and_b32 s32, s32, 3
    s_add_u32 s33, s33, s32
    s_add_u32 s33, s33, 0
    s_lshl_b32 s33, s33, 10
    s_add_u32 m0, s33, 40960
    s_nop 0
    buffer_load_dwordx4 v1, s[16:19], s33 offen lds
    s_add_u32 s32, s31, 2
    s_lshr_b32 s33, s32, 2
    s_mul_i32 s33, s33, 10
    s_and_b32 s32, s32, 3
    s_add_u32 s33, s33, s32
    s_add_u32 s33, s33, 0
    s_lshl_b32 s33, s33, 10
    s_add_u32 m0, s33, 40960
    s_nop 0
    buffer_load_dwordx4 v1, s[16:19], s33 offen lds
    s_add_u32 m0, s30, 16384
    s_movk_i32 s33, 512
    buffer_load_dwordx4 v8, s[12:15], s33 offen lds
    s_add_u32 m0, s30, 17408
    s_movk_i32 s33, 512
    buffer_load_dwordx4 v9, s[12:15], s33 offen lds
    s_add_u32 s32, s31, 0
    s_lshr_b32 s33, s32, 2
    s_mul_i32 s33, s33, 10
    s_and_b32 s32, s32, 3
    s_add_u32 s33, s33, s32
    s_add_u32 s33, s33, 4
    s_lshl_b32 s33, s33, 10
    s_add_u32 m0, s33, 40960
    s_nop 0
    buffer_load_dwordx4 v1, s[16:19], s33 offen lds
    s_add_u32 s32, s31, 1
    s_lshr_b32 s33, s32, 2
    s_mul_i32 s33, s33, 10
    s_and_b32 s32, s32, 3
    s_add_u32 s33, s33, s32
    s_add_u32 s33, s33, 4
    s_lshl_b32 s33, s33, 10
    s_add_u32 m0, s33, 40960
    s_nop 0
    buffer_load_dwordx4 v1, s[16:19], s33 offen lds
    s_add_u32 s32, s31, 2
    s_lshr_b32 s33, s32, 2
    s_mul_i32 s33, s33, 10
    s_and_b32 s32, s32, 3
    s_add_u32 s33, s33, s32
    s_add_u32 s33, s33, 4
    s_lshl_b32 s33, s33, 10
    s_add_u32 m0, s33, 40960
    s_nop 0
    buffer_load_dwordx4 v1, s[16:19], s33 offen lds
    s_lshl_b32 s32, s28, 10
    s_add_u32 m0, s32, 32768
    s_movk_i32 s33, 1024
    buffer_load_dwordx4 v10, s[12:15], s33 offen lds
    s_add_u32 s32, s28, 0
    s_lshr_b32 s33, s32, 1
    s_mul_i32 s33, s33, 10
    s_and_b32 s32, s32, 1
    s_add_u32 s33, s33, s32
    s_add_u32 s33, s33, 8
    s_lshl_b32 s33, s33, 10
    s_add_u32 m0, s33, 40960
    s_nop 0
    buffer_load_dwordx4 v1, s[16:19], s33 offen lds
    s_cmp_ge_u32 s28, 4
    s_cbranch_scc1 L_skip_24
    s_add_u32 s32, s28, 8
    s_lshr_b32 s33, s32, 1
    s_mul_i32 s33, s33, 10
    s_and_b32 s32, s32, 1
    s_add_u32 s33, s33, s32
    s_add_u32 s33, s33, 8
    s_lshl_b32 s33, s33, 10
    s_add_u32 m0, s33, 40960
    s_nop 0
    buffer_load_dwordx4 v1, s[16:19], s33 offen lds
L_skip_24:
    s_and_b32 s30, s28, 3
    s_cmp_ge_u32 s28, 4
    s_cbranch_scc1 L_hi_25
    v_and_b32 v3, 31, v0
    v_add_u32 v3, 0, v3
    v_lshlrev_b32 v9, 5, v3
    s_lshr_b32 s33, s55, 1
    s_and_b32 s33, s33, 7
    s_and_b32 s34, s30, 2
    s_xor_b32 s33, s33, s34
    v_lshrrev_b32 v5, 5, v0
    v_xor_b32 v5, s33, v5
    v_and_b32 v6, 7, v0
    v_xor_b32 v5, v5, v6
    v_lshlrev_b32 v6, 7, v3
    s_and_b32 s34, s30, 1
    s_lshl_b32 s34, s34, 3
    s_add_u32 s34, s34, 40960
    v_add_u32 v6, s34, v6
    v_lshl_add_u32 v12, v5, 4, v6
    v_xor_b32 v5, 4, v5
    v_lshl_add_u32 v13, v5, 4, v6
    v_lshlrev_b32 v14, 4, v0
    v_add_u32 v14, 40960, v14
    v_and_b32 v2, 3, v0
    v_lshrrev_b32 v3, 4, v0
    v_and_b32 v3, 1, v3
    v_lshl_add_u32 v2, v3, 2, v2
    v_lshrrev_b32 v3, 2, v0
    v_and_b32 v3, 3, v3
    v_lshrrev_b32 v4, 5, v0
    v_lshlrev_b32 v4, 2, v4
    v_lshrrev_b32 v5, 1, v3
    v_add_u32 v4, v4, v5
    v_lshlrev_b32 v5, 1, v2
    s_lshl_b32 s32, s30, 3
    v_add_u32 v2, s32, v2
    v_and_b32 v3, 1, v3
    v_lshlrev_b32 v3, 3, v3
    v_lshl_add_u32 v6, v2, 9, v3
    v_lshl_add_u32 v7, v2, 8, v3
    v_add_u32 v7, 32768, v7
    v_or_b32 v8, 0, v4
    v_xor_b32 v8, v8, v5
    v_lshl_add_u32 v16, v8, 4, v6
    v_lshl_add_u32 v20, v8, 4, v7
    v_or_b32 v8, 2, v4
    v_xor_b32 v8, v8, v5
    v_lshl_add_u32 v17, v8, 4, v6
    v_lshl_add_u32 v21, v8, 4, v7
    v_or_b32 v8, 8, v4
    v_xor_b32 v8, v8, v5
    v_lshl_add_u32 v18, v8, 4, v6
    v_lshl_add_u32 v22, v8, 4, v7
    v_or_b32 v8, 10, v4
    v_xor_b32 v8, v8, v5
    v_lshl_add_u32 v19, v8, 4, v6
    v_lshl_add_u32 v23, v8, 4, v7
    v_lshrrev_b32 v6, 3, v0
    s_mul_i32 s32, s30, 663552
    s_lshl_b32 s33, s55, 7
    s_add_u32 s32, s32, s33
    v_add_u32 v7, 0, v6
    v_xor_b32 v15, v7, v0
    v_and_b32 v15, 7, v15
    v_lshlrev_b32 v15, 4, v15
    v_lshl_add_u32 v15, v7, 13, v15
    v_add_u32 v224, s32, v15
    v_add_u32 v7, 8, v6
    v_xor_b32 v15, v7, v0
    v_and_b32 v15, 7, v15
    v_lshlrev_b32 v15, 4, v15
    v_lshl_add_u32 v15, v7, 13, v15
    v_add_u32 v225, s32, v15
    v_add_u32 v7, 16, v6
    v_xor_b32 v15, v7, v0
    v_and_b32 v15, 7, v15
    v_lshlrev_b32 v15, 4, v15
    v_lshl_add_u32 v15, v7, 13, v15
    v_add_u32 v226, s32, v15
    v_add_u32 v7, 24, v6
    v_xor_b32 v15, v7, v0
    v_and_b32 v15, 7, v15
    v_lshlrev_b32 v15, 4, v15
    v_lshl_add_u32 v15, v7, 13, v15
    v_add_u32 v227, s32, v15
    v_add_u32 v7, 32, v6
    v_xor_b32 v15, v7, v0
    v_and_b32 v15, 7, v15
    v_lshlrev_b32 v15, 4, v15
    v_lshl_add_u32 v15, v7, 13, v15
    v_add_u32 v228, s32, v15
    v_add_u32 v7, 40, v6
    v_xor_b32 v15, v7, v0
    v_and_b32 v15, 7, v15
    v_lshlrev_b32 v15, 4, v15
    v_lshl_add_u32 v15, v7, 13, v15
    v_add_u32 v229, s32, v15
    v_add_u32 v7, 48, v6
    v_xor_b32 v15, v7, v0
    v_and_b32 v15, 7, v15
    v_lshlrev_b32 v15, 4, v15
    v_lshl_add_u32 v15, v7, 13, v15
    v_add_u32 v230, s32, v15
    v_add_u32 v7, 56, v6
    v_xor_b32 v15, v7, v0
    v_and_b32 v15, 7, v15
    v_lshlrev_b32 v15, 4, v15
    v_lshl_add_u32 v15, v7, 13, v15
    v_add_u32 v231, s32, v15
    v_add_u32 v7, 64, v6
    v_xor_b32 v15, v7, v0
    v_and_b32 v15, 7, v15
    v_lshlrev_b32 v15, 4, v15
    v_lshl_add_u32 v15, v7, 13, v15
    v_add_u32 v232, s32, v15
    v_add_u32 v7, 72, v6
    v_xor_b32 v15, v7, v0
    v_and_b32 v15, 7, v15
    v_lshlrev_b32 v15, 4, v15
    v_lshl_add_u32 v15, v7, 13, v15
    v_add_u32 v233, s32, v15
    v_add_u32 v7, 80, v6
    v_xor_b32 v15, v7, v0
    v_and_b32 v15, 7, v15
    v_lshlrev_b32 v15, 4, v15
    v_lshl_add_u32 v15, v7, 13, v15
    v_add_u32 v15, s32, v15
    v_cmp_lt_u32 vcc, 80, v7
    v_mov_b32 v7, 0x7f000000
    s_nop 0
    v_cndmask_b32 v234, v15, v7, vcc
    s_waitcnt vmcnt(8)
    s_barrier
    s_getpc_b64 s[20:21]
    s_add_u32 s20, s20, tbl_tw640@rel32@lo+4
    s_addc_u32 s21, s21, tbl_tw640@rel32@hi+12
    s_mov_b32 s22, 3072
    s_mov_b32 s23, 0x20000
    buffer_load_dwordx4 v[208:211], v9, s[20:23], 0 offen offset:0
    buffer_load_dwordx2 v[212:213], v9, s[20:23], 0 offen offset:16
    buffer_load_dwordx4 v[216:219], v9, s[20:23], 0 offen offset:1024
    buffer_load_dwordx2 v[220:221], v9, s[20:23], 0 offen offset:1040
    s_mov_b32 s4, s74
    s_mov_b32 s5, s75
    s_mov_b32 s6, 256
    s_mov_b32 s7, 0x20000
    v_mov_b32 v202, 8
    buffer_load_dwordx2 v[200:201], v202, s[4:7], 0 offen sc1
    ds_read_b64_tr_b16 v[128:129], v16 offset:0
    ds_read_b64_tr_b16 v[130:131], v17 offset:0
    ds_read_b128 v[132:135], v14 offset:0
    ds_read_b128 v[136:139], v14 offset:10240
    ds_read_b128 v[140:143], v14 offset:20480
    ds_read_b128 v[144:147], v14 offset:30720
    ds_read_b64_tr_b16 v[148:149], v18 offset:0
    ds_read_b64_tr_b16 v[150:151], v19 offset:0
    ds_read_b128 v[152:155], v14 offset:1024
    ds_read_b128 v[156:159], v14 offset:11264
    ds_read_b128 v[160:163], v14 offset:21504
    ds_read_b128 v[164:167], v14 offset:31744
    s_waitcnt lgkmcnt(6)
    v_mfma_f32_32x32x16_bf16 v[64:79], v[128:131], v[132:135], 0
    ds_read_b64_tr_b16 v[168:169], v16 offset:256
    ds_read_b64_tr_b16 v[170:171], v17 offset:256
    v_mfma_f32_32x32x16_bf16 v[80:95], v[128:131], v[136:139], 0
    ds_read_b128 v[172:175], v14 offset:2048
    ds_read_b128 v[176:179], v14 offset:12288
    v_mfma_f32_32x32x16_bf16 v[96:111], v[128:131], v[140:143], 0
    ds_read_b128 v[180:183], v14 offset:22528
    ds_read_b128 v[184:187], v14 offset:32768
    v_mfma_f32_32x32x16_bf16 v[112:127], v[128:131], v[144:147], 0
    s_waitcnt lgkmcnt(6)
    v_mfma_f32_32x32x16_bf16 v[64:79], v[148:151], v[152:155], v[64:79]
    ds_read_b64_tr_b16 v[128:129], v18 offset:256
    ds_read_b64_tr_b16 v[130:131], v19 offset:256
    v_mfma_f32_32x32x16_bf16 v[80:95], v[148:151], v[156:159], v[80:95]
    ds_read_b128 v[132:135], v14 offset:3072
    ds_read_b128 v[136:139], v14 offset:13312
    v_mfma_f32_32x32x16_bf16 v[96:111], v[148:151], v[160:163], v[96:111]
    ds_read_b128 v[140:143], v14 offset:23552
    ds_read_b128 v[144:147], v14 offset:33792
    v_mfma_f32_32x32x16_bf16 v[112:127], v[148:151], v[164:167], v[112:127]
    s_waitcnt vmcnt(8)
    s_barrier
    s_waitcnt lgkmcnt(6)
    v_mfma_f32_32x32x16_bf16 v[64:79], v[168:171], v[172:175], v[64:79]
    ds_read_b64_tr_b16 v[148:149], v16 offset:16384
    ds_read_b64_tr_b16 v[150:151], v17 offset:16384
    v_mfma_f32_32x32x16_bf16 v[80:95], v[168:171], v[176:179], v[80:95]
    ds_read_b128 v[152:155], v14 offset:4096
    ds_read_b128 v[156:159], v14 offset:14336
    v_mfma_f32_32x32x16_bf16 v[96:111], v[168:171], v[180:183], v[96:111]
    ds_read_b128 v[160:163], v14 offset:24576
    ds_read_b128 v[164:167], v14 offset:34816
    v_mfma_f32_32x32x16_bf16 v[112:127], v[168:171], v[184:187], v[112:127]
    s_waitcnt lgkmcnt(6)
    v_mfma_f32_32x32x16_bf16 v[64:79], v[128:131], v[132:135], v[64:79]
    ds_read_b64_tr_b16 v[168:169], v18 offset:16384
    ds_read_b64_tr_b16 v[170:171], v19 offset:16384
    v_mfma_f32_32x32x16_bf16 v[80:95], v[128:131], v[136:139], v[80:95]
    ds_read_b128 v[172:175], v14 offset:5120
    ds_read_b128 v[176:179], v14 offset:15360
    v_mfma_f32_32x32x16_bf16 v[96:111], v[128:131], v[140:143], v[96:111]
    ds_read_b128 v[180:183], v14 offset:25600
    ds_read_b128 v[184:187], v14 offset:35840
    v_mfma_f32_32x32x16_bf16 v[112:127], v[128:131], v[144:147], v[112:127]
    s_waitcnt lgkmcnt(6)
    v_mfma_f32_32x32x16_bf16 v[64:79], v[148:151], v[152:155], v[64:79]
    ds_read_b64_tr_b16 v[128:129], v16 offset:16640
    ds_read_b64_tr_b16 v[130:131], v17 offset:16640
    v_mfma_f32_32x32x16_bf16 v[80:95], v[148:151], v[156:159], v[80:95]
    ds_read_b128 v[132:135], v14 offset:6144
    ds_read_b128 v[136:139], v14 offset:16384
    v_mfma_f32_32x32x16_bf16 v[96:111], v[148:151], v[160:163], v[96:111]
    ds_read_b128 v[140:143], v14 offset:26624
    ds_read_b128 v[144:147], v14 offset:36864
    v_mfma_f32_32x32x16_bf16 v[112:127], v[148:151], v[164:167], v[112:127]
    s_waitcnt lgkmcnt(6)
    v_mfma_f32_32x32x16_bf16 v[64:79], v[168:171], v[172:175], v[64:79]
    ds_read_b64_tr_b16 v[148:149], v18 offset:16640
    ds_read_b64_tr_b16 v[150:151], v19 offset:16640
    v_mfma_f32_32x32x16_bf16 v[80:95], v[168:171], v[176:179], v[80:95]
    ds_read_b128 v[152:155], v14 offset:7168
    ds_read_b128 v[156:159], v14 offset:17408
    v_mfma_f32_32x32x16_bf16 v[96:111], v[168:171], v[180:183], v[96:111]
    ds_read_b128 v[160:163], v14 offset:27648
    ds_read_b128 v[164:167], v14 offset:37888
    v_mfma_f32_32x32x16_bf16 v[112:127], v[168:171], v[184:187], v[112:127]
    s_waitcnt vmcnt(0)
    s_barrier
    s_mov_b32 s37, 65536
L_nt_27:
    v_readfirstlane_b32 s78, v200
    v_readfirstlane_b32 s79, v201
    s_sub_u32 s37, s37, 1
    s_cmp_eq_u32 s37, 0
    s_cbranch_scc1 L_ntd_28
    s_cmp_lg_u32 s78, 0
    s_cbranch_scc1 L_ntd_28
    s_sleep 2
    buffer_load_dwordx2 v[200:201], v202, s[4:7], 0 offen sc1
    s_waitcnt vmcnt(0)
    s_branch L_nt_27
L_ntd_28:
    s_mov_b32 s20, s58
    s_mov_b32 s21, s59
    s_mov_b32 s22, 1314816
    s_mov_b32 s23, 0x20000
    s_mov_b32 s24, s60
    s_mov_b32 s25, s61
    s_mov_b32 s26, 1314816
    s_mov_b32 s27, 0x20000
    s_mul_i32 s32, s55, 20544
    s_add_u32 s31, s28, 0
    s_lshl_b32 s33, s31, 10
    s_add_u32 s34, s33, s32
    s_add_u32 m0, s33, 102400
    s_nop 0
    buffer_load_dwordx4 v1, s[20:23], s34 offen lds
    s_add_u32 s31, s28, 8
    s_lshl_b32 s33, s31, 10
    s_add_u32 s34, s33, s32
    s_add_u32 m0, s33, 102400
    s_nop 0
    buffer_load_dwordx4 v1, s[20:23], s34 offen lds
    s_add_u32 s31, s28, 16
    s_cmp_ge_u32 s31, 21
    s_cbranch_scc1 L_wim_36
    s_lshl_b32 s33, s31, 10
    s_add_u32 s34, s33, s32
    s_add_u32 m0, s33, 102400
    s_nop 0
    buffer_load_dwordx4 v1, s[20:23], s34 offen lds
    s_branch L_wdn_37
L_wim_36:
    s_sub_u32 s31, s31, 21
    s_lshl_b32 s33, s31, 10
    s_add_u32 s34, s33, s32
    s_add_u32 m0, s33, 123904
    s_nop 0
    buffer_load_dwordx4 v1, s[24:27], s34 offen lds
L_wdn_37:
    s_add_u32 s31, s28, 24
    s_sub_u32 s31, s31, 21
    s_lshl_b32 s33, s31, 10
    s_add_u32 s34, s33, s32
    s_add_u32 m0, s33, 123904
    s_nop 0
    buffer_load_dwordx4 v1, s[24:27], s34 offen lds
    s_add_u32 s31, s28, 32
    s_sub_u32 s31, s31, 21
    s_lshl_b32 s33, s31, 10
    s_add_u32 s34, s33, s32
    s_add_u32 m0, s33, 123904
    s_nop 0
    buffer_load_dwordx4 v1, s[24:27], s34 offen lds
    s_add_u32 s31, s28, 40
    s_cmp_ge_u32 s31, 42
    s_cbranch_scc1 L_wsk_44
    s_sub_u32 s31, s31, 21
    s_lshl_b32 s33, s31, 10
    s_add_u32 s34, s33, s32
    s_add_u32 m0, s33, 123904
    s_nop 0
    buffer_load_dwordx4 v1, s[24:27], s34 offen lds
L_wsk_44:
    s_waitcnt lgkmcnt(6)
    v_mfma_f32_32x32x16_bf16 v[64:79], v[128:131], v[132:135], v[64:79]
    ds_read_b64_tr_b16 v[168:169], v20 offset:0
    ds_read_b64_tr_b16 v[170:171], v21 offset:0
    v_mfma_f32_32x32x16_bf16 v[80:95], v[128:131], v[136:139], v[80:95]
    ds_read_b128 v[172:175], v14 offset:8192
    ds_read_b128 v[176:179], v14 offset:18432
    v_mfma_f32_32x32x16_bf16 v[96:111], v[128:131], v[140:143], v[96:111]
    ds_read_b128 v[180:183], v14 offset:28672
    ds_read_b128 v[184:187], v14 offset:38912
    v_mfma_f32_32x32x16_bf16 v[112:127], v[128:131], v[144:147], v[112:127]
    s_waitcnt lgkmcnt(6)
    v_mfma_f32_32x32x16_bf16 v[64:79], v[148:151], v[152:155], v[64:79]
    ds_read_b64_tr_b16 v[128:129], v22 offset:0
    ds_read_b64_tr_b16 v[130:131], v23 offset:0
    v_mfma_f32_32x32x16_bf16 v[80:95], v[148:151], v[156:159], v[80:95]
    ds_read_b128 v[132:135], v14 offset:9216
    ds_read_b128 v[136:139], v14 offset:19456
    v_mfma_f32_32x32x16_bf16 v[96:111], v[148:151], v[160:163], v[96:111]
    ds_read_b128 v[140:143], v14 offset:29696
    ds_read_b128 v[144:147], v14 offset:39936
    v_mfma_f32_32x32x16_bf16 v[112:127], v[148:151], v[164:167], v[112:127]
    s_waitcnt lgkmcnt(6)
    v_mfma_f32_32x32x16_bf16 v[64:79], v[168:171], v[172:175], v[64:79]
    v_mfma_f32_32x32x16_bf16 v[80:95], v[168:171], v[176:179], v[80:95]
    v_mfma_f32_32x32x16_bf16 v[96:111], v[168:171], v[180:183], v[96:111]
    v_mfma_f32_32x32x16_bf16 v[112:127], v[168:171], v[184:187], v[112:127]
    s_waitcnt lgkmcnt(0)
    v_mfma_f32_32x32x16_bf16 v[64:79], v[128:131], v[132:135], v[64:79]
    v_mfma_f32_32x32x16_bf16 v[80:95], v[128:131], v[136:139], v[80:95]
    v_mfma_f32_32x32x16_bf16 v[96:111], v[128:131], v[140:143], v[96:111]
    v_mfma_f32_32x32x16_bf16 v[112:127], v[128:131], v[144:147], v[112:127]
    s_barrier
    s_nop 7
    s_nop 3
    v_mov_b32 v192, 1.0
    v_mov_b32 v193, v208
    v_mov_b32 v194, 0
    v_mov_b32 v195, v209
    v_mov_b32 v196, v210
    v_mov_b32 v197, v212
    v_mov_b32 v198, v211
    v_mov_b32 v199, v213
    v_pk_mul_f32 v[32:33], v[64:65], v[192:193]
    v_pk_mul_f32 v[34:35], v[80:81], v[192:193]
    v_pk_mul_f32 v[36:37], v[66:67], v[196:197]
    v_pk_mul_f32 v[38:39], v[82:83], v[196:197]
    v_pk_fma_f32 v[32:33], v[80:81], v[194:195], v[32:33]
    v_pk_fma_f32 v[34:35], v[64:65], v[194:195], v[34:35] neg_lo:[1,0,0] neg_hi:[1,0,0]
    v_pk_fma_f32 v[36:37], v[82:83], v[198:199], v[36:37]
    v_pk_fma_f32 v[38:39], v[66:67], v[198:199], v[38:39] neg_lo:[1,0,0] neg_hi:[1,0,0]
    v_pk_add_f32 v[64:65], v[32:33], v[36:37]
    v_pk_add_f32 v[80:81], v[34:35], v[38:39]
    v_pk_add_f32 v[66:67], v[32:33], v[36:37] neg_lo:[0,1] neg_hi:[0,1]
    v_pk_add_f32 v[82:83], v[34:35], v[38:39] neg_lo:[0,1] neg_hi:[0,1]
    v_pk_add_f32 v[128:129], v[64:65], v[64:65] op_sel:[0,1] op_sel_hi:[0,1] neg_hi:[0,1]
    v_pk_add_f32 v[130:131], v[80:81], v[80:81] op_sel:[0,1] op_sel_hi:[0,1] neg_hi:[1,0]
    v_pk_add_f32 v[132:133], v[66:67], v[82:83] op_sel:[0,1] op_sel_hi:[0,1] neg_hi:[0,1]
    v_pk_add_f32 v[134:135], v[82:83], v[66:67] op_sel:[0,1] op_sel_hi:[0,1] neg_lo:[0,1] neg_hi:[1,1]
    v_pk_mul_f32 v[40:41], v[68:69], v[192:193]
    v_pk_mul_f32 v[42:43], v[84:85], v[192:193]
    v_pk_mul_f32 v[44:45], v[70:71], v[196:197]
    v_pk_mul_f32 v[46:47], v[86:87], v[196:197]
    v_pk_fma_f32 v[40:41], v[84:85], v[194:195], v[40:41]
    v_pk_fma_f32 v[42:43], v[68:69], v[194:195], v[42:43] neg_lo:[1,0,0] neg_hi:[1,0,0]
    v_pk_fma_f32 v[44:45], v[86:87], v[198:199], v[44:45]
    v_pk_fma_f32 v[46:47], v[70:71], v[198:199], v[46:47] neg_lo:[1,0,0] neg_hi:[1,0,0]
    v_pk_add_f32 v[68:69], v[40:41], v[44:45]
    v_pk_add_f32 v[84:85], v[42:43], v[46:47]
    v_pk_add_f32 v[70:71], v[40:41], v[44:45] neg_lo:[0,1] neg_hi:[0,1]
    v_pk_add_f32 v[86:87], v[42:43], v[46:47] neg_lo:[0,1] neg_hi:[0,1]
    v_pk_add_f32 v[136:137], v[68:69], v[68:69] op_sel:[0,1] op_sel_hi:[0,1] neg_hi:[0,1]
    v_pk_add_f32 v[138:139], v[84:85], v[84:85] op_sel:[0,1] op_sel_hi:[0,1] neg_hi:[1,0]
    v_pk_add_f32 v[140:141], v[70:71], v[86:87] op_sel:[0,1] op_sel_hi:[0,1] neg_hi:[0,1]
    v_pk_add_f32 v[142:143], v[86:87], v[70:71] op_sel:[0,1] op_sel_hi:[0,1] neg_lo:[0,1] neg_hi:[1,1]
    v_pk_mul_f32 v[32:33], v[72:73], v[192:193]
    v_pk_mul_f32 v[34:35], v[88:89], v[192:193]
    v_pk_mul_f32 v[36:37], v[74:75], v[196:197]
    v_pk_mul_f32 v[38:39], v[90:91], v[196:197]
    v_pk_fma_f32 v[32:33], v[88:89], v[194:195], v[32:33]
    v_pk_fma_f32 v[34:35], v[72:73], v[194:195], v[34:35] neg_lo:[1,0,0] neg_hi:[1,0,0]
    v_pk_fma_f32 v[36:37], v[90:91], v[198:199], v[36:37]
    v_pk_fma_f32 v[38:39], v[74:75], v[198:199], v[38:39] neg_lo:[1,0,0] neg_hi:[1,0,0]
    v_pk_add_f32 v[72:73], v[32:33], v[36:37]
    v_pk_add_f32 v[88:89], v[34:35], v[38:39]
    v_pk_add_f32 v[74:75], v[32:33], v[36:37] neg_lo:[0,1] neg_hi:[0,1]
    v_pk_add_f32 v[90:91], v[34:35], v[38:39] neg_lo:[0,1] neg_hi:[0,1]
    v_pk_add_f32 v[144:145], v[72:73], v[72:73] op_sel:[0,1] op_sel_hi:[0,1] neg_hi:[0,1]
    v_pk_add_f32 v[146:147], v[88:89], v[88:89] op_sel:[0,1] op_sel_hi:[0,1] neg_hi:[1,0]
    v_pk_add_f32 v[148:149], v[74:75], v[90:91] op_sel:[0,1] op_sel_hi:[0,1] neg_hi:[0,1]
    v_pk_add_f32 v[150:151], v[90:91], v[74:75] op_sel:[0,1] op_sel_hi:[0,1] neg_lo:[0,1] neg_hi:[1,1]
    v_pk_mul_f32 v[40:41], v[76:77], v[192:193]
    v_pk_mul_f32 v[42:43], v[92:93], v[192:193]
    v_pk_mul_f32 v[44:45], v[78:79], v[196:197]
    v_pk_mul_f32 v[46:47], v[94:95], v[196:197]
    v_pk_fma_f32 v[40:41], v[92:93], v[194:195], v[40:41]
    v_pk_fma_f32 v[42:43], v[76:77], v[194:195], v[42:43] neg_lo:[1,0,0] neg_hi:[1,0,0]
    v_pk_fma_f32 v[44:45], v[94:95], v[198:199], v[44:45]
    v_pk_fma_f32 v[46:47], v[78:79], v[198:199], v[46:47] neg_lo:[1,0,0] neg_hi:[1,0,0]
    v_pk_add_f32 v[76:77], v[40:41], v[44:45]
    v_pk_add_f32 v[92:93], v[42:43], v[46:47]
    v_pk_add_f32 v[78:79], v[40:41], v[44:45] neg_lo:[0,1] neg_hi:[0,1]
    v_pk_add_f32 v[94:95], v[42:43], v[46:47] neg_lo:[0,1] neg_hi:[0,1]
    v_pk_add_f32 v[152:153], v[76:77], v[76:77] op_sel:[0,1] op_sel_hi:[0,1] neg_hi:[0,1]
    v_pk_add_f32 v[154:155], v[92:93], v[92:93] op_sel:[0,1] op_sel_hi:[0,1] neg_hi:[1,0]
    v_pk_add_f32 v[156:157], v[78:79], v[94:95] op_sel:[0,1] op_sel_hi:[0,1] neg_hi:[0,1]
    v_pk_add_f32 v[158:159], v[94:95], v[78:79] op_sel:[0,1] op_sel_hi:[0,1] neg_lo:[0,1] neg_hi:[1,1]
    v_cvt_pk_bf16_f32 v48, v128, v136
    v_cvt_pk_bf16_f32 v49, v144, v152
    ds_write_b64 v12, v[48:49] offset:0
    v_cvt_pk_bf16_f32 v50, v130, v138
    v_cvt_pk_bf16_f32 v51, v146, v154
    ds_write_b64 v13, v[50:51] offset:0
    v_cvt_pk_bf16_f32 v52, v132, v140
    v_cvt_pk_bf16_f32 v53, v148, v156
    ds_write_b64 v12, v[52:53] offset:12288
    v_cvt_pk_bf16_f32 v54, v134, v142
    v_cvt_pk_bf16_f32 v55, v150, v158
    ds_write_b64 v13, v[54:55] offset:12288
    v_cvt_pk_bf16_f32 v48, v129, v137
    v_cvt_pk_bf16_f32 v49, v145, v153
    ds_write_b64 v12, v[48:49] offset:24576
    v_cvt_pk_bf16_f32 v50, v131, v139
    v_cvt_pk_bf16_f32 v51, v147, v155
    ds_write_b64 v13, v[50:51] offset:24576
    v_cvt_pk_bf16_f32 v52, v133, v141
    v_cvt_pk_bf16_f32 v53, v149, v157
    ds_write_b64 v12, v[52:53] offset:36864
    v_cvt_pk_bf16_f32 v54, v135, v143
    v_cvt_pk_bf16_f32 v55, v151, v159
    ds_write_b64 v13, v[54:55] offset:36864
    v_mov_b32 v192, 1.0
    v_mov_b32 v193, v216
    v_mov_b32 v194, 0
    v_mov_b32 v195, v217
    v_mov_b32 v196, v218
    v_mov_b32 v197, v220
    v_mov_b32 v198, v219
    v_mov_b32 v199, v221
    v_pk_mul_f32 v[32:33], v[96:97], v[192:193]
    v_pk_mul_f32 v[34:35], v[112:113], v[192:193]
    v_pk_mul_f32 v[36:37], v[98:99], v[196:197]
    v_pk_mul_f32 v[38:39], v[114:115], v[196:197]
    v_pk_fma_f32 v[32:33], v[112:113], v[194:195], v[32:33]
    v_pk_fma_f32 v[34:35], v[96:97], v[194:195], v[34:35] neg_lo:[1,0,0] neg_hi:[1,0,0]
    v_pk_fma_f32 v[36:37], v[114:115], v[198:199], v[36:37]
    v_pk_fma_f32 v[38:39], v[98:99], v[198:199], v[38:39] neg_lo:[1,0,0] neg_hi:[1,0,0]
    v_pk_add_f32 v[96:97], v[32:33], v[36:37]
    v_pk_add_f32 v[112:113], v[34:35], v[38:39]
    v_pk_add_f32 v[98:99], v[32:33], v[36:37] neg_lo:[0,1] neg_hi:[0,1]
    v_pk_add_f32 v[114:115], v[34:35], v[38:39] neg_lo:[0,1] neg_hi:[0,1]
    v_pk_add_f32 v[128:129], v[96:97], v[96:97] op_sel:[0,1] op_sel_hi:[0,1] neg_hi:[0,1]
    v_pk_add_f32 v[130:131], v[112:113], v[112:113] op_sel:[0,1] op_sel_hi:[0,1] neg_hi:[1,0]
    v_pk_add_f32 v[132:133], v[98:99], v[114:115] op_sel:[0,1] op_sel_hi:[0,1] neg_hi:[0,1]
    v_pk_add_f32 v[134:135], v[114:115], v[98:99] op_sel:[0,1] op_sel_hi:[0,1] neg_lo:[0,1] neg_hi:[1,1]
    v_pk_mul_f32 v[40:41], v[100:101], v[192:193]
    v_pk_mul_f32 v[42:43], v[116:117], v[192:193]
    v_pk_mul_f32 v[44:45], v[102:103], v[196:197]
    v_pk_mul_f32 v[46:47], v[118:119], v[196:197]
    v_pk_fma_f32 v[40:41], v[116:117], v[194:195], v[40:41]
    v_pk_fma_f32 v[42:43], v[100:101], v[194:195], v[42:43] neg_lo:[1,0,0] neg_hi:[1,0,0]
    v_pk_fma_f32 v[44:45], v[118:119], v[198:199], v[44:45]
    v_pk_fma_f32 v[46:47], v[102:103], v[198:199], v[46:47] neg_lo:[1,0,0] neg_hi:[1,0,0]
    v_pk_add_f32 v[100:101], v[40:41], v[44:45]
    v_pk_add_f32 v[116:117], v[42:43], v[46:47]
    v_pk_add_f32 v[102:103], v[40:41], v[44:45] neg_lo:[0,1] neg_hi:[0,1]
    v_pk_add_f32 v[118:119], v[42:43], v[46:47] neg_lo:[0,1] neg_hi:[0,1]
    v_pk_add_f32 v[136:137], v[100:101], v[100:101] op_sel:[0,1] op_sel_hi:[0,1] neg_hi:[0,1]
    v_pk_add_f32 v[138:139], v[116:117], v[116:117] op_sel:[0,1] op_sel_hi:[0,1] neg_hi:[1,0]
    v_pk_add_f32 v[140:141], v[102:103], v[118:119] op_sel:[0,1] op_sel_hi:[0,1] neg_hi:[0,1]
    v_pk_add_f32 v[142:143], v[118:119], v[102:103] op_sel:[0,1] op_sel_hi:[0,1] neg_lo:[0,1] neg_hi:[1,1]
    v_pk_mul_f32 v[32:33], v[104:105], v[192:193]
    v_pk_mul_f32 v[34:35], v[120:121], v[192:193]
    v_pk_mul_f32 v[36:37], v[106:107], v[196:197]
    v_pk_mul_f32 v[38:39], v[122:123], v[196:197]
    v_pk_fma_f32 v[32:33], v[120:121], v[194:195], v[32:33]
    v_pk_fma_f32 v[34:35], v[104:105], v[194:195], v[34:35] neg_lo:[1,0,0] neg_hi:[1,0,0]
    v_pk_fma_f32 v[36:37], v[122:123], v[198:199], v[36:37]
    v_pk_fma_f32 v[38:39], v[106:107], v[198:199], v[38:39] neg_lo:[1,0,0] neg_hi:[1,0,0]
    v_pk_add_f32 v[104:105], v[32:33], v[36:37]
    v_pk_add_f32 v[120:121], v[34:35], v[38:39]
    v_pk_add_f32 v[106:107], v[32:33], v[36:37] neg_lo:[0,1] neg_hi:[0,1]
    v_pk_add_f32 v[122:123], v[34:35], v[38:39] neg_lo:[0,1] neg_hi:[0,1]
    v_pk_add_f32 v[144:145], v[104:105], v[104:105] op_sel:[0,1] op_sel_hi:[0,1] neg_hi:[0,1]
    v_pk_add_f32 v[146:147], v[120:121], v[120:121] op_sel:[0,1] op_sel_hi:[0,1] neg_hi:[1,0]
    v_pk_add_f32 v[148:149], v[106:107], v[122:123] op_sel:[0,1] op_sel_hi:[0,1] neg_hi:[0,1]
    v_pk_add_f32 v[150:151], v[122:123], v[106:107] op_sel:[0,1] op_sel_hi:[0,1] neg_lo:[0,1] neg_hi:[1,1]
    v_pk_mul_f32 v[40:41], v[108:109], v[192:193]
    v_pk_mul_f32 v[42:43], v[124:125], v[192:193]
    v_pk_mul_f32 v[44:45], v[110:111], v[196:197]
    v_pk_mul_f32 v[46:47], v[126:127], v[196:197]
    v_pk_fma_f32 v[40:41], v[124:125], v[194:195], v[40:41]
    v_pk_fma_f32 v[42:43], v[108:109], v[194:195], v[42:43] neg_lo:[1,0,0] neg_hi:[1,0,0]
    v_pk_fma_f32 v[44:45], v[126:127], v[198:199], v[44:45]
    v_pk_fma_f32 v[46:47], v[110:111], v[198:199], v[46:47] neg_lo:[1,0,0] neg_hi:[1,0,0]
    v_pk_add_f32 v[108:109], v[40:41], v[44:45]
    v_pk_add_f32 v[124:125], v[42:43], v[46:47]
    v_pk_add_f32 v[110:111], v[40:41], v[44:45] neg_lo:[0,1] neg_hi:[0,1]
    v_pk_add_f32 v[126:127], v[42:43], v[46:47] neg_lo:[0,1] neg_hi:[0,1]
    v_pk_add_f32 v[152:153], v[108:109], v[108:109] op_sel:[0,1] op_sel_hi:[0,1] neg_hi:[0,1]
    v_pk_add_f32 v[154:155], v[124:125], v[124:125] op_sel:[0,1] op_sel_hi:[0,1] neg_hi:[1,0]
    v_pk_add_f32 v[156:157], v[110:111], v[126:127] op_sel:[0,1] op_sel_hi:[0,1] neg_hi:[0,1]
    v_pk_add_f32 v[158:159], v[126:127], v[110:111] op_sel:[0,1] op_sel_hi:[0,1] neg_lo:[0,1] neg_hi:[1,1]
    v_cvt_pk_bf16_f32 v56, v128, v136
    v_cvt_pk_bf16_f32 v57, v144, v152
    ds_write_b64 v12, v[56:57] offset:4096
    v_cvt_pk_bf16_f32 v58, v130, v138
    v_cvt_pk_bf16_f32 v59, v146, v154
    ds_write_b64 v13, v[58:59] offset:4096
    v_cvt_pk_bf16_f32 v60, v132, v140
    v_cvt_pk_bf16_f32 v61, v148, v156
    ds_write_b64 v12, v[60:61] offset:16384
    v_cvt_pk_bf16_f32 v62, v134, v142
    v_cvt_pk_bf16_f32 v63, v150, v158
    ds_write_b64 v13, v[62:63] offset:16384
    v_cvt_pk_bf16_f32 v56, v129, v137
    v_cvt_pk_bf16_f32 v57, v145, v153
    ds_write_b64 v12, v[56:57] offset:28672
    v_cvt_pk_bf16_f32 v58, v131, v139
    v_cvt_pk_bf16_f32 v59, v147, v155
    ds_write_b64 v13, v[58:59] offset:28672
    v_cvt_pk_bf16_f32 v60, v133, v141
    v_cvt_pk_bf16_f32 v61, v149, v157
    ds_write_b64 v12, v[60:61] offset:40960
    v_cvt_pk_bf16_f32 v62, v135, v143
    v_cvt_pk_bf16_f32 v63, v151, v159
    ds_write_b64 v13, v[62:63] offset:40960
    s_waitcnt lgkmcnt(0)
    s_branch L_p1join_26
L_hi_25:
    v_and_b32 v3, 31, v0
    v_add_u32 v3, 64, v3
    v_lshlrev_b32 v9, 5, v3
    s_lshr_b32 s33, s55, 1
    s_and_b32 s33, s33, 7
    s_and_b32 s34, s30, 2
    s_xor_b32 s33, s33, s34
    v_lshrrev_b32 v5, 5, v0
    v_xor_b32 v5, s33, v5
    v_and_b32 v6, 7, v0
    v_xor_b32 v5, v5, v6
    v_lshlrev_b32 v6, 7, v3
    s_and_b32 s34, s30, 1
    s_lshl_b32 s34, s34, 3
    s_add_u32 s34, s34, 40960
    v_add_u32 v6, s34, v6
    v_lshl_add_u32 v12, v5, 4, v6
    v_xor_b32 v5, 4, v5
    v_lshl_add_u32 v13, v5, 4, v6
    v_lshlrev_b32 v14, 4, v0
    v_add_u32 v14, 81920, v14
    v_and_b32 v2, 3, v0
    v_lshrrev_b32 v3, 4, v0
    v_and_b32 v3, 1, v3
    v_lshl_add_u32 v2, v3, 2, v2
    v_lshrrev_b32 v3, 2, v0
    v_and_b32 v3, 3, v3
    v_lshrrev_b32 v4, 5, v0
    v_lshlrev_b32 v4, 2, v4
    v_lshrrev_b32 v5, 1, v3
    v_add_u32 v4, v4, v5
    v_lshlrev_b32 v5, 1, v2
    s_lshl_b32 s32, s30, 3
    v_add_u32 v2, s32, v2
    v_and_b32 v3, 1, v3
    v_lshlrev_b32 v3, 3, v3
    v_lshl_add_u32 v6, v2, 9, v3
    v_lshl_add_u32 v7, v2, 8, v3
    v_add_u32 v7, 32768, v7
    v_or_b32 v8, 0, v4
    v_xor_b32 v8, v8, v5
    v_lshl_add_u32 v16, v8, 4, v6
    v_lshl_add_u32 v20, v8, 4, v7
    v_or_b32 v8, 2, v4
    v_xor_b32 v8, v8, v5
    v_lshl_add_u32 v17, v8, 4, v6
    v_lshl_add_u32 v21, v8, 4, v7
    v_or_b32 v8, 8, v4
    v_xor_b32 v8, v8, v5
    v_lshl_add_u32 v18, v8, 4, v6
    v_lshl_add_u32 v22, v8, 4, v7
    v_or_b32 v8, 10, v4
    v_xor_b32 v8, v8, v5
    v_lshl_add_u32 v19, v8, 4, v6
    v_lshl_add_u32 v23, v8, 4, v7
    s_waitcnt vmcnt(7)
    s_barrier
    s_getpc_b64 s[20:21]
    s_add_u32 s20, s20, tbl_tw640@rel32@lo+4
    s_addc_u32 s21, s21, tbl_tw640@rel32@hi+12
    s_mov_b32 s22, 3072
    s_mov_b32 s23, 0x20000
    buffer_load_dwordx4 v[208:211], v9, s[20:23], 0 offen offset:0
    buffer_load_dwordx2 v[212:213], v9, s[20:23], 0 offen offset:16
    s_mov_b32 s24, s70
    s_mov_b32 s25, s71
    s_mov_b32 s26, 1280
    s_mov_b32 s27, 0x20000
    v_and_b32 v15, 7, v0
    v_lshlrev_b32 v4, 4, v15
    buffer_load_dwordx4 v[216:219], v4, s[24:27], 0 offen offset:0
    buffer_load_dwordx4 v[220:223], v4, s[24:27], 0 offen offset:128
    buffer_load_dwordx4 v[224:227], v4, s[24:27], 0 offen offset:256
    buffer_load_dwordx4 v[228:231], v4, s[24:27], 0 offen offset:384
    buffer_load_dwordx4 v[232:235], v4, s[24:27], 0 offen offset:512
    buffer_load_dwordx4 v[236:239], v4, s[24:27], 0 offen offset:640
    buffer_load_dwordx4 v[240:243], v4, s[24:27], 0 offen offset:768
    buffer_load_dwordx4 v[244:247], v4, s[24:27], 0 offen offset:896
    buffer_load_dwordx4 v[248:251], v4, s[24:27], 0 offen offset:1024
    buffer_load_dwordx4 v[252:255], v4, s[24:27], 0 offen offset:1152
    s_mov_b32 s4, s74
    s_mov_b32 s5, s75
    s_mov_b32 s6, 256
    s_mov_b32 s7, 0x20000
    v_mov_b32 v202, 8
    buffer_load_dwordx2 v[200:201], v202, s[4:7], 0 offen sc1
    ds_read_b64_tr_b16 v[128:129], v16 offset:0
    ds_read_b64_tr_b16 v[130:131], v17 offset:0
    ds_read_b128 v[132:135], v14 offset:0
    ds_read_b128 v[136:139], v14 offset:10240
    ds_read_b64_tr_b16 v[148:149], v18 offset:0
    ds_read_b64_tr_b16 v[150:151], v19 offset:0
    ds_read_b128 v[152:155], v14 offset:1024
    ds_read_b128 v[156:159], v14 offset:11264
    s_waitcnt lgkmcnt(4)
    v_mfma_f32_32x32x16_bf16 v[64:79], v[128:131], v[132:135], 0
    ds_read_b64_tr_b16 v[168:169], v16 offset:256
    ds_read_b64_tr_b16 v[170:171], v17 offset:256
    v_mfma_f32_32x32x16_bf16 v[80:95], v[128:131], v[136:139], 0
    ds_read_b128 v[172:175], v14 offset:2048
    ds_read_b128 v[176:179], v14 offset:12288
    s_waitcnt lgkmcnt(4)
    v_mfma_f32_32x32x16_bf16 v[64:79], v[148:151], v[152:155], v[64:79]
    ds_read_b64_tr_b16 v[128:129], v18 offset:256
    ds_read_b64_tr_b16 v[130:131], v19 offset:256
    v_mfma_f32_32x32x16_bf16 v[80:95], v[148:151], v[156:159], v[80:95]
    ds_read_b128 v[132:135], v14 offset:3072
    ds_read_b128 v[136:139], v14 offset:13312
    s_waitcnt vmcnt(15)
    s_barrier
    s_waitcnt lgkmcnt(4)
    v_mfma_f32_32x32x16_bf16 v[64:79], v[168:171], v[172:175], v[64:79]
    ds_read_b64_tr_b16 v[148:149], v16 offset:16384
    ds_read_b64_tr_b16 v[150:151], v17 offset:16384
    v_mfma_f32_32x32x16_bf16 v[80:95], v[168:171], v[176:179], v[80:95]
    ds_read_b128 v[152:155], v14 offset:4096
    ds_read_b128 v[156:159], v14 offset:14336
    s_waitcnt lgkmcnt(4)
    v_mfma_f32_32x32x16_bf16 v[64:79], v[128:131], v[132:135], v[64:79]
    ds_read_b64_tr_b16 v[168:169], v18 offset:16384
    ds_read_b64_tr_b16 v[170:171], v19 offset:16384
    v_mfma_f32_32x32x16_bf16 v[80:95], v[128:131], v[136:139], v[80:95]
    ds_read_b128 v[172:175], v14 offset:5120
    ds_read_b128 v[176:179], v14 offset:15360
    s_waitcnt lgkmcnt(4)
    v_mfma_f32_32x32x16_bf16 v[64:79], v[148:151], v[152:155], v[64:79]
    ds_read_b64_tr_b16 v[128:129], v16 offset:16640
    ds_read_b64_tr_b16 v[130:131], v17 offset:16640
    v_mfma_f32_32x32x16_bf16 v[80:95], v[148:151], v[156:159], v[80:95]
    ds_read_b128 v[132:135], v14 offset:6144
    ds_read_b128 v[136:139], v14 offset:16384
    s_waitcnt lgkmcnt(4)
    v_mfma_f32_32x32x16_bf16 v[64:79], v[168:171], v[172:175], v[64:79]
    ds_read_b64_tr_b16 v[148:149], v18 offset:16640
    ds_read_b64_tr_b16 v[150:151], v19 offset:16640
    v_mfma_f32_32x32x16_bf16 v[80:95], v[168:171], v[176:179], v[80:95]
    ds_read_b128 v[152:155], v14 offset:7168
    ds_read_b128 v[156:159], v14 offset:17408
    s_waitcnt vmcnt(0)
    s_barrier
    s_mov_b32 s37, 65536
L_nt_47:
    v_readfirstlane_b32 s78, v200
    v_readfirstlane_b32 s79, v201
    s_sub_u32 s37, s37, 1
    s_cmp_eq_u32 s37, 0
    s_cbranch_scc1 L_ntd_48
    s_cmp_lg_u32 s78, 0
    s_cbranch_scc1 L_ntd_48
    s_sleep 2
    buffer_load_dwordx2 v[200:201], v202, s[4:7], 0 offen sc1
    s_waitcnt vmcnt(0)
    s_branch L_nt_47
L_ntd_48:
    s_mov_b32 s20, s58
    s_mov_b32 s21, s59
    s_mov_b32 s22, 1314816
    s_mov_b32 s23, 0x20000
    s_mov_b32 s24, s60
    s_mov_b32 s25, s61
    s_mov_b32 s26, 1314816
    s_mov_b32 s27, 0x20000
    s_mul_i32 s32, s55, 20544
    s_add_u32 s31, s28, 0
    s_lshl_b32 s33, s31, 10
    s_add_u32 s34, s33, s32
    s_add_u32 m0, s33, 102400
    s_nop 0
    buffer_load_dwordx4 v1, s[20:23], s34 offen lds
    s_add_u32 s31, s28, 8
    s_lshl_b32 s33, s31, 10
    s_add_u32 s34, s33, s32
    s_add_u32 m0, s33, 102400
    s_nop 0
    buffer_load_dwordx4 v1, s[20:23], s34 offen lds
    s_add_u32 s31, s28, 16
    s_cmp_ge_u32 s31, 21
    s_cbranch_scc1 L_wim_56
    s_lshl_b32 s33, s31, 10
    s_add_u32 s34, s33, s32
    s_add_u32 m0, s33, 102400
    s_nop 0
    buffer_load_dwordx4 v1, s[20:23], s34 offen lds
    s_branch L_wdn_57
L_wim_56:
    s_sub_u32 s31, s31, 21
    s_lshl_b32 s33, s31, 10
    s_add_u32 s34, s33, s32
    s_add_u32 m0, s33, 123904
    s_nop 0
    buffer_load_dwordx4 v1, s[24:27], s34 offen lds
L_wdn_57:
    s_add_u32 s31, s28, 24
    s_sub_u32 s31, s31, 21
    s_lshl_b32 s33, s31, 10
    s_add_u32 s34, s33, s32
    s_add_u32 m0, s33, 123904
    s_nop 0
    buffer_load_dwordx4 v1, s[24:27], s34 offen lds
    s_add_u32 s31, s28, 32
    s_sub_u32 s31, s31, 21
    s_lshl_b32 s33, s31, 10
    s_add_u32 s34, s33, s32
    s_add_u32 m0, s33, 123904
    s_nop 0
    buffer_load_dwordx4 v1, s[24:27], s34 offen lds
    s_add_u32 s31, s28, 40
    s_cmp_ge_u32 s31, 42
    s_cbranch_scc1 L_wsk_64
    s_sub_u32 s31, s31, 21
    s_lshl_b32 s33, s31, 10
    s_add_u32 s34, s33, s32
    s_add_u32 m0, s33, 123904
    s_nop 0
    buffer_load_dwordx4 v1, s[24:27], s34 offen lds
L_wsk_64:
    s_waitcnt lgkmcnt(4)
    v_mfma_f32_32x32x16_bf16 v[64:79], v[128:131], v[132:135], v[64:79]
    ds_read_b64_tr_b16 v[168:169], v20 offset:0
    ds_read_b64_tr_b16 v[170:171], v21 offset:0
    v_mfma_f32_32x32x16_bf16 v[80:95], v[128:131], v[136:139], v[80:95]
    ds_read_b128 v[172:175], v14 offset:8192
    ds_read_b128 v[176:179], v14 offset:18432
    s_waitcnt lgkmcnt(4)
    v_mfma_f32_32x32x16_bf16 v[64:79], v[148:151], v[152:155], v[64:79]
    ds_read_b64_tr_b16 v[128:129], v22 offset:0
    ds_read_b64_tr_b16 v[130:131], v23 offset:0
    v_mfma_f32_32x32x16_bf16 v[80:95], v[148:151], v[156:159], v[80:95]
    ds_read_b128 v[132:135], v14 offset:9216
    ds_read_b128 v[136:139], v14 offset:19456
    s_waitcnt lgkmcnt(4)
    v_mfma_f32_32x32x16_bf16 v[64:79], v[168:171], v[172:175], v[64:79]
    v_mfma_f32_32x32x16_bf16 v[80:95], v[168:171], v[176:179], v[80:95]
    s_waitcnt lgkmcnt(0)
    v_mfma_f32_32x32x16_bf16 v[64:79], v[128:131], v[132:135], v[64:79]
    v_mfma_f32_32x32x16_bf16 v[80:95], v[128:131], v[136:139], v[80:95]
    s_barrier
    s_nop 7
    s_nop 3
    v_mov_b32 v192, 1.0
    v_mov_b32 v193, v208
    v_mov_b32 v194, 0
    v_mov_b32 v195, v209
    v_mov_b32 v196, v210
    v_mov_b32 v197, v212
    v_mov_b32 v198, v211
    v_mov_b32 v199, v213
    v_pk_mul_f32 v[32:33], v[64:65], v[192:193]
    v_pk_mul_f32 v[34:35], v[80:81], v[192:193]
    v_pk_mul_f32 v[36:37], v[66:67], v[196:197]
    v_pk_mul_f32 v[38:39], v[82:83], v[196:197]
    v_pk_fma_f32 v[32:33], v[80:81], v[194:195], v[32:33]
    v_pk_fma_f32 v[34:35], v[64:65], v[194:195], v[34:35] neg_lo:[1,0,0] neg_hi:[1,0,0]
    v_pk_fma_f32 v[36:37], v[82:83], v[198:199], v[36:37]
    v_pk_fma_f32 v[38:39], v[66:67], v[198:199], v[38:39] neg_lo:[1,0,0] neg_hi:[1,0,0]
    v_pk_add_f32 v[64:65], v[32:33], v[36:37]
    v_pk_add_f32 v[80:81], v[34:35], v[38:39]
    v_pk_add_f32 v[66:67], v[32:33], v[36:37] neg_lo:[0,1] neg_hi:[0,1]
    v_pk_add_f32 v[82:83], v[34:35], v[38:39] neg_lo:[0,1] neg_hi:[0,1]
    v_pk_add_f32 v[128:129], v[64:65], v[64:65] op_sel:[0,1] op_sel_hi:[0,1] neg_hi:[0,1]
    v_pk_add_f32 v[130:131], v[80:81], v[80:81] op_sel:[0,1] op_sel_hi:[0,1] neg_hi:[1,0]
    v_pk_add_f32 v[132:133], v[66:67], v[82:83] op_sel:[0,1] op_sel_hi:[0,1] neg_hi:[0,1]
    v_pk_add_f32 v[134:135], v[82:83], v[66:67] op_sel:[0,1] op_sel_hi:[0,1] neg_lo:[0,1] neg_hi:[1,1]
    v_pk_mul_f32 v[40:41], v[68:69], v[192:193]
    v_pk_mul_f32 v[42:43], v[84:85], v[192:193]
    v_pk_mul_f32 v[44:45], v[70:71], v[196:197]
    v_pk_mul_f32 v[46:47], v[86:87], v[196:197]
    v_pk_fma_f32 v[40:41], v[84:85], v[194:195], v[40:41]
    v_pk_fma_f32 v[42:43], v[68:69], v[194:195], v[42:43] neg_lo:[1,0,0] neg_hi:[1,0,0]
    v_pk_fma_f32 v[44:45], v[86:87], v[198:199], v[44:45]
    v_pk_fma_f32 v[46:47], v[70:71], v[198:199], v[46:47] neg_lo:[1,0,0] neg_hi:[1,0,0]
    v_pk_add_f32 v[68:69], v[40:41], v[44:45]
    v_pk_add_f32 v[84:85], v[42:43], v[46:47]
    v_pk_add_f32 v[70:71], v[40:41], v[44:45] neg_lo:[0,1] neg_hi:[0,1]
    v_pk_add_f32 v[86:87], v[42:43], v[46:47] neg_lo:[0,1] neg_hi:[0,1]
    v_pk_add_f32 v[136:137], v[68:69], v[68:69] op_sel:[0,1] op_sel_hi:[0,1] neg_hi:[0,1]
    v_pk_add_f32 v[138:139], v[84:85], v[84:85] op_sel:[0,1] op_sel_hi:[0,1] neg_hi:[1,0]
    v_pk_add_f32 v[140:141], v[70:71], v[86:87] op_sel:[0,1] op_sel_hi:[0,1] neg_hi:[0,1]
    v_pk_add_f32 v[142:143], v[86:87], v[70:71] op_sel:[0,1] op_sel_hi:[0,1] neg_lo:[0,1] neg_hi:[1,1]
    v_pk_mul_f32 v[32:33], v[72:73], v[192:193]
    v_pk_mul_f32 v[34:35], v[88:89], v[192:193]
    v_pk_mul_f32 v[36:37], v[74:75], v[196:197]
    v_pk_mul_f32 v[38:39], v[90:91], v[196:197]
    v_pk_fma_f32 v[32:33], v[88:89], v[194:195], v[32:33]
    v_pk_fma_f32 v[34:35], v[72:73], v[194:195], v[34:35] neg_lo:[1,0,0] neg_hi:[1,0,0]
    v_pk_fma_f32 v[36:37], v[90:91], v[198:199], v[36:37]
    v_pk_fma_f32 v[38:39], v[74:75], v[198:199], v[38:39] neg_lo:[1,0,0] neg_hi:[1,0,0]
    v_pk_add_f32 v[72:73], v[32:33], v[36:37]
    v_pk_add_f32 v[88:89], v[34:35], v[38:39]
    v_pk_add_f32 v[74:75], v[32:33], v[36:37] neg_lo:[0,1] neg_hi:[0,1]
    v_pk_add_f32 v[90:91], v[34:35], v[38:39] neg_lo:[0,1] neg_hi:[0,1]
    v_pk_add_f32 v[144:145], v[72:73], v[72:73] op_sel:[0,1] op_sel_hi:[0,1] neg_hi:[0,1]
    v_pk_add_f32 v[146:147], v[88:89], v[88:89] op_sel:[0,1] op_sel_hi:[0,1] neg_hi:[1,0]
    v_pk_add_f32 v[148:149], v[74:75], v[90:91] op_sel:[0,1] op_sel_hi:[0,1] neg_hi:[0,1]
    v_pk_add_f32 v[150:151], v[90:91], v[74:75] op_sel:[0,1] op_sel_hi:[0,1] neg_lo:[0,1] neg_hi:[1,1]
    v_pk_mul_f32 v[40:41], v[76:77], v[192:193]
    v_pk_mul_f32 v[42:43], v[92:93], v[192:193]
    v_pk_mul_f32 v[44:45], v[78:79], v[196:197]
    v_pk_mul_f32 v[46:47], v[94:95], v[196:197]
    v_pk_fma_f32 v[40:41], v[92:93], v[194:195], v[40:41]
    v_pk_fma_f32 v[42:43], v[76:77], v[194:195], v[42:43] neg_lo:[1,0,0] neg_hi:[1,0,0]
    v_pk_fma_f32 v[44:45], v[94:95], v[198:199], v[44:45]
    v_pk_fma_f32 v[46:47], v[78:79], v[198:199], v[46:47] neg_lo:[1,0,0] neg_hi:[1,0,0]
    v_pk_add_f32 v[76:77], v[40:41], v[44:45]
    v_pk_add_f32 v[92:93], v[42:43], v[46:47]
    v_pk_add_f32 v[78:79], v[40:41], v[44:45] neg_lo:[0,1] neg_hi:[0,1]
    v_pk_add_f32 v[94:95], v[42:43], v[46:47] neg_lo:[0,1] neg_hi:[0,1]
    v_pk_add_f32 v[152:153], v[76:77], v[76:77] op_sel:[0,1] op_sel_hi:[0,1] neg_hi:[0,1]
    v_pk_add_f32 v[154:155], v[92:93], v[92:93] op_sel:[0,1] op_sel_hi:[0,1] neg_hi:[1,0]
    v_pk_add_f32 v[156:157], v[78:79], v[94:95] op_sel:[0,1] op_sel_hi:[0,1] neg_hi:[0,1]
    v_pk_add_f32 v[158:159], v[94:95], v[78:79] op_sel:[0,1] op_sel_hi:[0,1] neg_lo:[0,1] neg_hi:[1,1]
    v_cvt_pk_bf16_f32 v48, v128, v136
    v_cvt_pk_bf16_f32 v49, v144, v152
    ds_write_b64 v12, v[48:49] offset:0
    v_cvt_pk_bf16_f32 v50, v130, v138
    v_cvt_pk_bf16_f32 v51, v146, v154
    ds_write_b64 v13, v[50:51] offset:0
    v_cvt_pk_bf16_f32 v52, v132, v140
    v_cvt_pk_bf16_f32 v53, v148, v156
    ds_write_b64 v12, v[52:53] offset:12288
    v_cvt_pk_bf16_f32 v54, v134, v142
    v_cvt_pk_bf16_f32 v55, v150, v158
    ds_write_b64 v13, v[54:55] offset:12288
    v_cvt_pk_bf16_f32 v48, v129, v137
    v_cvt_pk_bf16_f32 v49, v145, v153
    ds_write_b64 v12, v[48:49] offset:24576
    v_cvt_pk_bf16_f32 v50, v131, v139
    v_cvt_pk_bf16_f32 v51, v147, v155
    ds_write_b64 v13, v[50:51] offset:24576
    v_cvt_pk_bf16_f32 v52, v133, v141
    v_cvt_pk_bf16_f32 v53, v149, v157
    ds_write_b64 v12, v[52:53] offset:36864
    v_cvt_pk_bf16_f32 v54, v135, v143
    v_cvt_pk_bf16_f32 v55, v151, v159
    ds_write_b64 v13, v[54:55] offset:36864
    s_waitcnt lgkmcnt(0)
L_p1join_26:
    s_barrier
    s_cmp_ge_u32 s28, 4
    s_cbranch_scc1 L_gatew_67
    s_add_u32 s12, s76, 8388608
    s_addc_u32 s13, s77, 0
    s_mov_b32 s14, 2654208
    s_mov_b32 s15, 0x20000
    s_mul_i32 s31, s28, 12288
    s_add_u32 s31, s31, 40960
    v_lshlrev_b32 v3, 4, v0
    v_add_u32 v3, s31, v3
    ds_read_b128 v[16:19], v3 offset:0
    ds_read_b128 v[20:23], v3 offset:1024
    ds_read_b128 v[24:27], v3 offset:2048
    ds_read_b128 v[28:31], v3 offset:3072
    ds_read_b128 v[32:35], v3 offset:4096
    ds_read_b128 v[36:39], v3 offset:5120
    ds_read_b128 v[40:43], v3 offset:6144
    ds_read_b128 v[44:47], v3 offset:7168
    ds_read_b128 v[48:51], v3 offset:8192
    ds_read_b128 v[52:55], v3 offset:9216
    ds_read_b128 v[56:59], v3 offset:10240
    s_waitcnt lgkmcnt(10)
    buffer_store_dwordx4 v[16:19], v224, s[12:15], 0 offen sc1
    s_waitcnt lgkmcnt(9)
    buffer_store_dwordx4 v[20:23], v225, s[12:15], 0 offen sc1
    s_waitcnt lgkmcnt(8)
    buffer_store_dwordx4 v[24:27], v226, s[12:15], 0 offen sc1
    s_waitcnt lgkmcnt(7)
    buffer_store_dwordx4 v[28:31], v227, s[12:15], 0 offen sc1
    s_waitcnt lgkmcnt(6)
    buffer_store_dwordx4 v[32:35], v228, s[12:15], 0 offen sc1
    s_waitcnt lgkmcnt(5)
    buffer_store_dwordx4 v[36:39], v229, s[12:15], 0 offen sc1
    s_waitcnt lgkmcnt(4)
    buffer_store_dwordx4 v[40:43], v230, s[12:15], 0 offen sc1
    s_waitcnt lgkmcnt(3)
    buffer_store_dwordx4 v[44:47], v231, s[12:15], 0 offen sc1
    s_waitcnt lgkmcnt(2)
    buffer_store_dwordx4 v[48:51], v232, s[12:15], 0 offen sc1
    s_waitcnt lgkmcnt(1)
    buffer_store_dwordx4 v[52:55], v233, s[12:15], 0 offen sc1
    s_waitcnt lgkmcnt(0)
    buffer_store_dwordx4 v[56:59], v234, s[12:15], 0 offen sc1
    s_waitcnt vmcnt(11)
    s_branch L_j4_68
L_gatew_67:
    s_add_u32 s24, s76, 25165824
    s_addc_u32 s25, s77, 0
    s_mov_b32 s26, 16384
    s_mov_b32 s27, 0x20000
    v_lshrrev_b32 v8, 3, v0
    s_lshl_b32 s32, s30, 3
    v_add_u32 v8, s32, v8
    v_and_b32 v15, 7, v0
    v_and_b32 v5, 7, v8
    v_lshlrev_b32 v6, 1, v5
    v_xor_b32 v9, v15, v6
    v_lshlrev_b32 v9, 4, v9
    v_lshl_add_u32 v10, v8, 9, v9
    v_xor_b32 v11, 128, v10
    v_lshl_add_u32 v16, v8, 8, v9
    v_add_u32 v16, 32768, v16
    v_xor_b32 v17, 128, v16
    ds_read_b128 v[64:67], v10 offset:0
    ds_read_b128 v[68:71], v11 offset:0
    ds_read_b128 v[72:75], v10 offset:256
    ds_read_b128 v[76:79], v11 offset:256
    ds_read_b128 v[80:83], v10 offset:16384
    ds_read_b128 v[84:87], v11 offset:16384
    ds_read_b128 v[88:91], v10 offset:16640
    ds_read_b128 v[92:95], v11 offset:16640
    ds_read_b128 v[96:99], v16 offset:0
    ds_read_b128 v[100:103], v17 offset:0
    v_and_b32 v6, 24, v8
    v_and_b32 v7, 1, v8
    v_lshl_add_u32 v6, v7, 2, v6
    v_bfe_u32 v7, v8, 1, 2
    v_add_u32 v6, v6, v7
    v_lshlrev_b32 v6, 6, v6
    v_add_u32 v8, s55, v6
    v_mov_b32 v5, 0
    v_mov_b32 v6, 0
    s_waitcnt lgkmcnt(0)
    v_dot2_f32_bf16 v5, v64, v216, v5
    v_dot2_f32_bf16 v6, v65, v217, v6
    v_dot2_f32_bf16 v5, v66, v218, v5
    v_dot2_f32_bf16 v6, v67, v219, v6
    v_dot2_f32_bf16 v5, v68, v220, v5
    v_dot2_f32_bf16 v6, v69, v221, v6
    v_dot2_f32_bf16 v5, v70, v222, v5
    v_dot2_f32_bf16 v6, v71, v223, v6
    v_dot2_f32_bf16 v5, v72, v224, v5
    v_dot2_f32_bf16 v6, v73, v225, v6
    v_dot2_f32_bf16 v5, v74, v226, v5
    v_dot2_f32_bf16 v6, v75, v227, v6
    v_dot2_f32_bf16 v5, v76, v228, v5
    v_dot2_f32_bf16 v6, v77, v229, v6
    v_dot2_f32_bf16 v5, v78, v230, v5
    v_dot2_f32_bf16 v6, v79, v231, v6
    v_dot2_f32_bf16 v5, v80, v232, v5
    v_dot2_f32_bf16 v6, v81, v233, v6
    v_dot2_f32_bf16 v5, v82, v234, v5
    v_dot2_f32_bf16 v6, v83, v235, v6
    v_dot2_f32_bf16 v5, v84, v236, v5
    v_dot2_f32_bf16 v6, v85, v237, v6
    v_dot2_f32_bf16 v5, v86, v238, v5
    v_dot2_f32_bf16 v6, v87, v239, v6
    v_dot2_f32_bf16 v5, v88, v240, v5
    v_dot2_f32_bf16 v6, v89, v241, v6
    v_dot2_f32_bf16 v5, v90, v242, v5
    v_dot2_f32_bf16 v6, v91, v243, v6
    v_dot2_f32_bf16 v5, v92, v244, v5
    v_dot2_f32_bf16 v6, v93, v245, v6
    v_dot2_f32_bf16 v5, v94, v246, v5
    v_dot2_f32_bf16 v6, v95, v247, v6
    v_dot2_f32_bf16 v5, v96, v248, v5
    v_dot2_f32_bf16 v6, v97, v249, v6
    v_dot2_f32_bf16 v5, v98, v250, v5
    v_dot2_f32_bf16 v6, v99, v251, v6
    v_dot2_f32_bf16 v5, v100, v252, v5
    v_dot2_f32_bf16 v6, v101, v253, v6
    v_dot2_f32_bf16 v5, v102, v254, v5
    v_dot2_f32_bf16 v6, v103, v255, v6
    s_nop 2
    v_add_f32 v5, v5, v6
    s_nop 1
    v_add_f32_dpp v5, v5, v5 quad_perm:[1,0,3,2] row_mask:0xf bank_mask:0xf
    s_nop 1
    v_add_f32_dpp v5, v5, v5 quad_perm:[2,3,0,1] row_mask:0xf bank_mask:0xf
    s_nop 1
    v_add_f32_dpp v5, v5, v5 row_half_mirror row_mask:0xf bank_mask:0xf
    v_mul_f32 v5, 0xbfb8aa3b, v5
    v_exp_f32 v5, v5
    s_nop 0
    v_add_f32 v5, 1.0, v5
    v_rcp_f32 v5, v5
    s_nop 0
    v_sub_f32 v7, 1.0, v5
    v_mul_f32 v6, 0x354ccccd, v5
    v_lshlrev_b32 v2, 3, v8
    v_cmp_eq_u32 vcc, 0, v15
    s_and_saveexec_b64 s[36:37], vcc
    buffer_store_dwordx2 v[6:7], v2, s[24:27], 0 offen sc1
    s_mov_b64 exec, s[36:37]
    s_waitcnt vmcnt(1)
L_j4_68:
    s_barrier
    s_add_u32 s16, s76, 16777216
    s_addc_u32 s17, s77, 0
    s_mov_b32 s18, 2629632
    s_mov_b32 s19, 0x20000
    v_and_b32 v2, 7, v0
    v_lshrrev_b32 v3, 3, v0
    v_mul_u32_u24 v4, 2568, v2
    v_lshl_add_u32 v4, v3, 1, v4
    s_lshl_b32 s29, s28, 4
    s_add_u32 s29, s29, 102400
    v_add_u32 v4, s29, v4
    s_and_b32 s30, s55, 1
    s_lshl_b32 s30, s30, 12
    s_lshr_b32 s31, s55, 1
    s_lshl_b32 s31, s31, 7
    s_add_u32 s30, s30, s31
    s_lshl_b32 s31, s28, 16
    s_add_u32 s30, s30, s31
    v_lshlrev_b32 v5, 13, v3
    v_lshl_add_u32 v5, v2, 4, v5
    v_add_u32 v5, s30, v5
    ds_read_u16 v64, v4 offset:0
    ds_read_u16 v65, v4 offset:21504
    ds_read_u16 v66, v4 offset:642
    ds_read_u16 v67, v4 offset:22146
    ds_read_u16 v68, v4 offset:1284
    ds_read_u16 v69, v4 offset:22788
    ds_read_u16 v70, v4 offset:1926
    ds_read_u16 v71, v4 offset:23430
    ds_read_u16 v72, v4 offset:128
    ds_read_u16 v73, v4 offset:21632
    ds_read_u16 v74, v4 offset:770
    ds_read_u16 v75, v4 offset:22274
    ds_read_u16 v76, v4 offset:1412
    ds_read_u16 v77, v4 offset:22916
    ds_read_u16 v78, v4 offset:2054
    ds_read_u16 v79, v4 offset:23558
    s_waitcnt lgkmcnt(8)
    v_lshl_or_b32 v80, v65, 16, v64
    v_lshl_or_b32 v81, v67, 16, v66
    v_lshl_or_b32 v82, v69, 16, v68
    v_lshl_or_b32 v83, v71, 16, v70
    s_mov_b32 s31, 0
    buffer_store_dwordx4 v[80:83], v5, s[16:19], s31 offen sc1
    ds_read_u16 v64, v4 offset:256
    ds_read_u16 v65, v4 offset:21760
    ds_read_u16 v66, v4 offset:898
    ds_read_u16 v67, v4 offset:22402
    ds_read_u16 v68, v4 offset:1540
    ds_read_u16 v69, v4 offset:23044
    ds_read_u16 v70, v4 offset:2182
    ds_read_u16 v71, v4 offset:23686
    s_waitcnt lgkmcnt(8)
    v_lshl_or_b32 v84, v73, 16, v72
    v_lshl_or_b32 v85, v75, 16, v74
    v_lshl_or_b32 v86, v77, 16, v76
    v_lshl_or_b32 v87, v79, 16, v78
    s_mov_b32 s31, 524288
    buffer_store_dwordx4 v[84:87], v5, s[16:19], s31 offen sc1
    ds_read_u16 v72, v4 offset:384
    ds_read_u16 v73, v4 offset:21888
    ds_read_u16 v74, v4 offset:1026
    ds_read_u16 v75, v4 offset:22530
    ds_read_u16 v76, v4 offset:1668
    ds_read_u16 v77, v4 offset:23172
    ds_read_u16 v78, v4 offset:2310
    ds_read_u16 v79, v4 offset:23814
    s_waitcnt lgkmcnt(8)
    v_lshl_or_b32 v80, v65, 16, v64
    v_lshl_or_b32 v81, v67, 16, v66
    v_lshl_or_b32 v82, v69, 16, v68
    v_lshl_or_b32 v83, v71, 16, v70
    s_mov_b32 s31, 1048576
    buffer_store_dwordx4 v[80:83], v5, s[16:19], s31 offen sc1
    ds_read_u16 v64, v4 offset:512
    ds_read_u16 v65, v4 offset:22016
    ds_read_u16 v66, v4 offset:1154
    ds_read_u16 v67, v4 offset:22658
    ds_read_u16 v68, v4 offset:1796
    ds_read_u16 v69, v4 offset:23300
    ds_read_u16 v70, v4 offset:2438
    ds_read_u16 v71, v4 offset:23942
    s_waitcnt lgkmcnt(8)
    v_lshl_or_b32 v84, v73, 16, v72
    v_lshl_or_b32 v85, v75, 16, v74
    v_lshl_or_b32 v86, v77, 16, v76
    v_lshl_or_b32 v87, v79, 16, v78
    s_mov_b32 s31, 1572864
    buffer_store_dwordx4 v[84:87], v5, s[16:19], s31 offen sc1
    s_waitcnt lgkmcnt(0)
    v_lshl_or_b32 v80, v65, 16, v64
    v_lshl_or_b32 v81, v67, 16, v66
    v_lshl_or_b32 v82, v69, 16, v68
    v_lshl_or_b32 v83, v71, 16, v70
    s_mov_b32 s31, 2097152
    buffer_store_dwordx4 v[80:83], v5, s[16:19], s31 offen sc1
    s_cmp_ge_u32 s28, 1
    s_cbranch_scc1 L_wsk_69
    ds_read_u16 v72, v4 offset:640
    ds_read_u16 v73, v4 offset:22144
    ds_read_u16 v74, v4 offset:1282
    ds_read_u16 v75, v4 offset:22786
    ds_read_u16 v76, v4 offset:1924
    ds_read_u16 v77, v4 offset:23428
    ds_read_u16 v78, v4 offset:2566
    ds_read_u16 v79, v4 offset:24070
    s_waitcnt lgkmcnt(0)
    v_lshl_or_b32 v84, v73, 16, v72
    v_lshl_or_b32 v85, v75, 16, v74
    v_lshl_or_b32 v86, v77, 16, v76
    v_lshl_or_b32 v87, v79, 16, v78
    s_mov_b32 s31, 2621440
    buffer_store_dwordx4 v[84:87], v5, s[16:19], s31 offen sc1
L_wsk_69:
    s_cmp_ge_u32 s28, 4
    s_cbranch_scc1 L_hiw_70
    s_waitcnt vmcnt(5)
    s_lshl_b32 s52, s55, 3
    s_add_u32 s52, s52, 8192
    v_mov_b32 v104, 147460
    v_mov_b32 v105, 1
    s_mov_b64 s[36:37], exec
    s_mov_b64 exec, 1
    ds_add_rtn_u32 v106, v104, v105
    s_mov_b64 exec, s[36:37]
    s_waitcnt lgkmcnt(0)
    v_readfirstlane_b32 s36, v106
    s_nop 3
    s_cmp_lg_u32 s36, 3
    s_cbranch_scc1 L_arr_71
    s_add_u32 s12, s76, 29360128
    s_addc_u32 s13, s77, 0
    s_mov_b32 s14, 16384
    s_mov_b32 s15, 0x20000
    v_mov_b32 v104, s78
    v_mov_b32 v105, s79
    v_mov_b32 v106, s52
    s_mov_b64 s[36:37], exec
    s_mov_b64 exec, 1
    buffer_store_dwordx2 v[104:105], v106, s[12:15], 0 offen sc1
    s_mov_b64 exec, s[36:37]
L_arr_71:
L_hiw_70:
    s_barrier
    s_cmp_lt_u32 s55, 41
    s_cbranch_scc1 L_p2_72
    s_waitcnt vmcnt(0)
    s_lshl_b32 s52, s55, 3
    s_add_u32 s52, s52, 11264
    v_mov_b32 v104, 147472
    v_mov_b32 v105, 1
    s_mov_b64 s[36:37], exec
    s_mov_b64 exec, 1
    ds_add_rtn_u32 v106, v104, v105
    s_mov_b64 exec, s[36:37]
    s_waitcnt lgkmcnt(0)
    v_readfirstlane_b32 s36, v106
    s_nop 3
    s_cmp_lg_u32 s36, 7
    s_cbranch_scc1 L_arr_73
    s_add_u32 s12, s76, 29360128
    s_addc_u32 s13, s77, 0
    s_mov_b32 s14, 16384
    s_mov_b32 s15, 0x20000
    v_mov_b32 v104, s78
    v_mov_b32 v105, s79
    v_mov_b32 v106, s52
    s_mov_b64 s[36:37], exec
    s_mov_b64 exec, 1
    buffer_store_dwordx2 v[104:105], v106, s[12:15], 0 offen sc1
    s_mov_b64 exec, s[36:37]
L_arr_73:
    v_mbcnt_lo_u32_b32 v0, -1, 0
    v_mbcnt_hi_u32_b32 v0, -1, v0
    s_mov_b32 s4, s68
    s_mov_b32 s5, s69
    s_mov_b32 s6, 1966080
    s_mov_b32 s7, 0x20000
    s_add_u32 s8, s76, 20971520
    s_addc_u32 s9, s77, 0
    s_mov_b32 s10, 1966080
    s_mov_b32 s11, 0x20000
    s_sub_u32 s29, s55, 41
    s_lshl_b32 s29, s29, 3
    s_add_u32 s29, s29, s28
    s_mul_i32 s30, s29, 10240
    s_mul_i32 s31, s29, 1280
    v_add_u32 v2, 0, v0
    v_mul_u32_u24 v3, 0x334, v2
    v_lshrrev_b32 v3, 16, v3
    v_mul_u32_u24 v4, 80, v3
    v_sub_u32 v4, v2, v4
    v_mul_u32_u24 v5, 0x19a, v4
    v_lshrrev_b32 v5, 12, v5
    v_mul_u32_u24 v6, 10, v5
    v_sub_u32 v6, v4, v6
    v_mul_u32_u24 v5, 1280, v5
    v_mul_u32_u24 v7, 10, v3
    v_add_u32 v6, v6, v7
    v_lshl_add_u32 v16, v6, 4, v5
    buffer_load_dwordx4 v[64:67], v16, s[4:7], s30 offen
    v_mul_u32_u24 v3, 245760, v3
    v_lshl_add_u32 v32, v4, 4, v3
    v_add_u32 v2, 64, v0
    v_mul_u32_u24 v3, 0x334, v2
    v_lshrrev_b32 v3, 16, v3
    v_mul_u32_u24 v4, 80, v3
    v_sub_u32 v4, v2, v4
    v_mul_u32_u24 v5, 0x19a, v4
    v_lshrrev_b32 v5, 12, v5
    v_mul_u32_u24 v6, 10, v5
    v_sub_u32 v6, v4, v6
    v_mul_u32_u24 v5, 1280, v5
    v_mul_u32_u24 v7, 10, v3
    v_add_u32 v6, v6, v7
    v_lshl_add_u32 v17, v6, 4, v5
    buffer_load_dwordx4 v[68:71], v17, s[4:7], s30 offen
    v_mul_u32_u24 v3, 245760, v3
    v_lshl_add_u32 v33, v4, 4, v3
    v_add_u32 v2, 128, v0
    v_mul_u32_u24 v3, 0x334, v2
    v_lshrrev_b32 v3, 16, v3
    v_mul_u32_u24 v4, 80, v3
    v_sub_u32 v4, v2, v4
    v_mul_u32_u24 v5, 0x19a, v4
    v_lshrrev_b32 v5, 12, v5
    v_mul_u32_u24 v6, 10, v5
    v_sub_u32 v6, v4, v6
    v_mul_u32_u24 v5, 1280, v5
    v_mul_u32_u24 v7, 10, v3
    v_add_u32 v6, v6, v7
    v_lshl_add_u32 v18, v6, 4, v5
    buffer_load_dwordx4 v[72:75], v18, s[4:7], s30 offen
    v_mul_u32_u24 v3, 245760, v3
    v_lshl_add_u32 v34, v4, 4, v3
    v_add_u32 v2, 192, v0
    v_mul_u32_u24 v3, 0x334, v2
    v_lshrrev_b32 v3, 16, v3
    v_mul_u32_u24 v4, 80, v3
    v_sub_u32 v4, v2, v4
    v_mul_u32_u24 v5, 0x19a, v4
    v_lshrrev_b32 v5, 12, v5
    v_mul_u32_u24 v6, 10, v5
    v_sub_u32 v6, v4, v6
    v_mul_u32_u24 v5, 1280, v5
    v_mul_u32_u24 v7, 10, v3
    v_add_u32 v6, v6, v7
    v_lshl_add_u32 v19, v6, 4, v5
    buffer_load_dwordx4 v[76:79], v19, s[4:7], s30 offen
    v_mul_u32_u24 v3, 245760, v3
    v_lshl_add_u32 v35, v4, 4, v3
    v_add_u32 v2, 256, v0
    v_mul_u32_u24 v3, 0x334, v2
    v_lshrrev_b32 v3, 16, v3
    v_mul_u32_u24 v4, 80, v3
    v_sub_u32 v4, v2, v4
    v_mul_u32_u24 v5, 0x19a, v4
    v_lshrrev_b32 v5, 12, v5
    v_mul_u32_u24 v6, 10, v5
    v_sub_u32 v6, v4, v6
    v_mul_u32_u24 v5, 1280, v5
    v_mul_u32_u24 v7, 10, v3
    v_add_u32 v6, v6, v7
    v_lshl_add_u32 v20, v6, 4, v5
    buffer_load_dwordx4 v[80:83], v20, s[4:7], s30 offen
    v_mul_u32_u24 v3, 245760, v3
    v_lshl_add_u32 v36, v4, 4, v3
    v_add_u32 v2, 320, v0
    v_mul_u32_u24 v3, 0x334, v2
    v_lshrrev_b32 v3, 16, v3
    v_mul_u32_u24 v4, 80, v3
    v_sub_u32 v4, v2, v4
    v_mul_u32_u24 v5, 0x19a, v4
    v_lshrrev_b32 v5, 12, v5
    v_mul_u32_u24 v6, 10, v5
    v_sub_u32 v6, v4, v6
    v_mul_u32_u24 v5, 1280, v5
    v_mul_u32_u24 v7, 10, v3
    v_add_u32 v6, v6, v7
    v_lshl_add_u32 v21, v6, 4, v5
    buffer_load_dwordx4 v[84:87], v21, s[4:7], s30 offen
    v_mul_u32_u24 v3, 245760, v3
    v_lshl_add_u32 v37, v4, 4, v3
    v_add_u32 v2, 384, v0
    v_mul_u32_u24 v3, 0x334, v2
    v_lshrrev_b32 v3, 16, v3
    v_mul_u32_u24 v4, 80, v3
    v_sub_u32 v4, v2, v4
    v_mul_u32_u24 v5, 0x19a, v4
    v_lshrrev_b32 v5, 12, v5
    v_mul_u32_u24 v6, 10, v5
    v_sub_u32 v6, v4, v6
    v_mul_u32_u24 v5, 1280, v5
    v_mul_u32_u24 v7, 10, v3
    v_add_u32 v6, v6, v7
    v_lshl_add_u32 v22, v6, 4, v5
    buffer_load_dwordx4 v[88:91], v22, s[4:7], s30 offen
    v_mul_u32_u24 v3, 245760, v3
    v_lshl_add_u32 v38, v4, 4, v3
    v_add_u32 v2, 448, v0
    v_mul_u32_u24 v3, 0x334, v2
    v_lshrrev_b32 v3, 16, v3
    v_mul_u32_u24 v4, 80, v3
    v_sub_u32 v4, v2, v4
    v_mul_u32_u24 v5, 0x19a, v4
    v_lshrrev_b32 v5, 12, v5
    v_mul_u32_u24 v6, 10, v5
    v_sub_u32 v6, v4, v6
    v_mul_u32_u24 v5, 1280, v5
    v_mul_u32_u24 v7, 10, v3
    v_add_u32 v6, v6, v7
    v_lshl_add_u32 v23, v6, 4, v5
    buffer_load_dwordx4 v[92:95], v23, s[4:7], s30 offen
    v_mul_u32_u24 v3, 245760, v3
    v_lshl_add_u32 v39, v4, 4, v3
    v_add_u32 v2, 512, v0
    v_mul_u32_u24 v3, 0x334, v2
    v_lshrrev_b32 v3, 16, v3
    v_mul_u32_u24 v4, 80, v3
    v_sub_u32 v4, v2, v4
    v_mul_u32_u24 v5, 0x19a, v4
    v_lshrrev_b32 v5, 12, v5
    v_mul_u32_u24 v6, 10, v5
    v_sub_u32 v6, v4, v6
    v_mul_u32_u24 v5, 1280, v5
    v_mul_u32_u24 v7, 10, v3
    v_add_u32 v6, v6, v7
    v_lshl_add_u32 v24, v6, 4, v5
    buffer_load_dwordx4 v[96:99], v24, s[4:7], s30 offen
    v_mul_u32_u24 v3, 245760, v3
    v_lshl_add_u32 v40, v4, 4, v3
    v_add_u32 v2, 576, v0
    v_mul_u32_u24 v3, 0x334, v2
    v_lshrrev_b32 v3, 16, v3
    v_mul_u32_u24 v4, 80, v3
    v_sub_u32 v4, v2, v4
    v_mul_u32_u24 v5, 0x19a, v4
    v_lshrrev_b32 v5, 12, v5
    v_mul_u32_u24 v6, 10, v5
    v_sub_u32 v6, v4, v6
    v_mul_u32_u24 v5, 1280, v5
    v_mul_u32_u24 v7, 10, v3
    v_add_u32 v6, v6, v7
    v_lshl_add_u32 v25, v6, 4, v5
    buffer_load_dwordx4 v[100:103], v25, s[4:7], s30 offen
    v_mul_u32_u24 v3, 245760, v3
    v_lshl_add_u32 v41, v4, 4, v3
    s_sub_u32 s32, s55, 41
    s_cmp_lt_u32 s32, 8
    s_cselect_b32 s33, 1, 0
    s_cmp_eq_u32 s28, 7
    s_cselect_b32 s33, s33, 0
    s_cmp_eq_u32 s33, 0
    s_cbranch_scc1 L_wskip_74
    s_add_u32 s32, s32, 184
    s_mul_i32 s34, s32, 10240
    s_mul_i32 s35, s32, 1280
    buffer_load_dwordx4 v[104:107], v16, s[4:7], s34 offen
    buffer_load_dwordx4 v[108:111], v17, s[4:7], s34 offen
    buffer_load_dwordx4 v[112:115], v18, s[4:7], s34 offen
    buffer_load_dwordx4 v[116:119], v19, s[4:7], s34 offen
    buffer_load_dwordx4 v[120:123], v20, s[4:7], s34 offen
    buffer_load_dwordx4 v[124:127], v21, s[4:7], s34 offen
    buffer_load_dwordx4 v[128:131], v22, s[4:7], s34 offen
    buffer_load_dwordx4 v[132:135], v23, s[4:7], s34 offen
    buffer_load_dwordx4 v[136:139], v24, s[4:7], s34 offen
    buffer_load_dwordx4 v[140:143], v25, s[4:7], s34 offen
    s_waitcnt vmcnt(0)
    buffer_store_dwordx4 v[104:107], v32, s[8:11], s35 offen sc1
    buffer_store_dwordx4 v[108:111], v33, s[8:11], s35 offen sc1
    buffer_store_dwordx4 v[112:115], v34, s[8:11], s35 offen sc1
    buffer_store_dwordx4 v[116:119], v35, s[8:11], s35 offen sc1
    buffer_store_dwordx4 v[120:123], v36, s[8:11], s35 offen sc1
    buffer_store_dwordx4 v[124:127], v37, s[8:11], s35 offen sc1
    buffer_store_dwordx4 v[128:131], v38, s[8:11], s35 offen sc1
    buffer_store_dwordx4 v[132:135], v39, s[8:11], s35 offen sc1
    buffer_store_dwordx4 v[136:139], v40, s[8:11], s35 offen sc1
    buffer_store_dwordx4 v[140:143], v41, s[8:11], s35 offen sc1
L_wskip_74:
    s_waitcnt vmcnt(0)
    buffer_store_dwordx4 v[64:67], v32, s[8:11], s31 offen sc1
    buffer_store_dwordx4 v[68:71], v33, s[8:11], s31 offen sc1
    buffer_store_dwordx4 v[72:75], v34, s[8:11], s31 offen sc1
    buffer_store_dwordx4 v[76:79], v35, s[8:11], s31 offen sc1
    buffer_store_dwordx4 v[80:83], v36, s[8:11], s31 offen sc1
    buffer_store_dwordx4 v[84:87], v37, s[8:11], s31 offen sc1
    buffer_store_dwordx4 v[88:91], v38, s[8:11], s31 offen sc1
    buffer_store_dwordx4 v[92:95], v39, s[8:11], s31 offen sc1
    buffer_store_dwordx4 v[96:99], v40, s[8:11], s31 offen sc1
    buffer_store_dwordx4 v[100:103], v41, s[8:11], s31 offen sc1
    s_waitcnt vmcnt(0)
    s_sub_u32 s52, s55, 41
    s_lshl_b32 s52, s52, 3
    s_add_u32 s52, s52, 10240
    v_mov_b32 v104, 147468
    v_mov_b32 v105, 1
    s_mov_b64 s[36:37], exec
    s_mov_b64 exec, 1
    ds_add_rtn_u32 v106, v104, v105
    s_mov_b64 exec, s[36:37]
    s_waitcnt lgkmcnt(0)
    v_readfirstlane_b32 s36, v106
    s_nop 3
    s_cmp_lg_u32 s36, 7
    s_cbranch_scc1 L_arr_75
    s_add_u32 s12, s76, 29360128
    s_addc_u32 s13, s77, 0
    s_mov_b32 s14, 16384
    s_mov_b32 s15, 0x20000
    v_mov_b32 v104, s78
    v_mov_b32 v105, s79
    v_mov_b32 v106, s52
    s_mov_b64 s[36:37], exec
    s_mov_b64 exec, 1
    buffer_store_dwordx2 v[104:105], v106, s[12:15], 0 offen sc1
    s_mov_b64 exec, s[36:37]
L_arr_75:
    s_barrier
    s_branch L_final_3
L_p2_72:
    v_mbcnt_lo_u32_b32 v0, -1, 0
    v_mbcnt_hi_u32_b32 v0, -1, v0
    s_getpc_b64 s[6:7]
    s_add_u32 s6, s6, tbl_p2@rel32@lo+4
    s_addc_u32 s7, s7, tbl_p2@rel32@hi+12
    s_mov_b32 s12, s6
    s_mov_b32 s13, s7
    s_mov_b32 s14, 43008
    s_mov_b32 s15, 0x20000
    v_lshlrev_b32 v1, 4, v0
    s_lshl_b32 s29, s28, 10
    s_add_u32 s30, s29, 0
    s_add_u32 m0, s30, 0
    s_nop 0
    buffer_load_dwordx4 v1, s[12:15], s30 offen lds
    s_add_u32 s30, s29, 8192
    s_add_u32 m0, s30, 0
    s_nop 0
    buffer_load_dwordx4 v1, s[12:15], s30 offen lds
    s_add_u32 s30, s29, 16384
    s_add_u32 m0, s30, 0
    s_nop 0
    buffer_load_dwordx4 v1, s[12:15], s30 offen lds
    s_add_u32 s30, s29, 24576
    s_add_u32 m0, s30, 0
    s_nop 0
    buffer_load_dwordx4 v1, s[12:15], s30 offen lds
    s_add_u32 s30, s29, 32768
    s_add_u32 m0, s30, 0
    s_nop 0
    buffer_load_dwordx4 v1, s[12:15], s30 offen lds
    s_add_u32 s30, s29, 40960
    s_add_u32 m0, s30, 0
    s_cmp_ge_u32 s28, 2
    s_cbranch_scc1 L_skip_76
    buffer_load_dwordx4 v1, s[12:15], s30 offen lds
L_skip_76:
    s_lshr_b32 s41, s28, 2
    s_and_b32 s42, s28, 3
    s_lshl_b32 s40, s55, 1
    s_add_u32 s40, s40, s41
    s_min_u32 s40, s40, 80
    v_mbcnt_lo_u32_b32 v255, -1, 0
    v_mbcnt_hi_u32_b32 v255, -1, v255
    s_add_u32 s16, s76, 8388608
    s_addc_u32 s17, s77, 0
    s_mov_b32 s18, 2654208
    s_mov_b32 s19, 0x20000
    s_add_u32 s20, s76, 12582912
    s_addc_u32 s21, s77, 0
    s_mov_b32 s22, 2703360
    s_mov_b32 s23, 0x20000
    s_add_u32 s24, s76, 16777216
    s_addc_u32 s25, s77, 0
    s_mov_b32 s26, 2629632
    s_mov_b32 s27, 0x20000
    s_mul_i32 s50, s42, 81
    s_add_u32 s50, s50, s40
    s_lshl_b32 s50, s50, 13
    s_lshl_b32 s51, s28, 13
    s_add_u32 s51, s51, 43008
    s_sub_u32 s33, 320, s40
    s_sub_u32 s34, 160, s40
    s_add_u32 s32, s40, 160
    s_cmp_eq_u32 s42, 0
    s_cselect_b32 s32, s40, s32
    s_cmp_eq_u32 s42, 2
    s_cselect_b32 s32, s33, s32
    s_cmp_eq_u32 s42, 3
    s_cselect_b32 s32, s34, s32
    s_lshl_b32 s32, s32, 13
    v_and_b32 v240, 31, v255
    v_lshlrev_b32 v240, 2, v240
    v_lshrrev_b32 v241, 5, v255
    v_lshlrev_b32 v241, 9, v241
    v_add3_u32 v245, v240, v241, s32
    v_add_u32 v254, 4096, v245
    s_getpc_b64 s[12:13]
    s_add_u32 s12, s12, tbl_tw640@rel32@lo+4
    s_addc_u32 s13, s13, tbl_tw640@rel32@hi+12
    s_lshl_b32 s32, s40, 5
    s_add_u32 s12, s12, s32
    s_addc_u32 s13, s13, 0
    s_load_dwordx4 s[44:47], s[12:13], 0
    s_load_dwordx2 s[48:49], s[12:13], 16
    v_and_b32 v240, 31, v255
    v_lshrrev_b32 v241, 1, v240
    v_and_b32 v241, 7, v241
    v_lshrrev_b32 v242, 5, v255
    v_xor_b32 v241, v241, v242
    v_lshlrev_b32 v240, 7, v240
    v_add_u32 v240, s51, v240
    v_xor_b32 v242, 0, v241
    v_lshl_add_u32 v246, v242, 4, v240
    v_xor_b32 v242, 2, v241
    v_lshl_add_u32 v247, v242, 4, v240
    v_xor_b32 v242, 4, v241
    v_lshl_add_u32 v248, v242, 4, v240
    v_xor_b32 v242, 6, v241
    v_lshl_add_u32 v249, v242, 4, v240
    v_lshlrev_b32 v244, 4, v255
    s_waitcnt lgkmcnt(0)
    s_waitcnt vmcnt(5)
    s_lshl_b32 s52, s55, 3
    s_add_u32 s52, s52, 11264
    v_mov_b32 v104, 147472
    v_mov_b32 v105, 1
    s_mov_b64 s[36:37], exec
    s_mov_b64 exec, 1
    ds_add_rtn_u32 v106, v104, v105
    s_mov_b64 exec, s[36:37]
    s_waitcnt lgkmcnt(0)
    v_readfirstlane_b32 s36, v106
    s_nop 3
    s_cmp_lg_u32 s36, 7
    s_cbranch_scc1 L_arr_77
    s_add_u32 s12, s76, 29360128
    s_addc_u32 s13, s77, 0
    s_mov_b32 s14, 16384
    s_mov_b32 s15, 0x20000
    v_mov_b32 v104, s78
    v_mov_b32 v105, s79
    v_mov_b32 v106, s52
    s_mov_b64 s[36:37], exec
    s_mov_b64 exec, 1
    buffer_store_dwordx2 v[104:105], v106, s[12:15], 0 offen sc1
    s_mov_b64 exec, s[36:37]
L_arr_77:
    s_cmp_lg_u32 s28, 0
    s_cbranch_scc1 L_nopoll_78
    s_add_u32 s12, s76, 29360128
    s_addc_u32 s13, s77, 0
    s_mov_b32 s14, 16384
    s_mov_b32 s15, 0x20000
    v_lshlrev_b32 v2, 3, v255
    v_add_u32 v2, 8192, v2
    s_mov_b64 s[4:5], -1
    s_mov_b32 s8, 65536
L_wf_79:
    buffer_load_dwordx2 v[4:5], v2, s[12:15], 0 offen sc1
    s_waitcnt vmcnt(0)
    v_cmp_eq_u32 vcc, s78, v4
    v_cmp_eq_u32 s[6:7], s79, v5
    s_nop 3
    s_and_b64 vcc, vcc, s[6:7]
    s_and_b64 vcc, vcc, s[4:5]
    s_cmp_eq_u64 vcc, s[4:5]
    s_cbranch_scc1 L_wfd_80
    s_sleep 1
    s_sub_u32 s8, s8, 1
    s_cmp_lg_u32 s8, 0
    s_cbranch_scc1 L_wf_79
L_wfd_80:
    s_waitcnt vmcnt(0)
L_nopoll_78:
    s_waitcnt vmcnt(0)
    s_barrier
    s_cmp_lt_u32 s28, 4
    s_cbranch_scc1 L_prio_81
    s_setprio 1
L_prio_81:
    s_mov_b32 m0, s51
    s_add_u32 s33, s50, 4096
    buffer_load_dwordx4 v244, s[16:19], s50 offen offset:0 sc1 lds
    buffer_load_dwordx4 v244, s[16:19], s50 offen offset:1024 sc1 lds
    buffer_load_dwordx4 v244, s[16:19], s50 offen offset:2048 sc1 lds
    buffer_load_dwordx4 v244, s[16:19], s50 offen offset:3072 sc1 lds
    s_add_u32 m0, s51, 4096
    s_nop 0
    buffer_load_dwordx4 v244, s[16:19], s33 offen offset:0 sc1 lds
    buffer_load_dwordx4 v244, s[16:19], s33 offen offset:1024 sc1 lds
    buffer_load_dwordx4 v244, s[16:19], s33 offen offset:2048 sc1 lds
    buffer_load_dwordx4 v244, s[16:19], s33 offen offset:3072 sc1 lds
    s_add_u32 s12, s76, 29360128
    s_addc_u32 s13, s77, 0
    s_mov_b32 s14, 16384
    s_mov_b32 s15, 0x20000
    v_lshlrev_b32 v252, 3, v255
    v_add_u32 v252, 11264, v252
    buffer_load_dwordx2 v[250:251], v252, s[12:15], 0 offen sc1
    ds_read_b128 v[0:3], v244 offset:0
    ds_read_b128 v[4:7], v244 offset:1024
    ds_read_b128 v[8:11], v244 offset:2048
    ds_read_b128 v[12:15], v244 offset:3072
    ds_read_b128 v[16:19], v244 offset:4096
    ds_read_b128 v[20:23], v244 offset:5120
    ds_read_b128 v[144:147], v244 offset:18432
    ds_read_b128 v[148:151], v244 offset:19456
    ds_read_b128 v[152:155], v244 offset:20480
    ds_read_b128 v[156:159], v244 offset:21504
    ds_read_b128 v[160:163], v244 offset:22528
    ds_read_b128 v[164:167], v244 offset:23552
    ds_read_b128 v[168:171], v244 offset:24576
    ds_read_b128 v[172:175], v244 offset:25600
    s_waitcnt vmcnt(1)
    ds_read_b128 v[48:51], v246 offset:0
    ds_read_b128 v[52:55], v247 offset:0
    ds_read_b128 v[56:59], v246 offset:4096
    ds_read_b128 v[60:63], v247 offset:4096
    ds_read_b128 v[64:67], v248 offset:0
    ds_read_b128 v[68:71], v249 offset:0
    ds_read_b128 v[72:75], v248 offset:4096
    ds_read_b128 v[76:79], v249 offset:4096
    s_waitcnt lgkmcnt(0)
    ds_read_b128 v[176:179], v244 offset:26624
    ds_read_b128 v[180:183], v244 offset:27648
    ds_read_b128 v[184:187], v244 offset:28672
    ds_read_b128 v[188:191], v244 offset:29696
    ds_read_b128 v[192:195], v244 offset:30720
    ds_read_b128 v[196:199], v244 offset:31744
    ds_read_b128 v[200:203], v244 offset:32768
    ds_read_b128 v[204:207], v244 offset:33792
    ds_read_b128 v[24:27], v244 offset:6144
    ds_read_b128 v[28:31], v244 offset:7168
    ds_read_b128 v[32:35], v244 offset:8192
    ds_read_b128 v[36:39], v244 offset:9216
    ds_read_b128 v[40:43], v244 offset:10240
    ds_read_b128 v[44:47], v244 offset:11264
    v_mfma_f32_32x32x16_bf16 v[80:95], v[48:51], v[0:3], 0
    v_mfma_f32_32x32x16_bf16 v[96:111], v[64:67], v[0:3], 0
    v_mfma_f32_32x32x16_bf16 v[80:95], v[64:67], v[8:11], v[80:95]
    v_mfma_f32_32x32x16_bf16 v[96:111], v[48:51], v[16:19], v[96:111]
    v_mfma_f32_32x32x16_bf16 v[80:95], v[52:55], v[4:7], v[80:95]
    v_mfma_f32_32x32x16_bf16 v[96:111], v[68:71], v[4:7], v[96:111]
    v_mfma_f32_32x32x16_bf16 v[80:95], v[68:71], v[12:15], v[80:95]
    v_mfma_f32_32x32x16_bf16 v[96:111], v[52:55], v[20:23], v[96:111]
    v_mfma_f32_32x32x16_bf16 v[112:127], v[56:59], v[0:3], 0
    v_mfma_f32_32x32x16_bf16 v[128:143], v[72:75], v[0:3], 0
    v_mfma_f32_32x32x16_bf16 v[112:127], v[72:75], v[8:11], v[112:127]
    v_mfma_f32_32x32x16_bf16 v[128:143], v[56:59], v[16:19], v[128:143]
    v_mfma_f32_32x32x16_bf16 v[112:127], v[60:63], v[4:7], v[112:127]
    v_mfma_f32_32x32x16_bf16 v[128:143], v[76:79], v[4:7], v[128:143]
    v_mfma_f32_32x32x16_bf16 v[112:127], v[76:79], v[12:15], v[112:127]
    v_mfma_f32_32x32x16_bf16 v[128:143], v[60:63], v[20:23], v[128:143]
    s_waitcnt vmcnt(0)
    s_mov_b64 s[4:5], -1
    v_cmp_eq_u32 vcc, s78, v250
    v_cmp_eq_u32 s[6:7], s79, v251
    s_nop 3
    s_and_b64 vcc, vcc, s[6:7]
    s_and_b64 vcc, vcc, s[4:5]
    s_cmp_eq_u64 vcc, s[4:5]
    s_cbranch_scc1 L_xok_82
    s_mov_b32 s8, 65536
L_wf_83:
    buffer_load_dwordx2 v[250:251], v252, s[12:15], 0 offen sc1
    s_waitcnt vmcnt(0)
    v_cmp_eq_u32 vcc, s78, v250
    v_cmp_eq_u32 s[6:7], s79, v251
    s_nop 3
    s_and_b64 vcc, vcc, s[6:7]
    s_and_b64 vcc, vcc, s[4:5]
    s_cmp_eq_u64 vcc, s[4:5]
    s_cbranch_scc1 L_wfd_84
    s_sleep 1
    s_sub_u32 s8, s8, 1
    s_cmp_lg_u32 s8, 0
    s_cbranch_scc1 L_wf_83
L_wfd_84:
    s_waitcnt vmcnt(0)
L_xok_82:
    buffer_load_dword v208, v245, s[24:27], 0 offen offset:0 sc1
    buffer_load_dword v209, v245, s[24:27], 0 offen offset:128 sc1
    buffer_load_dword v210, v245, s[24:27], 0 offen offset:256 sc1
    buffer_load_dword v211, v245, s[24:27], 0 offen offset:384 sc1
    buffer_load_dword v212, v245, s[24:27], 0 offen offset:1024 sc1
    buffer_load_dword v213, v245, s[24:27], 0 offen offset:1152 sc1
    buffer_load_dword v214, v245, s[24:27], 0 offen offset:1280 sc1
    buffer_load_dword v215, v245, s[24:27], 0 offen offset:1408 sc1
    buffer_load_dword v216, v245, s[24:27], 0 offen offset:2048 sc1
    buffer_load_dword v217, v245, s[24:27], 0 offen offset:2176 sc1
    buffer_load_dword v218, v245, s[24:27], 0 offen offset:2304 sc1
    buffer_load_dword v219, v245, s[24:27], 0 offen offset:2432 sc1
    buffer_load_dword v220, v245, s[24:27], 0 offen offset:3072 sc1
    buffer_load_dword v221, v245, s[24:27], 0 offen offset:3200 sc1
    buffer_load_dword v222, v245, s[24:27], 0 offen offset:3328 sc1
    buffer_load_dword v223, v245, s[24:27], 0 offen offset:3456 sc1
    buffer_load_dword v224, v254, s[24:27], 0 offen offset:0 sc1
    buffer_load_dword v225, v254, s[24:27], 0 offen offset:128 sc1
    buffer_load_dword v226, v254, s[24:27], 0 offen offset:256 sc1
    buffer_load_dword v227, v254, s[24:27], 0 offen offset:384 sc1
    buffer_load_dword v228, v254, s[24:27], 0 offen offset:1024 sc1
    buffer_load_dword v229, v254, s[24:27], 0 offen offset:1152 sc1
    buffer_load_dword v230, v254, s[24:27], 0 offen offset:1280 sc1
    buffer_load_dword v231, v254, s[24:27], 0 offen offset:1408 sc1
    buffer_load_dword v232, v254, s[24:27], 0 offen offset:2048 sc1
    buffer_load_dword v233, v254, s[24:27], 0 offen offset:2176 sc1
    buffer_load_dword v234, v254, s[24:27], 0 offen offset:2304 sc1
    buffer_load_dword v235, v254, s[24:27], 0 offen offset:2432 sc1
    buffer_load_dword v236, v254, s[24:27], 0 offen offset:3072 sc1
    buffer_load_dword v237, v254, s[24:27], 0 offen offset:3200 sc1
    buffer_load_dword v238, v254, s[24:27], 0 offen offset:3328 sc1
    buffer_load_dword v239, v254, s[24:27], 0 offen offset:3456 sc1
    s_waitcnt lgkmcnt(0)
    v_mul_f32 v250, v80, v144
    v_mul_f32 v251, v96, v144
    v_fmac_f32 v250, v96, v160
    v_fma_f32 v251, -v80, v160, v251
    v_fma_f32 v80, v112, v176, v250
    v_fma_f32 v96, v128, v176, v251
    v_fmac_f32 v80, v128, v192
    v_fma_f32 v96, -v112, v192, v96
    v_fma_f32 v112, 2.0, v250, -v80
    v_fma_f32 v128, 2.0, v251, -v96
    v_mul_f32 v252, v81, v145
    v_mul_f32 v253, v97, v145
    v_fmac_f32 v252, v97, v161
    v_fma_f32 v253, -v81, v161, v253
    v_fma_f32 v81, v113, v177, v252
    v_fma_f32 v97, v129, v177, v253
    v_fmac_f32 v81, v129, v193
    v_fma_f32 v97, -v113, v193, v97
    v_fma_f32 v113, 2.0, v252, -v81
    v_fma_f32 v129, 2.0, v253, -v97
    v_mul_f32 v250, v82, v146
    v_mul_f32 v251, v98, v146
    v_fmac_f32 v250, v98, v162
    v_fma_f32 v251, -v82, v162, v251
    v_fma_f32 v82, v114, v178, v250
    v_fma_f32 v98, v130, v178, v251
    v_fmac_f32 v82, v130, v194
    v_fma_f32 v98, -v114, v194, v98
    v_fma_f32 v114, 2.0, v250, -v82
    v_fma_f32 v130, 2.0, v251, -v98
    v_mul_f32 v252, v83, v147
    v_mul_f32 v253, v99, v147
    v_fmac_f32 v252, v99, v163
    v_fma_f32 v253, -v83, v163, v253
    v_fma_f32 v83, v115, v179, v252
    v_fma_f32 v99, v131, v179, v253
    v_fmac_f32 v83, v131, v195
    v_fma_f32 v99, -v115, v195, v99
    v_fma_f32 v115, 2.0, v252, -v83
    v_fma_f32 v131, 2.0, v253, -v99
    v_mul_f32 v250, v84, v148
    v_mul_f32 v251, v100, v148
    v_fmac_f32 v250, v100, v164
    v_fma_f32 v251, -v84, v164, v251
    v_fma_f32 v84, v116, v180, v250
    v_fma_f32 v100, v132, v180, v251
    v_fmac_f32 v84, v132, v196
    v_fma_f32 v100, -v116, v196, v100
    v_fma_f32 v116, 2.0, v250, -v84
    v_fma_f32 v132, 2.0, v251, -v100
    v_mul_f32 v252, v85, v149
    v_mul_f32 v253, v101, v149
    v_fmac_f32 v252, v101, v165
    v_fma_f32 v253, -v85, v165, v253
    v_fma_f32 v85, v117, v181, v252
    v_fma_f32 v101, v133, v181, v253
    v_fmac_f32 v85, v133, v197
    v_fma_f32 v101, -v117, v197, v101
    v_fma_f32 v117, 2.0, v252, -v85
    v_fma_f32 v133, 2.0, v253, -v101
    v_mul_f32 v250, v86, v150
    v_mul_f32 v251, v102, v150
    v_fmac_f32 v250, v102, v166
    v_fma_f32 v251, -v86, v166, v251
    v_fma_f32 v86, v118, v182, v250
    v_fma_f32 v102, v134, v182, v251
    v_fmac_f32 v86, v134, v198
    v_fma_f32 v102, -v118, v198, v102
    v_fma_f32 v118, 2.0, v250, -v86
    v_fma_f32 v134, 2.0, v251, -v102
    v_mul_f32 v252, v87, v151
    v_mul_f32 v253, v103, v151
    v_fmac_f32 v252, v103, v167
    v_fma_f32 v253, -v87, v167, v253
    v_fma_f32 v87, v119, v183, v252
    v_fma_f32 v103, v135, v183, v253
    v_fmac_f32 v87, v135, v199
    v_fma_f32 v103, -v119, v199, v103
    v_fma_f32 v119, 2.0, v252, -v87
    v_fma_f32 v135, 2.0, v253, -v103
    v_mul_f32 v250, v88, v152
    v_mul_f32 v251, v104, v152
    v_fmac_f32 v250, v104, v168
    v_fma_f32 v251, -v88, v168, v251
    v_fma_f32 v88, v120, v184, v250
    v_fma_f32 v104, v136, v184, v251
    v_fmac_f32 v88, v136, v200
    v_fma_f32 v104, -v120, v200, v104
    v_fma_f32 v120, 2.0, v250, -v88
    v_fma_f32 v136, 2.0, v251, -v104
    v_mul_f32 v252, v89, v153
    v_mul_f32 v253, v105, v153
    v_fmac_f32 v252, v105, v169
    v_fma_f32 v253, -v89, v169, v253
    v_fma_f32 v89, v121, v185, v252
    v_fma_f32 v105, v137, v185, v253
    v_fmac_f32 v89, v137, v201
    v_fma_f32 v105, -v121, v201, v105
    v_fma_f32 v121, 2.0, v252, -v89
    v_fma_f32 v137, 2.0, v253, -v105
    v_mul_f32 v250, v90, v154
    v_mul_f32 v251, v106, v154
    v_fmac_f32 v250, v106, v170
    v_fma_f32 v251, -v90, v170, v251
    v_fma_f32 v90, v122, v186, v250
    v_fma_f32 v106, v138, v186, v251
    v_fmac_f32 v90, v138, v202
    v_fma_f32 v106, -v122, v202, v106
    v_fma_f32 v122, 2.0, v250, -v90
    v_fma_f32 v138, 2.0, v251, -v106
    v_mul_f32 v252, v91, v155
    v_mul_f32 v253, v107, v155
    v_fmac_f32 v252, v107, v171
    v_fma_f32 v253, -v91, v171, v253
    v_fma_f32 v91, v123, v187, v252
    v_fma_f32 v107, v139, v187, v253
    v_fmac_f32 v91, v139, v203
    v_fma_f32 v107, -v123, v203, v107
    v_fma_f32 v123, 2.0, v252, -v91
    v_fma_f32 v139, 2.0, v253, -v107
    v_mul_f32 v250, v92, v156
    v_mul_f32 v251, v108, v156
    v_fmac_f32 v250, v108, v172
    v_fma_f32 v251, -v92, v172, v251
    v_fma_f32 v92, v124, v188, v250
    v_fma_f32 v108, v140, v188, v251
    v_fmac_f32 v92, v140, v204
    v_fma_f32 v108, -v124, v204, v108
    v_fma_f32 v124, 2.0, v250, -v92
    v_fma_f32 v140, 2.0, v251, -v108
    v_mul_f32 v252, v93, v157
    v_mul_f32 v253, v109, v157
    v_fmac_f32 v252, v109, v173
    v_fma_f32 v253, -v93, v173, v253
    v_fma_f32 v93, v125, v189, v252
    v_fma_f32 v109, v141, v189, v253
    v_fmac_f32 v93, v141, v205
    v_fma_f32 v109, -v125, v205, v109
    v_fma_f32 v125, 2.0, v252, -v93
    v_fma_f32 v141, 2.0, v253, -v109
    v_mul_f32 v250, v94, v158
    v_mul_f32 v251, v110, v158
    v_fmac_f32 v250, v110, v174
    v_fma_f32 v251, -v94, v174, v251
    v_fma_f32 v94, v126, v190, v250
    v_fma_f32 v110, v142, v190, v251
    v_fmac_f32 v94, v142, v206
    v_fma_f32 v110, -v126, v206, v110
    v_fma_f32 v126, 2.0, v250, -v94
    v_fma_f32 v142, 2.0, v251, -v110
    v_mul_f32 v252, v95, v159
    v_mul_f32 v253, v111, v159
    v_fmac_f32 v252, v111, v175
    v_fma_f32 v253, -v95, v175, v253
    v_fma_f32 v95, v127, v191, v252
    v_fma_f32 v111, v143, v191, v253
    v_fmac_f32 v95, v143, v207
    v_fma_f32 v111, -v127, v207, v111
    v_fma_f32 v127, 2.0, v252, -v95
    v_fma_f32 v143, 2.0, v253, -v111
    s_mov_b32 s3, 0xffff0000
    v_cvt_pk_bf16_f32 v48, v80, v81
    v_cvt_pk_bf16_f32 v49, v82, v83
    v_cvt_pk_bf16_f32 v50, v84, v85
    v_cvt_pk_bf16_f32 v51, v86, v87
    v_cvt_pk_bf16_f32 v52, v88, v89
    v_cvt_pk_bf16_f32 v53, v90, v91
    v_cvt_pk_bf16_f32 v54, v92, v93
    v_cvt_pk_bf16_f32 v55, v94, v95
    v_cvt_pk_bf16_f32 v56, v96, v97
    v_cvt_pk_bf16_f32 v57, v98, v99
    v_cvt_pk_bf16_f32 v58, v100, v101
    v_cvt_pk_bf16_f32 v59, v102, v103
    v_cvt_pk_bf16_f32 v60, v104, v105
    v_cvt_pk_bf16_f32 v61, v106, v107
    v_cvt_pk_bf16_f32 v62, v108, v109
    v_cvt_pk_bf16_f32 v63, v110, v111
    s_nop 1
    v_mfma_f32_32x32x16_bf16 v[144:159], v[0:3], v[48:51], 0
    v_cvt_pk_bf16_f32 v64, v112, v113
    v_cvt_pk_bf16_f32 v65, v114, v115
    v_mfma_f32_32x32x16_bf16 v[160:175], v[0:3], v[56:59], 0
    v_cvt_pk_bf16_f32 v66, v116, v117
    v_cvt_pk_bf16_f32 v67, v118, v119
    v_mfma_f32_32x32x16_bf16 v[144:159], v[8:11], v[56:59], v[144:159]
    v_cvt_pk_bf16_f32 v68, v120, v121
    v_cvt_pk_bf16_f32 v69, v122, v123
    v_mfma_f32_32x32x16_bf16 v[160:175], v[16:19], v[48:51], v[160:175]
    v_cvt_pk_bf16_f32 v70, v124, v125
    v_cvt_pk_bf16_f32 v71, v126, v127
    v_mfma_f32_32x32x16_bf16 v[144:159], v[4:7], v[52:55], v[144:159]
    v_cvt_pk_bf16_f32 v72, v128, v129
    v_cvt_pk_bf16_f32 v73, v130, v131
    v_mfma_f32_32x32x16_bf16 v[160:175], v[4:7], v[60:63], v[160:175]
    v_cvt_pk_bf16_f32 v74, v132, v133
    v_cvt_pk_bf16_f32 v75, v134, v135
    v_mfma_f32_32x32x16_bf16 v[144:159], v[12:15], v[60:63], v[144:159]
    v_cvt_pk_bf16_f32 v76, v136, v137
    v_cvt_pk_bf16_f32 v77, v138, v139
    v_mfma_f32_32x32x16_bf16 v[160:175], v[20:23], v[52:55], v[160:175]
    v_cvt_pk_bf16_f32 v78, v140, v141
    v_cvt_pk_bf16_f32 v79, v142, v143
    s_waitcnt vmcnt(0)
    s_nop 0
    v_mfma_f32_32x32x16_bf16 v[176:191], v[24:27], v[64:67], 0
    v_lshlrev_b32 v80, 16, v208
    v_and_b32 v96, s3, v208
    v_lshlrev_b32 v81, 16, v209
    v_and_b32 v97, s3, v209
    v_lshlrev_b32 v82, 16, v210
    v_mfma_f32_32x32x16_bf16 v[192:207], v[24:27], v[72:75], 0
    v_and_b32 v98, s3, v210
    v_lshlrev_b32 v83, 16, v211
    v_and_b32 v99, s3, v211
    v_lshlrev_b32 v84, 16, v212
    v_and_b32 v100, s3, v212
    v_mfma_f32_32x32x16_bf16 v[176:191], v[32:35], v[72:75], v[176:191]
    v_lshlrev_b32 v85, 16, v213
    v_and_b32 v101, s3, v213
    v_lshlrev_b32 v86, 16, v214
    v_and_b32 v102, s3, v214
    v_lshlrev_b32 v87, 16, v215
    v_mfma_f32_32x32x16_bf16 v[192:207], v[40:43], v[64:67], v[192:207]
    v_and_b32 v103, s3, v215
    v_lshlrev_b32 v88, 16, v216
    v_and_b32 v104, s3, v216
    v_lshlrev_b32 v89, 16, v217
    v_and_b32 v105, s3, v217
    v_mfma_f32_32x32x16_bf16 v[176:191], v[28:31], v[68:71], v[176:191]
    v_lshlrev_b32 v90, 16, v218
    v_and_b32 v106, s3, v218
    v_lshlrev_b32 v91, 16, v219
    v_and_b32 v107, s3, v219
    v_lshlrev_b32 v92, 16, v220
    v_mfma_f32_32x32x16_bf16 v[192:207], v[28:31], v[76:79], v[192:207]
    v_and_b32 v108, s3, v220
    v_lshlrev_b32 v93, 16, v221
    v_and_b32 v109, s3, v221
    v_lshlrev_b32 v94, 16, v222
    v_and_b32 v110, s3, v222
    v_mfma_f32_32x32x16_bf16 v[176:191], v[36:39], v[76:79], v[176:191]
    v_lshlrev_b32 v95, 16, v223
    v_and_b32 v111, s3, v223
    v_mul_f32 v246, v160, v96
    v_mul_f32 v160, v160, v80
    v_fmac_f32 v160, v144, v96
    v_mfma_f32_32x32x16_bf16 v[192:207], v[44:47], v[68:71], v[192:207]
    v_fma_f32 v144, v144, v80, -v246
    v_mul_f32 v247, v161, v97
    v_mul_f32 v161, v161, v81
    v_fmac_f32 v161, v145, v97
    v_fma_f32 v145, v145, v81, -v247
    ds_read_b128 v[24:27], v244 offset:12288
    ds_read_b128 v[28:31], v244 offset:13312
    ds_read_b128 v[32:35], v244 offset:14336
    ds_read_b128 v[36:39], v244 offset:15360
    ds_read_b128 v[40:43], v244 offset:16384
    ds_read_b128 v[44:47], v244 offset:17408
    v_mul_f32 v248, v162, v98
    v_mul_f32 v162, v162, v82
    v_fmac_f32 v162, v146, v98
    v_fma_f32 v146, v146, v82, -v248
    v_mul_f32 v249, v163, v99
    v_mul_f32 v163, v163, v83
    v_fmac_f32 v163, v147, v99
    v_fma_f32 v147, v147, v83, -v249
    v_mul_f32 v246, v164, v100
    v_mul_f32 v164, v164, v84
    v_fmac_f32 v164, v148, v100
    v_fma_f32 v148, v148, v84, -v246
    v_mul_f32 v247, v165, v101
    v_mul_f32 v165, v165, v85
    v_fmac_f32 v165, v149, v101
    v_fma_f32 v149, v149, v85, -v247
    v_mul_f32 v248, v166, v102
    v_mul_f32 v166, v166, v86
    v_fmac_f32 v166, v150, v102
    v_fma_f32 v150, v150, v86, -v248
    v_mul_f32 v249, v167, v103
    v_mul_f32 v167, v167, v87
    v_fmac_f32 v167, v151, v103
    v_fma_f32 v151, v151, v87, -v249
    v_mul_f32 v246, v168, v104
    v_mul_f32 v168, v168, v88
    v_fmac_f32 v168, v152, v104
    v_fma_f32 v152, v152, v88, -v246
    v_mul_f32 v247, v169, v105
    v_mul_f32 v169, v169, v89
    v_fmac_f32 v169, v153, v105
    v_fma_f32 v153, v153, v89, -v247
    v_mul_f32 v248, v170, v106
    v_mul_f32 v170, v170, v90
    v_fmac_f32 v170, v154, v106
    v_fma_f32 v154, v154, v90, -v248
    v_mul_f32 v249, v171, v107
    v_mul_f32 v171, v171, v91
    v_fmac_f32 v171, v155, v107
    v_fma_f32 v155, v155, v91, -v249
    v_mul_f32 v246, v172, v108
    v_mul_f32 v172, v172, v92
    v_fmac_f32 v172, v156, v108
    v_fma_f32 v156, v156, v92, -v246
    v_mul_f32 v247, v173, v109
    v_mul_f32 v173, v173, v93
    v_fmac_f32 v173, v157, v109
    v_fma_f32 v157, v157, v93, -v247
    v_mul_f32 v248, v174, v110
    v_mul_f32 v174, v174, v94
    v_fmac_f32 v174, v158, v110
    v_fma_f32 v158, v158, v94, -v248
    v_mul_f32 v249, v175, v111
    v_mul_f32 v175, v175, v95
    v_fmac_f32 v175, v159, v111
    v_fma_f32 v159, v159, v95, -v249
    v_cvt_pk_bf16_f32 v48, v144, v145
    v_cvt_pk_bf16_f32 v49, v146, v147
    v_cvt_pk_bf16_f32 v50, v148, v149
    v_cvt_pk_bf16_f32 v51, v150, v151
    v_cvt_pk_bf16_f32 v52, v152, v153
    v_cvt_pk_bf16_f32 v53, v154, v155
    v_cvt_pk_bf16_f32 v54, v156, v157
    v_cvt_pk_bf16_f32 v55, v158, v159
    v_cvt_pk_bf16_f32 v56, v160, v161
    v_cvt_pk_bf16_f32 v57, v162, v163
    v_cvt_pk_bf16_f32 v58, v164, v165
    v_cvt_pk_bf16_f32 v59, v166, v167
    v_cvt_pk_bf16_f32 v60, v168, v169
    v_cvt_pk_bf16_f32 v61, v170, v171
    v_cvt_pk_bf16_f32 v62, v172, v173
    v_cvt_pk_bf16_f32 v63, v174, v175
    s_nop 1
    v_mfma_f32_32x32x16_bf16 v[144:159], v[48:51], v[0:3], 0
    v_lshlrev_b32 v112, 16, v224
    v_and_b32 v128, s3, v224
    v_lshlrev_b32 v113, 16, v225
    v_and_b32 v129, s3, v225
    v_lshlrev_b32 v114, 16, v226
    v_and_b32 v130, s3, v226
    v_mfma_f32_32x32x16_bf16 v[160:175], v[56:59], v[0:3], 0
    v_lshlrev_b32 v115, 16, v227
    v_and_b32 v131, s3, v227
    v_lshlrev_b32 v116, 16, v228
    v_and_b32 v132, s3, v228
    v_lshlrev_b32 v117, 16, v229
    v_and_b32 v133, s3, v229
    v_mfma_f32_32x32x16_bf16 v[144:159], v[56:59], v[16:19], v[144:159]
    v_lshlrev_b32 v118, 16, v230
    v_and_b32 v134, s3, v230
    v_lshlrev_b32 v119, 16, v231
    v_and_b32 v135, s3, v231
    v_lshlrev_b32 v120, 16, v232
    v_and_b32 v136, s3, v232
    v_mfma_f32_32x32x16_bf16 v[160:175], v[48:51], v[8:11], v[160:175]
    v_lshlrev_b32 v121, 16, v233
    v_and_b32 v137, s3, v233
    v_lshlrev_b32 v122, 16, v234
    v_and_b32 v138, s3, v234
    v_lshlrev_b32 v123, 16, v235
    v_and_b32 v139, s3, v235
    v_mfma_f32_32x32x16_bf16 v[144:159], v[52:55], v[4:7], v[144:159]
    v_lshlrev_b32 v124, 16, v236
    v_and_b32 v140, s3, v236
    v_lshlrev_b32 v125, 16, v237
    v_and_b32 v141, s3, v237
    v_lshlrev_b32 v126, 16, v238
    v_and_b32 v142, s3, v238
    v_mfma_f32_32x32x16_bf16 v[160:175], v[60:63], v[4:7], v[160:175]
    v_lshlrev_b32 v127, 16, v239
    v_and_b32 v143, s3, v239
    v_mul_f32 v246, v192, v128
    v_mul_f32 v192, v192, v112
    v_fmac_f32 v192, v176, v128
    v_fma_f32 v176, v176, v112, -v246
    v_mfma_f32_32x32x16_bf16 v[144:159], v[60:63], v[20:23], v[144:159]
    v_mul_f32 v247, v193, v129
    v_mul_f32 v193, v193, v113
    v_fmac_f32 v193, v177, v129
    v_fma_f32 v177, v177, v113, -v247
    v_mul_f32 v248, v194, v130
    v_mul_f32 v194, v194, v114
    v_mfma_f32_32x32x16_bf16 v[160:175], v[52:55], v[12:15], v[160:175]
    v_fmac_f32 v194, v178, v130
    v_fma_f32 v178, v178, v114, -v248
    v_mul_f32 v249, v195, v131
    v_mul_f32 v195, v195, v115
    v_fmac_f32 v195, v179, v131
    v_fma_f32 v179, v179, v115, -v249
    v_mul_f32 v246, v196, v132
    v_mul_f32 v196, v196, v116
    v_fmac_f32 v196, v180, v132
    v_fma_f32 v180, v180, v116, -v246
    v_mul_f32 v247, v197, v133
    v_mul_f32 v197, v197, v117
    v_fmac_f32 v197, v181, v133
    v_fma_f32 v181, v181, v117, -v247
    v_mul_f32 v248, v198, v134
    v_mul_f32 v198, v198, v118
    v_fmac_f32 v198, v182, v134
    v_fma_f32 v182, v182, v118, -v248
    v_mul_f32 v249, v199, v135
    v_mul_f32 v199, v199, v119
    v_fmac_f32 v199, v183, v135
    v_fma_f32 v183, v183, v119, -v249
    v_mul_f32 v246, v200, v136
    v_mul_f32 v200, v200, v120
    v_fmac_f32 v200, v184, v136
    v_fma_f32 v184, v184, v120, -v246
    v_mul_f32 v247, v201, v137
    v_mul_f32 v201, v201, v121
    v_fmac_f32 v201, v185, v137
    v_fma_f32 v185, v185, v121, -v247
    v_mul_f32 v248, v202, v138
    v_mul_f32 v202, v202, v122
    v_fmac_f32 v202, v186, v138
    v_fma_f32 v186, v186, v122, -v248
    v_mul_f32 v249, v203, v139
    v_mul_f32 v203, v203, v123
    v_fmac_f32 v203, v187, v139
    v_fma_f32 v187, v187, v123, -v249
    v_mul_f32 v246, v204, v140
    v_mul_f32 v204, v204, v124
    v_fmac_f32 v204, v188, v140
    v_fma_f32 v188, v188, v124, -v246
    v_mul_f32 v247, v205, v141
    v_mul_f32 v205, v205, v125
    v_fmac_f32 v205, v189, v141
    v_fma_f32 v189, v189, v125, -v247
    v_mul_f32 v248, v206, v142
    v_mul_f32 v206, v206, v126
    v_fmac_f32 v206, v190, v142
    v_fma_f32 v190, v190, v126, -v248
    v_mul_f32 v249, v207, v143
    v_mul_f32 v207, v207, v127
    v_fmac_f32 v207, v191, v143
    v_fma_f32 v191, v191, v127, -v249
    v_cvt_pk_bf16_f32 v64, v176, v177
    v_cvt_pk_bf16_f32 v65, v178, v179
    v_cvt_pk_bf16_f32 v66, v180, v181
    v_cvt_pk_bf16_f32 v67, v182, v183
    v_cvt_pk_bf16_f32 v68, v184, v185
    v_cvt_pk_bf16_f32 v69, v186, v187
    v_cvt_pk_bf16_f32 v70, v188, v189
    v_cvt_pk_bf16_f32 v71, v190, v191
    v_cvt_pk_bf16_f32 v72, v192, v193
    v_cvt_pk_bf16_f32 v73, v194, v195
    v_cvt_pk_bf16_f32 v74, v196, v197
    v_cvt_pk_bf16_f32 v75, v198, v199
    v_cvt_pk_bf16_f32 v76, v200, v201
    v_cvt_pk_bf16_f32 v77, v202, v203
    v_cvt_pk_bf16_f32 v78, v204, v205
    v_cvt_pk_bf16_f32 v79, v206, v207
    ds_read_b128 v[80:83], v244 offset:18432
    ds_read_b128 v[84:87], v244 offset:19456
    ds_read_b128 v[88:91], v244 offset:20480
    ds_read_b128 v[92:95], v244 offset:21504
    ds_read_b128 v[96:99], v244 offset:22528
    ds_read_b128 v[100:103], v244 offset:23552
    ds_read_b128 v[104:107], v244 offset:24576
    ds_read_b128 v[108:111], v244 offset:25600
    ds_read_b128 v[112:115], v244 offset:34816
    ds_read_b128 v[116:119], v244 offset:35840
    ds_read_b128 v[120:123], v244 offset:36864
    ds_read_b128 v[124:127], v244 offset:37888
    ds_read_b128 v[128:131], v244 offset:38912
    ds_read_b128 v[132:135], v244 offset:39936
    ds_read_b128 v[136:139], v244 offset:40960
    ds_read_b128 v[140:143], v244 offset:41984
    s_waitcnt lgkmcnt(15)
    v_mfma_f32_32x32x16_bf16 v[176:191], v[64:67], v[24:27], 0
    v_mfma_f32_32x32x16_bf16 v[192:207], v[72:75], v[24:27], 0
    v_mfma_f32_32x32x16_bf16 v[176:191], v[72:75], v[40:43], v[176:191]
    v_mfma_f32_32x32x16_bf16 v[192:207], v[64:67], v[32:35], v[192:207]
    v_mfma_f32_32x32x16_bf16 v[176:191], v[68:71], v[28:31], v[176:191]
    v_mfma_f32_32x32x16_bf16 v[192:207], v[76:79], v[28:31], v[192:207]
    v_mfma_f32_32x32x16_bf16 v[176:191], v[76:79], v[44:47], v[176:191]
    v_mfma_f32_32x32x16_bf16 v[192:207], v[68:71], v[36:39], v[192:207]
    s_waitcnt lgkmcnt(0)
    s_nop 7
    s_nop 3
    v_add_f32 v144, v144, v176
    v_add_f32 v160, v160, v192
    v_fma_f32 v176, -2.0, v176, v144
    v_fma_f32 v192, -2.0, v192, v160
    v_add_f32 v145, v145, v177
    v_add_f32 v161, v161, v193
    v_fma_f32 v177, -2.0, v177, v145
    v_fma_f32 v193, -2.0, v193, v161
    v_add_f32 v146, v146, v178
    v_add_f32 v162, v162, v194
    v_fma_f32 v178, -2.0, v178, v146
    v_fma_f32 v194, -2.0, v194, v162
    v_add_f32 v147, v147, v179
    v_add_f32 v163, v163, v195
    v_fma_f32 v179, -2.0, v179, v147
    v_fma_f32 v195, -2.0, v195, v163
    v_add_f32 v148, v148, v180
    v_add_f32 v164, v164, v196
    v_fma_f32 v180, -2.0, v180, v148
    v_fma_f32 v196, -2.0, v196, v164
    v_add_f32 v149, v149, v181
    v_add_f32 v165, v165, v197
    v_fma_f32 v181, -2.0, v181, v149
    v_fma_f32 v197, -2.0, v197, v165
    v_add_f32 v150, v150, v182
    v_add_f32 v166, v166, v198
    v_fma_f32 v182, -2.0, v182, v150
    v_fma_f32 v198, -2.0, v198, v166
    v_add_f32 v151, v151, v183
    v_add_f32 v167, v167, v199
    v_fma_f32 v183, -2.0, v183, v151
    v_fma_f32 v199, -2.0, v199, v167
    v_add_f32 v152, v152, v184
    v_add_f32 v168, v168, v200
    v_fma_f32 v184, -2.0, v184, v152
    v_fma_f32 v200, -2.0, v200, v168
    v_add_f32 v153, v153, v185
    v_add_f32 v169, v169, v201
    v_fma_f32 v185, -2.0, v185, v153
    v_fma_f32 v201, -2.0, v201, v169
    v_add_f32 v154, v154, v186
    v_add_f32 v170, v170, v202
    v_fma_f32 v186, -2.0, v186, v154
    v_fma_f32 v202, -2.0, v202, v170
    v_add_f32 v155, v155, v187
    v_add_f32 v171, v171, v203
    v_fma_f32 v187, -2.0, v187, v155
    v_fma_f32 v203, -2.0, v203, v171
    v_add_f32 v156, v156, v188
    v_add_f32 v172, v172, v204
    v_fma_f32 v188, -2.0, v188, v156
    v_fma_f32 v204, -2.0, v204, v172
    v_add_f32 v157, v157, v189
    v_add_f32 v173, v173, v205
    v_fma_f32 v189, -2.0, v189, v157
    v_fma_f32 v205, -2.0, v205, v173
    v_add_f32 v158, v158, v190
    v_add_f32 v174, v174, v206
    v_fma_f32 v190, -2.0, v190, v158
    v_fma_f32 v206, -2.0, v206, v174
    v_add_f32 v159, v159, v191
    v_add_f32 v175, v175, v207
    v_fma_f32 v191, -2.0, v191, v159
    v_fma_f32 v207, -2.0, v207, v175
    v_mul_f32 v246, v160, v96
    v_mul_f32 v160, v160, v80
    v_fmac_f32 v160, v144, v96
    v_fma_f32 v144, v144, v80, -v246
    v_mul_f32 v247, v161, v97
    v_mul_f32 v161, v161, v81
    v_fmac_f32 v161, v145, v97
    v_fma_f32 v145, v145, v81, -v247
    v_mul_f32 v248, v162, v98
    v_mul_f32 v162, v162, v82
    v_fmac_f32 v162, v146, v98
    v_fma_f32 v146, v146, v82, -v248
    v_mul_f32 v249, v163, v99
    v_mul_f32 v163, v163, v83
    v_fmac_f32 v163, v147, v99
    v_fma_f32 v147, v147, v83, -v249
    v_mul_f32 v246, v164, v100
    v_mul_f32 v164, v164, v84
    v_fmac_f32 v164, v148, v100
    v_fma_f32 v148, v148, v84, -v246
    v_mul_f32 v247, v165, v101
    v_mul_f32 v165, v165, v85
    v_fmac_f32 v165, v149, v101
    v_fma_f32 v149, v149, v85, -v247
    v_mul_f32 v248, v166, v102
    v_mul_f32 v166, v166, v86
    v_fmac_f32 v166, v150, v102
    v_fma_f32 v150, v150, v86, -v248
    v_mul_f32 v249, v167, v103
    v_mul_f32 v167, v167, v87
    v_fmac_f32 v167, v151, v103
    v_fma_f32 v151, v151, v87, -v249
    v_mul_f32 v246, v168, v104
    v_mul_f32 v168, v168, v88
    v_fmac_f32 v168, v152, v104
    v_fma_f32 v152, v152, v88, -v246
    v_mul_f32 v247, v169, v105
    v_mul_f32 v169, v169, v89
    v_fmac_f32 v169, v153, v105
    v_fma_f32 v153, v153, v89, -v247
    v_mul_f32 v248, v170, v106
    v_mul_f32 v170, v170, v90
    v_fmac_f32 v170, v154, v106
    v_fma_f32 v154, v154, v90, -v248
    v_mul_f32 v249, v171, v107
    v_mul_f32 v171, v171, v91
    v_fmac_f32 v171, v155, v107
    v_fma_f32 v155, v155, v91, -v249
    v_mul_f32 v246, v172, v108
    v_mul_f32 v172, v172, v92
    v_fmac_f32 v172, v156, v108
    v_fma_f32 v156, v156, v92, -v246
    v_mul_f32 v247, v173, v109
    v_mul_f32 v173, v173, v93
    v_fmac_f32 v173, v157, v109
    v_fma_f32 v157, v157, v93, -v247
    v_mul_f32 v248, v174, v110
    v_mul_f32 v174, v174, v94
    v_fmac_f32 v174, v158, v110
    v_fma_f32 v158, v158, v94, -v248
    v_mul_f32 v249, v175, v111
    v_mul_f32 v175, v175, v95
    v_fmac_f32 v175, v159, v111
    v_fma_f32 v159, v159, v95, -v249
    v_cvt_pk_bf16_f32 v48, v144, v145
    v_cvt_pk_bf16_f32 v49, v146, v147
    v_cvt_pk_bf16_f32 v50, v148, v149
    v_cvt_pk_bf16_f32 v51, v150, v151
    v_cvt_pk_bf16_f32 v52, v152, v153
    v_cvt_pk_bf16_f32 v53, v154, v155
    v_cvt_pk_bf16_f32 v54, v156, v157
    v_cvt_pk_bf16_f32 v55, v158, v159
    v_cvt_pk_bf16_f32 v56, v160, v161
    v_cvt_pk_bf16_f32 v57, v162, v163
    v_cvt_pk_bf16_f32 v58, v164, v165
    v_cvt_pk_bf16_f32 v59, v166, v167
    v_cvt_pk_bf16_f32 v60, v168, v169
    v_cvt_pk_bf16_f32 v61, v170, v171
    v_cvt_pk_bf16_f32 v62, v172, v173
    v_cvt_pk_bf16_f32 v63, v174, v175
    s_nop 1
    v_mfma_f32_32x32x16_bf16 v[80:95], v[48:51], v[0:3], 0
    v_mul_f32 v246, v192, v128
    v_mul_f32 v192, v192, v112
    v_fmac_f32 v192, v176, v128
    v_fma_f32 v176, v176, v112, -v246
    v_mul_f32 v247, v193, v129
    v_mul_f32 v193, v193, v113
    v_mfma_f32_32x32x16_bf16 v[96:111], v[56:59], v[0:3], 0
    v_fmac_f32 v193, v177, v129
    v_fma_f32 v177, v177, v113, -v247
    v_mul_f32 v248, v194, v130
    v_mul_f32 v194, v194, v114
    v_fmac_f32 v194, v178, v130
    v_fma_f32 v178, v178, v114, -v248
    v_mfma_f32_32x32x16_bf16 v[80:95], v[56:59], v[16:19], v[80:95]
    v_mul_f32 v249, v195, v131
    v_mul_f32 v195, v195, v115
    v_fmac_f32 v195, v179, v131
    v_fma_f32 v179, v179, v115, -v249
    v_mul_f32 v246, v196, v132
    v_mul_f32 v196, v196, v116
    v_mfma_f32_32x32x16_bf16 v[96:111], v[48:51], v[8:11], v[96:111]
    v_fmac_f32 v196, v180, v132
    v_fma_f32 v180, v180, v116, -v246
    v_mul_f32 v247, v197, v133
    v_mul_f32 v197, v197, v117
    v_fmac_f32 v197, v181, v133
    v_fma_f32 v181, v181, v117, -v247
    v_mfma_f32_32x32x16_bf16 v[80:95], v[52:55], v[4:7], v[80:95]
    v_mul_f32 v248, v198, v134
    v_mul_f32 v198, v198, v118
    v_fmac_f32 v198, v182, v134
    v_fma_f32 v182, v182, v118, -v248
    v_mul_f32 v249, v199, v135
    v_mul_f32 v199, v199, v119
    v_mfma_f32_32x32x16_bf16 v[96:111], v[60:63], v[4:7], v[96:111]
    v_fmac_f32 v199, v183, v135
    v_fma_f32 v183, v183, v119, -v249
    v_mul_f32 v246, v200, v136
    v_mul_f32 v200, v200, v120
    v_fmac_f32 v200, v184, v136
    v_fma_f32 v184, v184, v120, -v246
    v_mfma_f32_32x32x16_bf16 v[80:95], v[60:63], v[20:23], v[80:95]
    v_mul_f32 v247, v201, v137
    v_mul_f32 v201, v201, v121
    v_fmac_f32 v201, v185, v137
    v_fma_f32 v185, v185, v121, -v247
    v_mul_f32 v248, v202, v138
    v_mul_f32 v202, v202, v122
    v_mfma_f32_32x32x16_bf16 v[96:111], v[52:55], v[12:15], v[96:111]
    v_fmac_f32 v202, v186, v138
    v_fma_f32 v186, v186, v122, -v248
    v_mul_f32 v249, v203, v139
    v_mul_f32 v203, v203, v123
    v_fmac_f32 v203, v187, v139
    v_fma_f32 v187, v187, v123, -v249
    v_mul_f32 v246, v204, v140
    v_mul_f32 v204, v204, v124
    v_fmac_f32 v204, v188, v140
    v_fma_f32 v188, v188, v124, -v246
    v_mul_f32 v247, v205, v141
    v_mul_f32 v205, v205, v125
    v_fmac_f32 v205, v189, v141
    v_fma_f32 v189, v189, v125, -v247
    v_mul_f32 v248, v206, v142
    v_mul_f32 v206, v206, v126
    v_fmac_f32 v206, v190, v142
    v_fma_f32 v190, v190, v126, -v248
    v_mul_f32 v249, v207, v143
    v_mul_f32 v207, v207, v127
    v_fmac_f32 v207, v191, v143
    v_fma_f32 v191, v191, v127, -v249
    v_cvt_pk_bf16_f32 v64, v176, v177
    v_cvt_pk_bf16_f32 v65, v178, v179
    v_cvt_pk_bf16_f32 v66, v180, v181
    v_cvt_pk_bf16_f32 v67, v182, v183
    v_cvt_pk_bf16_f32 v68, v184, v185
    v_cvt_pk_bf16_f32 v69, v186, v187
    v_cvt_pk_bf16_f32 v70, v188, v189
    v_cvt_pk_bf16_f32 v71, v190, v191
    v_cvt_pk_bf16_f32 v72, v192, v193
    v_cvt_pk_bf16_f32 v73, v194, v195
    v_cvt_pk_bf16_f32 v74, v196, v197
    v_cvt_pk_bf16_f32 v75, v198, v199
    v_cvt_pk_bf16_f32 v76, v200, v201
    v_cvt_pk_bf16_f32 v77, v202, v203
    v_cvt_pk_bf16_f32 v78, v204, v205
    v_cvt_pk_bf16_f32 v79, v206, v207
    s_nop 1
    v_mfma_f32_32x32x16_bf16 v[112:127], v[64:67], v[0:3], 0
    v_mfma_f32_32x32x16_bf16 v[128:143], v[72:75], v[0:3], 0
    v_mfma_f32_32x32x16_bf16 v[112:127], v[72:75], v[16:19], v[112:127]
    v_mfma_f32_32x32x16_bf16 v[128:143], v[64:67], v[8:11], v[128:143]
    v_mfma_f32_32x32x16_bf16 v[112:127], v[68:71], v[4:7], v[112:127]
    v_mfma_f32_32x32x16_bf16 v[128:143], v[76:79], v[4:7], v[128:143]
    v_mfma_f32_32x32x16_bf16 v[112:127], v[76:79], v[20:23], v[112:127]
    v_mfma_f32_32x32x16_bf16 v[128:143], v[68:71], v[12:15], v[128:143]
    v_and_b32 v240, 31, v255
    v_and_b32 v241, 7, v255
    v_lshrrev_b32 v242, 5, v255
    v_lshlrev_b32 v242, 1, v242
    v_xor_b32 v241, v241, v242
    v_lshlrev_b32 v240, 7, v240
    v_add_u32 v240, s51, v240
    v_xor_b32 v243, 0, v241
    v_lshl_add_u32 v246, v243, 4, v240
    v_xor_b32 v243, 1, v241
    v_lshl_add_u32 v247, v243, 4, v240
    v_xor_b32 v243, 4, v241
    v_lshl_add_u32 v248, v243, 4, v240
    v_xor_b32 v243, 5, v241
    v_lshl_add_u32 v249, v243, 4, v240
    v_lshrrev_b32 v240, 3, v255
    s_lshl_b32 s33, s42, 3
    v_add_u32 v240, s33, v240
    v_xor_b32 v241, v240, v255
    v_and_b32 v241, 7, v241
    s_lshl_b32 s32, s41, 15
    s_add_u32 s32, s32, 43008
    v_lshlrev_b32 v240, 7, v240
    v_lshl_add_u32 v240, v241, 4, v240
    v_add_u32 v250, s32, v240
    s_mul_i32 s30, s40, 4224
    s_lshl_b32 s33, s42, 10
    s_add_u32 s30, s30, s33
    s_add_u32 s31, s30, 337920
    s_cmp_eq_u32 s40, 0
    s_cselect_b32 s31, 0x40000000, s31
    s_cselect_b32 s35, 0, 1.0
    s_cmp_eq_u32 s40, 80
    s_cselect_b32 s31, 0x40000000, s31
    v_lshlrev_b32 v244, 4, v255
    v_add_u32 v245, s31, v244
    v_add_u32 v244, s30, v244
    s_nop 7
    v_cvt_pk_bf16_f32 v48, v80, v81
    v_cvt_pk_bf16_f32 v49, v82, v83
    v_cvt_pk_bf16_f32 v50, v84, v85
    v_cvt_pk_bf16_f32 v51, v86, v87
    v_cvt_pk_bf16_f32 v52, v88, v89
    v_cvt_pk_bf16_f32 v53, v90, v91
    v_cvt_pk_bf16_f32 v54, v92, v93
    v_cvt_pk_bf16_f32 v55, v94, v95
    ds_write_b128 v246, v[48:51] offset:0
    ds_write_b128 v247, v[52:55] offset:0
    v_cvt_pk_bf16_f32 v56, v96, v97
    v_cvt_pk_bf16_f32 v57, v98, v99
    v_cvt_pk_bf16_f32 v58, v100, v101
    v_cvt_pk_bf16_f32 v59, v102, v103
    v_cvt_pk_bf16_f32 v60, v104, v105
    v_cvt_pk_bf16_f32 v61, v106, v107
    v_cvt_pk_bf16_f32 v62, v108, v109
    v_cvt_pk_bf16_f32 v63, v110, v111
    ds_write_b128 v246, v[56:59] offset:4096
    ds_write_b128 v247, v[60:63] offset:4096
    v_cvt_pk_bf16_f32 v64, v112, v113
    v_cvt_pk_bf16_f32 v65, v114, v115
    v_cvt_pk_bf16_f32 v66, v116, v117
    v_cvt_pk_bf16_f32 v67, v118, v119
    v_cvt_pk_bf16_f32 v68, v120, v121
    v_cvt_pk_bf16_f32 v69, v122, v123
    v_cvt_pk_bf16_f32 v70, v124, v125
    v_cvt_pk_bf16_f32 v71, v126, v127
    ds_write_b128 v248, v[64:67] offset:0
    ds_write_b128 v249, v[68:71] offset:0
    v_cvt_pk_bf16_f32 v72, v128, v129
    v_cvt_pk_bf16_f32 v73, v130, v131
    v_cvt_pk_bf16_f32 v74, v132, v133
    v_cvt_pk_bf16_f32 v75, v134, v135
    v_cvt_pk_bf16_f32 v76, v136, v137
    v_cvt_pk_bf16_f32 v77, v138, v139
    v_cvt_pk_bf16_f32 v78, v140, v141
    v_cvt_pk_bf16_f32 v79, v142, v143
    ds_write_b128 v248, v[72:75] offset:4096
    ds_write_b128 v249, v[76:79] offset:4096
    s_waitcnt lgkmcnt(0)
    s_barrier
    ds_read_b128 v[144:147], v250 offset:0
    ds_read_b128 v[148:151], v250 offset:4096
    ds_read_b128 v[152:155], v250 offset:8192
    ds_read_b128 v[156:159], v250 offset:12288
    ds_read_b128 v[160:163], v250 offset:16384
    ds_read_b128 v[164:167], v250 offset:20480
    ds_read_b128 v[168:171], v250 offset:24576
    ds_read_b128 v[172:175], v250 offset:28672
    s_waitcnt lgkmcnt(7)
    v_lshlrev_b32 v0, 16, v144
    v_and_b32 v1, 0xffff0000, v144
    v_lshlrev_b32 v2, 16, v145
    v_and_b32 v3, 0xffff0000, v145
    v_lshlrev_b32 v4, 16, v146
    v_and_b32 v5, 0xffff0000, v146
    v_lshlrev_b32 v6, 16, v147
    v_and_b32 v7, 0xffff0000, v147
    s_waitcnt lgkmcnt(6)
    v_lshlrev_b32 v8, 16, v148
    v_and_b32 v9, 0xffff0000, v148
    v_lshlrev_b32 v10, 16, v149
    v_and_b32 v11, 0xffff0000, v149
    v_lshlrev_b32 v12, 16, v150
    v_and_b32 v13, 0xffff0000, v150
    v_lshlrev_b32 v14, 16, v151
    v_and_b32 v15, 0xffff0000, v151
    s_waitcnt lgkmcnt(5)
    v_lshlrev_b32 v16, 16, v152
    v_and_b32 v17, 0xffff0000, v152
    v_lshlrev_b32 v18, 16, v153
    v_and_b32 v19, 0xffff0000, v153
    v_lshlrev_b32 v20, 16, v154
    v_and_b32 v21, 0xffff0000, v154
    v_lshlrev_b32 v22, 16, v155
    v_and_b32 v23, 0xffff0000, v155
    s_waitcnt lgkmcnt(4)
    v_lshlrev_b32 v24, 16, v156
    v_and_b32 v25, 0xffff0000, v156
    v_lshlrev_b32 v26, 16, v157
    v_and_b32 v27, 0xffff0000, v157
    v_lshlrev_b32 v28, 16, v158
    v_and_b32 v29, 0xffff0000, v158
    v_lshlrev_b32 v30, 16, v159
    v_and_b32 v31, 0xffff0000, v159
    s_waitcnt lgkmcnt(3)
    v_lshlrev_b32 v32, 16, v160
    v_and_b32 v33, 0xffff0000, v160
    v_lshlrev_b32 v34, 16, v161
    v_and_b32 v35, 0xffff0000, v161
    v_lshlrev_b32 v36, 16, v162
    v_and_b32 v37, 0xffff0000, v162
    v_lshlrev_b32 v38, 16, v163
    v_and_b32 v39, 0xffff0000, v163
    s_waitcnt lgkmcnt(2)
    v_lshlrev_b32 v40, 16, v164
    v_and_b32 v41, 0xffff0000, v164
    v_lshlrev_b32 v42, 16, v165
    v_and_b32 v43, 0xffff0000, v165
    v_lshlrev_b32 v44, 16, v166
    v_and_b32 v45, 0xffff0000, v166
    v_lshlrev_b32 v46, 16, v167
    v_and_b32 v47, 0xffff0000, v167
    s_waitcnt lgkmcnt(1)
    v_lshlrev_b32 v48, 16, v168
    v_and_b32 v49, 0xffff0000, v168
    v_lshlrev_b32 v50, 16, v169
    v_and_b32 v51, 0xffff0000, v169
    v_lshlrev_b32 v52, 16, v170
    v_and_b32 v53, 0xffff0000, v170
    v_lshlrev_b32 v54, 16, v171
    v_and_b32 v55, 0xffff0000, v171
    s_waitcnt lgkmcnt(0)
    v_lshlrev_b32 v56, 16, v172
    v_and_b32 v57, 0xffff0000, v172
    v_lshlrev_b32 v58, 16, v173
    v_and_b32 v59, 0xffff0000, v173
    v_lshlrev_b32 v60, 16, v174
    v_and_b32 v61, 0xffff0000, v174
    v_lshlrev_b32 v62, 16, v175
    v_and_b32 v63, 0xffff0000, v175
    s_mov_b32 s36, s35
    s_mov_b32 s37, s35
    s_mov_b32 s4, s44
    s_mov_b32 s5, s44
    s_mov_b32 s6, s45
    s_mov_b32 s7, s45
    s_mov_b32 s8, s46
    s_mov_b32 s9, s46
    s_mov_b32 s10, s47
    s_mov_b32 s11, s47
    s_mov_b32 s12, s48
    s_mov_b32 s13, s48
    s_mov_b32 s14, s49
    s_mov_b32 s15, s49
    v_pk_mul_f32 v[8:9], v[8:9], s[36:37]
    v_pk_mul_f32 v[40:41], v[40:41], s[36:37]
    v_pk_add_f32 v[176:177], v[0:1], v[32:33]
    v_pk_add_f32 v[178:179], v[8:9], v[40:41] neg_lo:[0,1] neg_hi:[0,1]
    v_pk_add_f32 v[180:181], v[0:1], v[32:33] neg_lo:[0,1] neg_hi:[0,1]
    v_pk_add_f32 v[182:183], v[8:9], v[40:41]
    v_pk_add_f32 v[184:185], v[16:17], v[48:49]
    v_pk_add_f32 v[186:187], v[24:25], v[56:57] neg_lo:[0,1] neg_hi:[0,1]
    v_pk_add_f32 v[188:189], v[16:17], v[48:49] neg_lo:[0,1] neg_hi:[0,1]
    v_pk_add_f32 v[190:191], v[24:25], v[56:57]
    v_pk_add_f32 v[64:65], v[176:177], v[184:185]
    v_pk_add_f32 v[72:73], v[178:179], v[186:187]
    v_pk_add_f32 v[32:33], v[176:177], v[184:185] neg_lo:[0,1] neg_hi:[0,1]
    v_pk_add_f32 v[40:41], v[178:179], v[186:187] neg_lo:[0,1] neg_hi:[0,1]
    v_pk_add_f32 v[16:17], v[180:181], v[190:191] neg_lo:[0,1] neg_hi:[0,1]
    v_pk_add_f32 v[24:25], v[182:183], v[188:189]
    v_pk_add_f32 v[48:49], v[180:181], v[190:191]
    v_pk_add_f32 v[56:57], v[182:183], v[188:189] neg_lo:[0,1] neg_hi:[0,1]
    v_pk_mul_f32 v[80:81], v[16:17], s[4:5]
    v_pk_mul_f32 v[88:89], v[24:25], s[4:5]
    v_pk_mul_f32 v[96:97], v[32:33], s[8:9]
    v_pk_mul_f32 v[104:105], v[40:41], s[8:9]
    v_pk_mul_f32 v[112:113], v[48:49], s[12:13]
    v_pk_mul_f32 v[120:121], v[56:57], s[12:13]
    v_pk_fma_f32 v[80:81], v[24:25], s[6:7], v[80:81] neg_lo:[1,0,0] neg_hi:[1,0,0]
    v_pk_fma_f32 v[88:89], v[16:17], s[6:7], v[88:89]
    v_pk_fma_f32 v[96:97], v[40:41], s[10:11], v[96:97] neg_lo:[1,0,0] neg_hi:[1,0,0]
    v_pk_fma_f32 v[104:105], v[32:33], s[10:11], v[104:105]
    v_pk_fma_f32 v[112:113], v[56:57], s[14:15], v[112:113] neg_lo:[1,0,0] neg_hi:[1,0,0]
    v_pk_fma_f32 v[120:121], v[48:49], s[14:15], v[120:121]
    v_pk_mul_f32 v[10:11], v[10:11], s[36:37]
    v_pk_mul_f32 v[42:43], v[42:43], s[36:37]
    v_pk_add_f32 v[192:193], v[2:3], v[34:35]
    v_pk_add_f32 v[194:195], v[10:11], v[42:43] neg_lo:[0,1] neg_hi:[0,1]
    v_pk_add_f32 v[196:197], v[2:3], v[34:35] neg_lo:[0,1] neg_hi:[0,1]
    v_pk_add_f32 v[198:199], v[10:11], v[42:43]
    v_pk_add_f32 v[200:201], v[18:19], v[50:51]
    v_pk_add_f32 v[202:203], v[26:27], v[58:59] neg_lo:[0,1] neg_hi:[0,1]
    v_pk_add_f32 v[204:205], v[18:19], v[50:51] neg_lo:[0,1] neg_hi:[0,1]
    v_pk_add_f32 v[206:207], v[26:27], v[58:59]
    v_pk_add_f32 v[66:67], v[192:193], v[200:201]
    v_pk_add_f32 v[74:75], v[194:195], v[202:203]
    v_pk_add_f32 v[34:35], v[192:193], v[200:201] neg_lo:[0,1] neg_hi:[0,1]
    v_pk_add_f32 v[42:43], v[194:195], v[202:203] neg_lo:[0,1] neg_hi:[0,1]
    v_pk_add_f32 v[18:19], v[196:197], v[206:207] neg_lo:[0,1] neg_hi:[0,1]
    v_pk_add_f32 v[26:27], v[198:199], v[204:205]
    v_pk_add_f32 v[50:51], v[196:197], v[206:207]
    v_pk_add_f32 v[58:59], v[198:199], v[204:205] neg_lo:[0,1] neg_hi:[0,1]
    v_pk_mul_f32 v[82:83], v[18:19], s[4:5]
    v_pk_mul_f32 v[90:91], v[26:27], s[4:5]
    v_pk_mul_f32 v[98:99], v[34:35], s[8:9]
    v_pk_mul_f32 v[106:107], v[42:43], s[8:9]
    v_pk_mul_f32 v[114:115], v[50:51], s[12:13]
    v_pk_mul_f32 v[122:123], v[58:59], s[12:13]
    v_pk_fma_f32 v[82:83], v[26:27], s[6:7], v[82:83] neg_lo:[1,0,0] neg_hi:[1,0,0]
    v_pk_fma_f32 v[90:91], v[18:19], s[6:7], v[90:91]
    v_pk_fma_f32 v[98:99], v[42:43], s[10:11], v[98:99] neg_lo:[1,0,0] neg_hi:[1,0,0]
    v_pk_fma_f32 v[106:107], v[34:35], s[10:11], v[106:107]
    v_pk_fma_f32 v[114:115], v[58:59], s[14:15], v[114:115] neg_lo:[1,0,0] neg_hi:[1,0,0]
    v_pk_fma_f32 v[122:123], v[50:51], s[14:15], v[122:123]
    v_pk_mul_f32 v[12:13], v[12:13], s[36:37]
    v_pk_mul_f32 v[44:45], v[44:45], s[36:37]
    v_pk_add_f32 v[176:177], v[4:5], v[36:37]
    v_pk_add_f32 v[178:179], v[12:13], v[44:45] neg_lo:[0,1] neg_hi:[0,1]
    v_pk_add_f32 v[180:181], v[4:5], v[36:37] neg_lo:[0,1] neg_hi:[0,1]
    v_pk_add_f32 v[182:183], v[12:13], v[44:45]
    v_pk_add_f32 v[184:185], v[20:21], v[52:53]
    v_pk_add_f32 v[186:187], v[28:29], v[60:61] neg_lo:[0,1] neg_hi:[0,1]
    v_pk_add_f32 v[188:189], v[20:21], v[52:53] neg_lo:[0,1] neg_hi:[0,1]
    v_pk_add_f32 v[190:191], v[28:29], v[60:61]
    v_pk_add_f32 v[68:69], v[176:177], v[184:185]
    v_pk_add_f32 v[76:77], v[178:179], v[186:187]
    v_pk_add_f32 v[36:37], v[176:177], v[184:185] neg_lo:[0,1] neg_hi:[0,1]
    v_pk_add_f32 v[44:45], v[178:179], v[186:187] neg_lo:[0,1] neg_hi:[0,1]
    v_pk_add_f32 v[20:21], v[180:181], v[190:191] neg_lo:[0,1] neg_hi:[0,1]
    v_pk_add_f32 v[28:29], v[182:183], v[188:189]
    v_pk_add_f32 v[52:53], v[180:181], v[190:191]
    v_pk_add_f32 v[60:61], v[182:183], v[188:189] neg_lo:[0,1] neg_hi:[0,1]
    v_pk_mul_f32 v[84:85], v[20:21], s[4:5]
    v_pk_mul_f32 v[92:93], v[28:29], s[4:5]
    v_pk_mul_f32 v[100:101], v[36:37], s[8:9]
    v_pk_mul_f32 v[108:109], v[44:45], s[8:9]
    v_pk_mul_f32 v[116:117], v[52:53], s[12:13]
    v_pk_mul_f32 v[124:125], v[60:61], s[12:13]
    v_pk_fma_f32 v[84:85], v[28:29], s[6:7], v[84:85] neg_lo:[1,0,0] neg_hi:[1,0,0]
    v_pk_fma_f32 v[92:93], v[20:21], s[6:7], v[92:93]
    v_pk_fma_f32 v[100:101], v[44:45], s[10:11], v[100:101] neg_lo:[1,0,0] neg_hi:[1,0,0]
    v_pk_fma_f32 v[108:109], v[36:37], s[10:11], v[108:109]
    v_pk_fma_f32 v[116:117], v[60:61], s[14:15], v[116:117] neg_lo:[1,0,0] neg_hi:[1,0,0]
    v_pk_fma_f32 v[124:125], v[52:53], s[14:15], v[124:125]
    v_pk_mul_f32 v[14:15], v[14:15], s[36:37]
    v_pk_mul_f32 v[46:47], v[46:47], s[36:37]
    v_pk_add_f32 v[192:193], v[6:7], v[38:39]
    v_pk_add_f32 v[194:195], v[14:15], v[46:47] neg_lo:[0,1] neg_hi:[0,1]
    v_pk_add_f32 v[196:197], v[6:7], v[38:39] neg_lo:[0,1] neg_hi:[0,1]
    v_pk_add_f32 v[198:199], v[14:15], v[46:47]
    v_pk_add_f32 v[200:201], v[22:23], v[54:55]
    v_pk_add_f32 v[202:203], v[30:31], v[62:63] neg_lo:[0,1] neg_hi:[0,1]
    v_pk_add_f32 v[204:205], v[22:23], v[54:55] neg_lo:[0,1] neg_hi:[0,1]
    v_pk_add_f32 v[206:207], v[30:31], v[62:63]
    v_pk_add_f32 v[70:71], v[192:193], v[200:201]
    v_pk_add_f32 v[78:79], v[194:195], v[202:203]
    v_pk_add_f32 v[38:39], v[192:193], v[200:201] neg_lo:[0,1] neg_hi:[0,1]
    v_pk_add_f32 v[46:47], v[194:195], v[202:203] neg_lo:[0,1] neg_hi:[0,1]
    v_pk_add_f32 v[22:23], v[196:197], v[206:207] neg_lo:[0,1] neg_hi:[0,1]
    v_pk_add_f32 v[30:31], v[198:199], v[204:205]
    v_pk_add_f32 v[54:55], v[196:197], v[206:207]
    v_pk_add_f32 v[62:63], v[198:199], v[204:205] neg_lo:[0,1] neg_hi:[0,1]
    v_pk_mul_f32 v[86:87], v[22:23], s[4:5]
    v_pk_mul_f32 v[94:95], v[30:31], s[4:5]
    v_pk_mul_f32 v[102:103], v[38:39], s[8:9]
    v_pk_mul_f32 v[110:111], v[46:47], s[8:9]
    v_pk_mul_f32 v[118:119], v[54:55], s[12:13]
    v_pk_mul_f32 v[126:127], v[62:63], s[12:13]
    v_pk_fma_f32 v[86:87], v[30:31], s[6:7], v[86:87] neg_lo:[1,0,0] neg_hi:[1,0,0]
    v_pk_fma_f32 v[94:95], v[22:23], s[6:7], v[94:95]
    v_pk_fma_f32 v[102:103], v[46:47], s[10:11], v[102:103] neg_lo:[1,0,0] neg_hi:[1,0,0]
    v_pk_fma_f32 v[110:111], v[38:39], s[10:11], v[110:111]
    v_pk_fma_f32 v[118:119], v[62:63], s[14:15], v[118:119] neg_lo:[1,0,0] neg_hi:[1,0,0]
    v_pk_fma_f32 v[126:127], v[54:55], s[14:15], v[126:127]
    s_add_u32 s12, s76, 29360128
    s_addc_u32 s13, s77, 0
    s_mov_b32 s14, 16384
    s_mov_b32 s15, 0x20000
    s_and_b32 s31, s2, 7
    s_lshr_b32 s32, s2, 3
    s_and_b32 s29, s31, 3
    s_lshl_b32 s29, s29, 3
    s_and_b32 s33, s32, 7
    s_add_u32 s29, s29, s33
    s_lshr_b32 s33, s29, 1
    s_lshl_b32 s33, s33, 7
    v_lshlrev_b32 v210, 3, v255
    v_add_u32 v218, 10240, v210
    v_add_u32 v210, s33, v210
    buffer_load_dwordx2 v[208:209], v210, s[12:15], 0 offen sc1
    buffer_load_dwordx2 v[212:213], v218, s[12:15], 0 offen offset:0 sc1
    v_cvt_pk_bf16_f32 v144, v64, v65
    v_cvt_pk_bf16_f32 v145, v66, v67
    v_cvt_pk_bf16_f32 v146, v68, v69
    v_cvt_pk_bf16_f32 v147, v70, v71
    s_mov_b32 s32, 0
    buffer_store_dwordx4 v[144:147], v244, s[20:23], s32 offen sc1
    v_cvt_pk_bf16_f32 v148, v72, v73
    v_cvt_pk_bf16_f32 v149, v74, v75
    v_cvt_pk_bf16_f32 v150, v76, v77
    v_cvt_pk_bf16_f32 v151, v78, v79
    s_mov_b32 s32, 0
    buffer_store_dwordx4 v[148:151], v245, s[20:23], s32 offen sc1
    v_cvt_pk_bf16_f32 v152, v80, v81
    v_cvt_pk_bf16_f32 v153, v82, v83
    v_cvt_pk_bf16_f32 v154, v84, v85
    v_cvt_pk_bf16_f32 v155, v86, v87
    s_mov_b32 s32, 675840
    buffer_store_dwordx4 v[152:155], v244, s[20:23], s32 offen sc1
    v_cvt_pk_bf16_f32 v156, v88, v89
    v_cvt_pk_bf16_f32 v157, v90, v91
    v_cvt_pk_bf16_f32 v158, v92, v93
    v_cvt_pk_bf16_f32 v159, v94, v95
    s_mov_b32 s32, 675840
    buffer_store_dwordx4 v[156:159], v245, s[20:23], s32 offen sc1
    v_cvt_pk_bf16_f32 v160, v96, v97
    v_cvt_pk_bf16_f32 v161, v98, v99
    v_cvt_pk_bf16_f32 v162, v100, v101
    v_cvt_pk_bf16_f32 v163, v102, v103
    s_mov_b32 s32, 1351680
    buffer_store_dwordx4 v[160:163], v244, s[20:23], s32 offen sc1
    v_cvt_pk_bf16_f32 v164, v104, v105
    v_cvt_pk_bf16_f32 v165, v106, v107
    v_cvt_pk_bf16_f32 v166, v108, v109
    v_cvt_pk_bf16_f32 v167, v110, v111
    s_mov_b32 s32, 1351680
    buffer_store_dwordx4 v[164:167], v245, s[20:23], s32 offen sc1
    v_cvt_pk_bf16_f32 v168, v112, v113
    v_cvt_pk_bf16_f32 v169, v114, v115
    v_cvt_pk_bf16_f32 v170, v116, v117
    v_cvt_pk_bf16_f32 v171, v118, v119
    s_mov_b32 s32, 2027520
    buffer_store_dwordx4 v[168:171], v244, s[20:23], s32 offen sc1
    v_cvt_pk_bf16_f32 v172, v120, v121
    v_cvt_pk_bf16_f32 v173, v122, v123
    v_cvt_pk_bf16_f32 v174, v124, v125
    v_cvt_pk_bf16_f32 v175, v126, v127
    s_mov_b32 s32, 2027520
    buffer_store_dwordx4 v[172:175], v245, s[20:23], s32 offen sc1
    s_setprio 0
    s_mov_b32 s62, 1
L_final_3:
    s_and_b32 s31, s2, 7
    s_lshr_b32 s32, s2, 3
    s_and_b32 s29, s31, 3
    s_lshl_b32 s29, s29, 3
    s_and_b32 s33, s32, 7
    s_add_u32 s29, s29, s33
    s_lshr_b32 s30, s31, 2
    s_lshl_b32 s30, s30, 2
    s_lshr_b32 s33, s32, 3
    s_add_u32 s30, s30, s33
    s_cmp_ge_u32 s28, 4
    s_cbranch_scc1 L_finload_4
    v_mbcnt_lo_u32_b32 v0, -1, 0
    v_mbcnt_hi_u32_b32 v0, -1, v0
    s_cmp_lg_u32 s62, 1
    s_cbranch_scc1 L_nox3_85
    s_barrier
L_nox3_85:
    s_cmp_lg_u32 s54, 0
    s_cbranch_scc1 L_ba_86
    s_cmp_lg_u32 s28, 1
    s_cbranch_scc1 L_nofw_87
    s_add_u32 s12, s76, 29360128
    s_addc_u32 s13, s77, 0
    s_mov_b32 s14, 16384
    s_mov_b32 s15, 0x20000
    v_lshlrev_b32 v2, 3, v0
    v_add_u32 v2, 10240, v2
    buffer_load_dwordx2 v[4:5], v2, s[12:15], 0 offen offset:0 sc1
    s_waitcnt vmcnt(0)
    s_mov_b32 s44, 0x7fffff
    s_mov_b32 s45, 0
    s_mov_b32 s37, 1
    v_cmp_eq_u32 vcc, s78, v4
    v_cmp_eq_u32 s[46:47], s79, v5
    s_nop 3
    s_and_b64 vcc, vcc, s[46:47]
    s_and_b64 vcc, vcc, s[44:45]
    s_cmp_eq_u64 vcc, s[44:45]
    s_cselect_b32 s37, s37, 0
    v_mov_b32 v2, 147456
    v_mov_b32 v3, s37
    ds_write_b32 v2, v3
    s_waitcnt lgkmcnt(0)
L_nofw_87:
    s_waitcnt vmcnt(0)
L_ba_86:
    s_barrier
    s_cmp_lg_u32 s28, 0
    s_cbranch_scc1 L_nowait_88
    s_add_u32 s12, s76, 29360128
    s_addc_u32 s13, s77, 0
    s_mov_b32 s14, 16384
    s_mov_b32 s15, 0x20000
    s_lshr_b32 s37, s29, 1
    s_lshl_b32 s37, s37, 7
    v_lshlrev_b32 v2, 3, v0
    v_add_u32 v2, s37, v2
    s_mov_b32 s44, 0xfff
    s_mov_b32 s45, 0
    s_cmp_lg_u32 s54, 0
    s_cbranch_scc1 L_nosig_89
    v_mov_b32 v6, s78
    v_mov_b32 v7, s79
    v_mov_b32 v8, s53
    s_mov_b64 s[36:37], exec
    s_mov_b64 exec, 1
    buffer_store_dwordx2 v[6:7], v8, s[12:15], 0 offen sc1
    s_mov_b64 exec, s[36:37]
    s_branch L_poll_90
L_nosig_89:
    s_cmp_eq_u32 s62, 0
    s_cbranch_scc1 L_poll_90
    s_waitcnt vmcnt(9)
    v_cmp_eq_u32 vcc, s78, v208
    v_cmp_eq_u32 s[46:47], s79, v209
    s_nop 3
    s_and_b64 vcc, vcc, s[46:47]
    s_and_b64 vcc, vcc, s[44:45]
    s_cmp_eq_u64 vcc, s[44:45]
    s_cbranch_scc1 L_nowait_88
L_poll_90:
    s_cmp_eq_u32 s54, 1
    s_cselect_b32 s37, 1, 0
    s_cmp_eq_u32 s62, 0
    s_cselect_b32 s37, s37, 0
    s_cmp_eq_u32 s37, 1
    s_cbranch_scc1 L_slowpoll_91
    s_mov_b32 s48, 65536
L_wf_92:
    buffer_load_dwordx2 v[4:5], v2, s[12:15], 0 offen sc1
    s_waitcnt vmcnt(0)
    v_cmp_eq_u32 vcc, s78, v4
    v_cmp_eq_u32 s[46:47], s79, v5
    s_nop 3
    s_and_b64 vcc, vcc, s[46:47]
    s_and_b64 vcc, vcc, s[44:45]
    s_cmp_eq_u64 vcc, s[44:45]
    s_cbranch_scc1 L_wfd_93
    s_sleep 1
    s_sub_u32 s48, s48, 1
    s_cmp_lg_u32 s48, 0
    s_cbranch_scc1 L_wf_92
L_wfd_93:
    s_waitcnt vmcnt(0)
    s_branch L_nowait_88
L_slowpoll_91:
    s_mov_b32 s48, 65536
L_wf_94:
    buffer_load_dwordx2 v[4:5], v2, s[12:15], 0 offen sc1
    s_waitcnt vmcnt(0)
    v_cmp_eq_u32 vcc, s78, v4
    v_cmp_eq_u32 s[46:47], s79, v5
    s_nop 3
    s_and_b64 vcc, vcc, s[46:47]
    s_and_b64 vcc, vcc, s[44:45]
    s_cmp_eq_u64 vcc, s[44:45]
    s_cbranch_scc1 L_wfd_95
    s_sleep 12
    s_sub_u32 s48, s48, 1
    s_cmp_lg_u32 s48, 0
    s_cbranch_scc1 L_wf_94
L_wfd_95:
    s_waitcnt vmcnt(0)
L_nowait_88:
    s_barrier
    s_and_b32 s33, s28, 1
    s_lshr_b32 s34, s28, 1
    s_add_u32 s20, s76, 25165824
    s_addc_u32 s21, s77, 0
    s_mov_b32 s22, 16384
    s_mov_b32 s23, 0x20000
    s_mov_b32 s24, s72
    s_mov_b32 s25, s73
    s_mov_b32 s26, 2621440
    s_mov_b32 s27, 0x20000
    s_getpc_b64 s[16:17]
    s_add_u32 s16, s16, tbl_t160i@rel32@lo+4
    s_addc_u32 s17, s17, tbl_t160i@rel32@hi+12
    s_mov_b32 s18, 81920
    s_mov_b32 s19, 0x20000
    s_lshl_b32 s37, s30, 1
    s_add_u32 s37, s37, s34
    s_mul_i32 s37, s37, 5120
    v_lshlrev_b32 v2, 4, v0
    v_add_u32 v2, s37, v2
    buffer_load_dwordx4 v[112:115], v2, s[16:19], 0 offen offset:0
    buffer_load_dwordx4 v[116:119], v2, s[16:19], 0 offen offset:1024
    buffer_load_dwordx4 v[120:123], v2, s[16:19], 0 offen offset:2048
    buffer_load_dwordx4 v[124:127], v2, s[16:19], 0 offen offset:3072
    v_add_u32 v2, 4096, v2
    buffer_load_dwordx4 v[128:131], v2, s[16:19], 0 offen offset:0
    v_and_b32 v1, 15, v0
    v_lshrrev_b32 v2, 4, v0
    v_bfe_u32 v3, v0, 2, 2
    v_and_b32 v4, 3, v0
    v_and_b32 v5, 1, v2
    v_lshrrev_b32 v6, 1, v2
    v_lshlrev_b32 v8, 3, v4
    v_lshlrev_b32 v7, 4, v6
    v_lshl_add_u32 v7, v5, 2, v7
    v_add_u32 v7, v7, v3
    v_mul_u32_u24 v7, 160, v7
    s_mul_i32 s37, s34, 96
    v_add3_u32 v96, v7, v8, s37
    s_lshl_b32 s37, s33, 13
    s_add_u32 s37, s37, 20480
    v_lshlrev_b32 v9, 8, v1
    v_add_u32 v9, s37, v9
    v_or_b32 v10, 0, v2
    v_xor_b32 v10, v10, v1
    v_lshl_add_u32 v97, v10, 4, v9
    v_or_b32 v10, 4, v2
    v_xor_b32 v10, v10, v1
    v_lshl_add_u32 v98, v10, 4, v9
    v_or_b32 v10, 8, v2
    v_xor_b32 v10, v10, v1
    v_lshl_add_u32 v99, v10, 4, v9
    v_or_b32 v10, 12, v2
    v_xor_b32 v10, v10, v1
    v_lshl_add_u32 v100, v10, 4, v9
    v_lshl_add_u32 v9, v2, 3, v3
    v_lshlrev_b32 v9, 7, v9
    v_add_u32 v9, v9, v8
    v_add_u32 v9, 20480, v9
    v_xor_b32 v10, v5, v6
    v_lshlrev_b32 v10, 1, v10
    v_lshrrev_b32 v11, 1, v3
    v_or_b32 v10, v10, v11
    s_lshl_b32 s37, s33, 1
    s_add_u32 s37, s37, 0
    v_xor_b32 v11, s37, v10
    v_lshl_add_u32 v101, v11, 5, v9
    v_subrev_u32 v156, 20480, v101
    s_lshl_b32 s37, s33, 1
    s_add_u32 s37, s37, 1
    v_xor_b32 v11, s37, v10
    v_lshl_add_u32 v102, v11, 5, v9
    v_subrev_u32 v157, 20480, v102
    s_lshl_b32 s37, s33, 5
    s_add_u32 s37, s37, 0
    v_add_u32 v9, s37, v1
    v_and_b32 v10, 35, v9
    v_bfe_u32 v11, v9, 2, 2
    v_lshl_add_u32 v10, v11, 3, v10
    v_bfe_u32 v11, v9, 4, 1
    v_lshl_add_u32 v10, v11, 2, v10
    s_lshl_b32 s37, s29, 6
    v_add_u32 v10, s37, v10
    v_lshlrev_b32 v108, 3, v10
    v_mul_u32_u24 v10, 1280, v10
    s_mul_i32 s37, s30, 160
    s_mul_i32 s38, s34, 96
    s_add_u32 s37, s37, s38
    v_lshlrev_b32 v11, 3, v2
    v_add3_u32 v110, v10, v11, s37
    s_lshl_b32 s37, s33, 5
    s_add_u32 s37, s37, 16
    v_add_u32 v9, s37, v1
    v_and_b32 v10, 35, v9
    v_bfe_u32 v11, v9, 2, 2
    v_lshl_add_u32 v10, v11, 3, v10
    v_bfe_u32 v11, v9, 4, 1
    v_lshl_add_u32 v10, v11, 2, v10
    s_lshl_b32 s37, s29, 6
    v_add_u32 v10, s37, v10
    v_lshlrev_b32 v109, 3, v10
    v_mul_u32_u24 v10, 1280, v10
    s_mul_i32 s37, s30, 160
    s_mul_i32 s38, s34, 96
    s_add_u32 s37, s37, s38
    v_lshlrev_b32 v11, 3, v2
    v_add3_u32 v111, v10, v11, s37
    v_mov_b32 v132, 0
    v_mov_b32 v133, 0
    v_mov_b32 v134, 0
    v_mov_b32 v135, 0
    v_mov_b32 v136, 0
    v_mov_b32 v137, 0
    v_mov_b32 v138, 0
    v_mov_b32 v139, 0
    v_mov_b32 v140, 0
    v_mov_b32 v141, 0
    v_mov_b32 v142, 0
    v_mov_b32 v143, 0
    v_mov_b32 v144, 0
    v_mov_b32 v145, 0
    v_mov_b32 v146, 0
    v_mov_b32 v147, 0
    v_mov_b32 v148, 0
    v_mov_b32 v149, 0
    v_mov_b32 v150, 0
    v_mov_b32 v151, 0
    v_mov_b32 v152, 0
    v_mov_b32 v153, 0
    v_mov_b32 v154, 0
    v_mov_b32 v155, 0
    v_mov_b32 v160, 0
    v_mov_b32 v161, 0
    v_mov_b32 v162, 0
    v_mov_b32 v163, 0
    v_mov_b32 v164, 0
    v_mov_b32 v165, 0
    v_mov_b32 v166, 0
    v_mov_b32 v167, 0
    v_mov_b32 v168, 0
    v_mov_b32 v169, 0
    v_mov_b32 v170, 0
    v_mov_b32 v171, 0
    v_mov_b32 v172, 0
    v_mov_b32 v173, 0
    v_mov_b32 v174, 0
    v_mov_b32 v175, 0
    v_mov_b32 v176, 0
    v_mov_b32 v177, 0
    v_mov_b32 v178, 0
    v_mov_b32 v179, 0
    v_mov_b32 v180, 0
    v_mov_b32 v181, 0
    v_mov_b32 v182, 0
    v_mov_b32 v183, 0
    v_mov_b32 v184, 0
    v_mov_b32 v185, 0
    v_mov_b32 v186, 0
    v_mov_b32 v187, 0
    v_mov_b32 v188, 0
    v_mov_b32 v189, 0
    v_mov_b32 v190, 0
    v_mov_b32 v191, 0
    s_cmp_lg_u32 s62, 1
    s_cbranch_scc1 L_nou_96
    s_waitcnt vmcnt(5)
    s_lshl_b32 s52, s55, 3
    s_add_u32 s52, s52, 9216
    v_mov_b32 v6, 147464
    v_mov_b32 v7, 1
    s_mov_b64 s[36:37], exec
    s_mov_b64 exec, 1
    ds_add_rtn_u32 v8, v6, v7
    s_mov_b64 exec, s[36:37]
    s_waitcnt lgkmcnt(0)
    v_readfirstlane_b32 s36, v8
    s_nop 3
    s_cmp_lg_u32 s36, 7
    s_cbranch_scc1 L_arr_97
    s_add_u32 s12, s76, 29360128
    s_addc_u32 s13, s77, 0
    s_mov_b32 s14, 16384
    s_mov_b32 s15, 0x20000
    v_mov_b32 v6, s78
    v_mov_b32 v7, s79
    v_mov_b32 v8, s52
    s_mov_b64 s[36:37], exec
    s_mov_b64 exec, 1
    buffer_store_dwordx2 v[6:7], v8, s[12:15], 0 offen sc1
    s_mov_b64 exec, s[36:37]
L_arr_97:
L_nou_96:
    s_cmp_eq_u32 s34, 1
    s_cbranch_scc1 L_dh1_98
    s_mov_b32 s40, 0
    s_barrier
    ds_read_b128 v[28:31], v97 offset:0
    ds_read_b128 v[32:35], v97 offset:4096
    ds_read_b64_tr_b16 v[16:17], v96 offset:0
    ds_read_b64_tr_b16 v[18:19], v96 offset:1280
    ds_read_b64_tr_b16 v[20:21], v96 offset:32
    ds_read_b64_tr_b16 v[22:23], v96 offset:1312
    ds_read_b64_tr_b16 v[24:25], v96 offset:64
    ds_read_b64_tr_b16 v[26:27], v96 offset:1344
    ds_read_b128 v[48:51], v98 offset:0
    ds_read_b128 v[52:55], v98 offset:4096
    ds_read_b64_tr_b16 v[36:37], v96 offset:5120
    ds_read_b64_tr_b16 v[38:39], v96 offset:6400
    ds_read_b64_tr_b16 v[40:41], v96 offset:5152
    ds_read_b64_tr_b16 v[42:43], v96 offset:6432
    ds_read_b64_tr_b16 v[44:45], v96 offset:5184
    ds_read_b64_tr_b16 v[46:47], v96 offset:6464
    s_mov_b32 s41, 11
L_cl_99:
    s_waitcnt lgkmcnt(8)
    v_mfma_f32_16x16x32_bf16 v[132:135], v[16:19], v[28:31], v[132:135]
    ds_read_b128 v[68:71], v99 offset:0
    ds_read_b128 v[72:75], v99 offset:4096
    ds_read_b64_tr_b16 v[56:57], v96 offset:10240
    v_mfma_f32_16x16x32_bf16 v[136:139], v[16:19], v[32:35], v[136:139]
    ds_read_b64_tr_b16 v[58:59], v96 offset:11520
    ds_read_b64_tr_b16 v[60:61], v96 offset:10272
    ds_read_b64_tr_b16 v[62:63], v96 offset:11552
    v_mfma_f32_16x16x32_bf16 v[140:143], v[20:23], v[28:31], v[140:143]
    ds_read_b64_tr_b16 v[64:65], v96 offset:10304
    ds_read_b64_tr_b16 v[66:67], v96 offset:11584
    v_mfma_f32_16x16x32_bf16 v[144:147], v[20:23], v[32:35], v[144:147]
    v_mfma_f32_16x16x32_bf16 v[148:151], v[24:27], v[28:31], v[148:151]
    v_mfma_f32_16x16x32_bf16 v[152:155], v[24:27], v[32:35], v[152:155]
    s_waitcnt lgkmcnt(8)
    v_mfma_f32_16x16x32_bf16 v[132:135], v[36:39], v[48:51], v[132:135]
    ds_read_b128 v[88:91], v100 offset:0
    ds_read_b128 v[92:95], v100 offset:4096
    ds_read_b64_tr_b16 v[76:77], v96 offset:15360
    v_mfma_f32_16x16x32_bf16 v[136:139], v[36:39], v[52:55], v[136:139]
    ds_read_b64_tr_b16 v[78:79], v96 offset:16640
    ds_read_b64_tr_b16 v[80:81], v96 offset:15392
    ds_read_b64_tr_b16 v[82:83], v96 offset:16672
    v_mfma_f32_16x16x32_bf16 v[140:143], v[40:43], v[48:51], v[140:143]
    ds_read_b64_tr_b16 v[84:85], v96 offset:15424
    ds_read_b64_tr_b16 v[86:87], v96 offset:16704
    s_add_u32 s40, s40, 1
    v_mfma_f32_16x16x32_bf16 v[144:147], v[40:43], v[52:55], v[144:147]
    s_cmp_eq_u32 s40, 4
    s_mov_b32 s42, 36864
    s_cselect_b32 s42, 0xfffe5000, s42
    v_mfma_f32_16x16x32_bf16 v[148:151], v[44:47], v[48:51], v[148:151]
    s_cselect_b32 s40, 0, s40
    v_add_u32 v96, s42, v96
    v_add_u32 v97, s42, v97
    v_mfma_f32_16x16x32_bf16 v[152:155], v[44:47], v[52:55], v[152:155]
    v_add_u32 v98, s42, v98
    v_add_u32 v99, s42, v99
    v_add_u32 v100, s42, v100
    v_add_u32 v101, s42, v101
    v_add_u32 v102, s42, v102
    v_add_u32 v156, s42, v156
    v_add_u32 v157, s42, v157
    s_waitcnt lgkmcnt(0)
    s_barrier
    v_mfma_f32_16x16x32_bf16 v[132:135], v[56:59], v[68:71], v[132:135]
    ds_read_b128 v[28:31], v97 offset:0
    ds_read_b128 v[32:35], v97 offset:4096
    ds_read_b64_tr_b16 v[16:17], v96 offset:0
    v_mfma_f32_16x16x32_bf16 v[136:139], v[56:59], v[72:75], v[136:139]
    ds_read_b64_tr_b16 v[18:19], v96 offset:1280
    ds_read_b64_tr_b16 v[20:21], v96 offset:32
    ds_read_b64_tr_b16 v[22:23], v96 offset:1312
    v_mfma_f32_16x16x32_bf16 v[140:143], v[60:63], v[68:71], v[140:143]
    ds_read_b64_tr_b16 v[24:25], v96 offset:64
    ds_read_b64_tr_b16 v[26:27], v96 offset:1344
    ds_read_b128 v[48:51], v98 offset:0
    v_mfma_f32_16x16x32_bf16 v[144:147], v[60:63], v[72:75], v[144:147]
    ds_read_b128 v[52:55], v98 offset:4096
    ds_read_b64_tr_b16 v[36:37], v96 offset:5120
    ds_read_b64_tr_b16 v[38:39], v96 offset:6400
    v_mfma_f32_16x16x32_bf16 v[148:151], v[64:67], v[68:71], v[148:151]
    ds_read_b64_tr_b16 v[40:41], v96 offset:5152
    ds_read_b64_tr_b16 v[42:43], v96 offset:6432
    ds_read_b64_tr_b16 v[44:45], v96 offset:5184
    v_mfma_f32_16x16x32_bf16 v[152:155], v[64:67], v[72:75], v[152:155]
    ds_read_b64_tr_b16 v[46:47], v96 offset:6464
    v_mfma_f32_16x16x32_bf16 v[132:135], v[76:79], v[88:91], v[132:135]
    v_mfma_f32_16x16x32_bf16 v[136:139], v[76:79], v[92:95], v[136:139]
    v_mfma_f32_16x16x32_bf16 v[140:143], v[80:83], v[88:91], v[140:143]
    v_mfma_f32_16x16x32_bf16 v[144:147], v[80:83], v[92:95], v[144:147]
    v_mfma_f32_16x16x32_bf16 v[148:151], v[84:87], v[88:91], v[148:151]
    v_mfma_f32_16x16x32_bf16 v[152:155], v[84:87], v[92:95], v[152:155]
    s_sub_u32 s41, s41, 1
    s_cmp_lg_u32 s41, 0
    s_cbranch_scc1 L_cl_99
    s_waitcnt lgkmcnt(8)
    v_mfma_f32_16x16x32_bf16 v[132:135], v[16:19], v[28:31], v[132:135]
    ds_read_b128 v[68:71], v99 offset:0
    ds_read_b128 v[72:75], v99 offset:4096
    ds_read_b64_tr_b16 v[56:57], v96 offset:10240
    v_mfma_f32_16x16x32_bf16 v[136:139], v[16:19], v[32:35], v[136:139]
    ds_read_b64_tr_b16 v[58:59], v96 offset:11520
    ds_read_b64_tr_b16 v[60:61], v96 offset:10272
    ds_read_b64_tr_b16 v[62:63], v96 offset:11552
    v_mfma_f32_16x16x32_bf16 v[140:143], v[20:23], v[28:31], v[140:143]
    ds_read_b64_tr_b16 v[64:65], v96 offset:10304
    ds_read_b64_tr_b16 v[66:67], v96 offset:11584
    v_mfma_f32_16x16x32_bf16 v[144:147], v[20:23], v[32:35], v[144:147]
    v_mfma_f32_16x16x32_bf16 v[148:151], v[24:27], v[28:31], v[148:151]
    v_mfma_f32_16x16x32_bf16 v[152:155], v[24:27], v[32:35], v[152:155]
    s_waitcnt lgkmcnt(8)
    v_mfma_f32_16x16x32_bf16 v[132:135], v[36:39], v[48:51], v[132:135]
    ds_read_b128 v[88:91], v100 offset:0
    ds_read_b128 v[92:95], v100 offset:4096
    ds_read_b64_tr_b16 v[76:77], v96 offset:15360
    v_mfma_f32_16x16x32_bf16 v[136:139], v[36:39], v[52:55], v[136:139]
    ds_read_b64_tr_b16 v[78:79], v96 offset:16640
    ds_read_b64_tr_b16 v[80:81], v96 offset:15392
    ds_read_b64_tr_b16 v[82:83], v96 offset:16672
    v_mfma_f32_16x16x32_bf16 v[140:143], v[40:43], v[48:51], v[140:143]
    ds_read_b64_tr_b16 v[84:85], v96 offset:15424
    ds_read_b64_tr_b16 v[86:87], v96 offset:16704
    s_add_u32 s40, s40, 1
    v_mfma_f32_16x16x32_bf16 v[144:147], v[40:43], v[52:55], v[144:147]
    s_cmp_eq_u32 s40, 4
    s_mov_b32 s42, 36864
    s_cselect_b32 s42, 0xfffe5000, s42
    v_mfma_f32_16x16x32_bf16 v[148:151], v[44:47], v[48:51], v[148:151]
    s_cselect_b32 s40, 0, s40
    v_add_u32 v96, s42, v96
    v_add_u32 v97, s42, v97
    v_mfma_f32_16x16x32_bf16 v[152:155], v[44:47], v[52:55], v[152:155]
    v_add_u32 v98, s42, v98
    v_add_u32 v99, s42, v99
    v_add_u32 v100, s42, v100
    v_add_u32 v101, s42, v101
    v_add_u32 v102, s42, v102
    v_add_u32 v156, s42, v156
    v_add_u32 v157, s42, v157
    s_waitcnt vmcnt(0)
    s_waitcnt lgkmcnt(0)
    s_barrier
    v_mfma_f32_16x16x32_bf16 v[132:135], v[56:59], v[68:71], v[132:135]
    ds_read_b64_tr_b16 v[28:29], v101 offset:0
    ds_read_b64_tr_b16 v[30:31], v101 offset:512
    ds_read_b64_tr_b16 v[32:33], v102 offset:0
    v_mfma_f32_16x16x32_bf16 v[136:139], v[56:59], v[72:75], v[136:139]
    ds_read_b64_tr_b16 v[34:35], v102 offset:512
    ds_read_b64_tr_b16 v[48:49], v101 offset:4096
    ds_read_b64_tr_b16 v[50:51], v101 offset:4608
    v_mfma_f32_16x16x32_bf16 v[140:143], v[60:63], v[68:71], v[140:143]
    ds_read_b64_tr_b16 v[52:53], v102 offset:4096
    ds_read_b64_tr_b16 v[54:55], v102 offset:4608
    v_mfma_f32_16x16x32_bf16 v[144:147], v[60:63], v[72:75], v[144:147]
    v_mfma_f32_16x16x32_bf16 v[148:151], v[64:67], v[68:71], v[148:151]
    v_mfma_f32_16x16x32_bf16 v[152:155], v[64:67], v[72:75], v[152:155]
    v_mfma_f32_16x16x32_bf16 v[132:135], v[76:79], v[88:91], v[132:135]
    v_mfma_f32_16x16x32_bf16 v[136:139], v[76:79], v[92:95], v[136:139]
    v_mfma_f32_16x16x32_bf16 v[140:143], v[80:83], v[88:91], v[140:143]
    v_mfma_f32_16x16x32_bf16 v[144:147], v[80:83], v[92:95], v[144:147]
    v_mfma_f32_16x16x32_bf16 v[148:151], v[84:87], v[88:91], v[148:151]
    v_mfma_f32_16x16x32_bf16 v[152:155], v[84:87], v[92:95], v[152:155]
    s_waitcnt lgkmcnt(4)
    v_mfma_f32_16x16x32_bf16 v[160:163], v[112:115], v[28:31], v[160:163]
    ds_read_b64_tr_b16 v[68:69], v101 offset:8192
    ds_read_b64_tr_b16 v[70:71], v101 offset:8704
    ds_read_b64_tr_b16 v[72:73], v102 offset:8192
    v_mfma_f32_16x16x32_bf16 v[164:167], v[112:115], v[32:35], v[164:167]
    ds_read_b64_tr_b16 v[74:75], v102 offset:8704
    s_waitcnt lgkmcnt(4)
    v_mfma_f32_16x16x32_bf16 v[160:163], v[116:119], v[48:51], v[160:163]
    ds_read_b64_tr_b16 v[88:89], v101 offset:12288
    ds_read_b64_tr_b16 v[90:91], v101 offset:12800
    ds_read_b64_tr_b16 v[92:93], v102 offset:12288
    v_mfma_f32_16x16x32_bf16 v[164:167], v[116:119], v[52:55], v[164:167]
    ds_read_b64_tr_b16 v[94:95], v102 offset:12800
    s_waitcnt lgkmcnt(0)
    v_mfma_f32_16x16x32_bf16 v[160:163], v[120:123], v[68:71], v[160:163]
    ds_read_b64_tr_b16 v[28:29], v156 offset:0
    ds_read_b64_tr_b16 v[30:31], v156 offset:512
    ds_read_b64_tr_b16 v[32:33], v157 offset:0
    v_mfma_f32_16x16x32_bf16 v[164:167], v[120:123], v[72:75], v[164:167]
    ds_read_b64_tr_b16 v[34:35], v157 offset:512
    ds_read_b64_tr_b16 v[48:49], v156 offset:4096
    ds_read_b64_tr_b16 v[50:51], v156 offset:4608
    v_mfma_f32_16x16x32_bf16 v[160:163], v[124:127], v[88:91], v[160:163]
    ds_read_b64_tr_b16 v[52:53], v157 offset:4096
    ds_read_b64_tr_b16 v[54:55], v157 offset:4608
    v_mfma_f32_16x16x32_bf16 v[164:167], v[124:127], v[92:95], v[164:167]
    s_waitcnt lgkmcnt(4)
    v_mfma_f32_16x16x32_bf16 v[160:163], v[128:131], v[28:31], v[160:163]
    ds_read_b64_tr_b16 v[68:69], v156 offset:8192
    ds_read_b64_tr_b16 v[70:71], v156 offset:8704
    ds_read_b64_tr_b16 v[72:73], v157 offset:8192
    v_mfma_f32_16x16x32_bf16 v[164:167], v[128:131], v[32:35], v[164:167]
    ds_read_b64_tr_b16 v[74:75], v157 offset:8704
    s_waitcnt lgkmcnt(4)
    v_mfma_f32_16x16x32_bf16 v[168:171], v[112:115], v[48:51], v[168:171]
    ds_read_b64_tr_b16 v[88:89], v156 offset:12288
    ds_read_b64_tr_b16 v[90:91], v156 offset:12800
    ds_read_b64_tr_b16 v[92:93], v157 offset:12288
    v_mfma_f32_16x16x32_bf16 v[172:175], v[112:115], v[52:55], v[172:175]
    ds_read_b64_tr_b16 v[94:95], v157 offset:12800
    s_add_u32 s40, s40, 1
    s_cmp_eq_u32 s40, 4
    s_mov_b32 s42, 36864
    s_cselect_b32 s42, 0xfffe5000, s42
    s_cselect_b32 s40, 0, s40
    v_add_u32 v96, s42, v96
    v_add_u32 v97, s42, v97
    v_add_u32 v98, s42, v98
    v_add_u32 v99, s42, v99
    v_add_u32 v100, s42, v100
    v_add_u32 v101, s42, v101
    v_add_u32 v102, s42, v102
    v_add_u32 v156, s42, v156
    v_add_u32 v157, s42, v157
    buffer_load_dwordx2 v[104:105], v108, s[20:23], 0 offen sc1
    buffer_load_dwordx2 v[106:107], v109, s[20:23], 0 offen sc1
    s_waitcnt lgkmcnt(0)
    s_barrier
    v_mfma_f32_16x16x32_bf16 v[168:171], v[116:119], v[68:71], v[168:171]
    ds_read_b64_tr_b16 v[28:29], v101 offset:0
    ds_read_b64_tr_b16 v[30:31], v101 offset:512
    ds_read_b64_tr_b16 v[32:33], v102 offset:0
    v_mfma_f32_16x16x32_bf16 v[172:175], v[116:119], v[72:75], v[172:175]
    ds_read_b64_tr_b16 v[34:35], v102 offset:512
    ds_read_b64_tr_b16 v[48:49], v101 offset:4096
    ds_read_b64_tr_b16 v[50:51], v101 offset:4608
    v_mfma_f32_16x16x32_bf16 v[168:171], v[120:123], v[88:91], v[168:171]
    ds_read_b64_tr_b16 v[52:53], v102 offset:4096
    ds_read_b64_tr_b16 v[54:55], v102 offset:4608
    v_mfma_f32_16x16x32_bf16 v[172:175], v[120:123], v[92:95], v[172:175]
    s_waitcnt lgkmcnt(4)
    v_mfma_f32_16x16x32_bf16 v[168:171], v[124:127], v[28:31], v[168:171]
    ds_read_b64_tr_b16 v[68:69], v101 offset:8192
    ds_read_b64_tr_b16 v[70:71], v101 offset:8704
    ds_read_b64_tr_b16 v[72:73], v102 offset:8192
    v_mfma_f32_16x16x32_bf16 v[172:175], v[124:127], v[32:35], v[172:175]
    ds_read_b64_tr_b16 v[74:75], v102 offset:8704
    s_waitcnt lgkmcnt(4)
    v_mfma_f32_16x16x32_bf16 v[168:171], v[128:131], v[48:51], v[168:171]
    ds_read_b64_tr_b16 v[88:89], v101 offset:12288
    ds_read_b64_tr_b16 v[90:91], v101 offset:12800
    ds_read_b64_tr_b16 v[92:93], v102 offset:12288
    v_mfma_f32_16x16x32_bf16 v[172:175], v[128:131], v[52:55], v[172:175]
    ds_read_b64_tr_b16 v[94:95], v102 offset:12800
    s_waitcnt lgkmcnt(0)
    v_mfma_f32_16x16x32_bf16 v[176:179], v[112:115], v[68:71], v[176:179]
    ds_read_b64_tr_b16 v[28:29], v156 offset:0
    ds_read_b64_tr_b16 v[30:31], v156 offset:512
    ds_read_b64_tr_b16 v[32:33], v157 offset:0
    v_mfma_f32_16x16x32_bf16 v[180:183], v[112:115], v[72:75], v[180:183]
    ds_read_b64_tr_b16 v[34:35], v157 offset:512
    ds_read_b64_tr_b16 v[48:49], v156 offset:4096
    ds_read_b64_tr_b16 v[50:51], v156 offset:4608
    v_mfma_f32_16x16x32_bf16 v[176:179], v[116:119], v[88:91], v[176:179]
    ds_read_b64_tr_b16 v[52:53], v157 offset:4096
    ds_read_b64_tr_b16 v[54:55], v157 offset:4608
    v_mfma_f32_16x16x32_bf16 v[180:183], v[116:119], v[92:95], v[180:183]
    s_waitcnt lgkmcnt(4)
    v_mfma_f32_16x16x32_bf16 v[176:179], v[120:123], v[28:31], v[176:179]
    ds_read_b64_tr_b16 v[68:69], v156 offset:8192
    ds_read_b64_tr_b16 v[70:71], v156 offset:8704
    ds_read_b64_tr_b16 v[72:73], v157 offset:8192
    v_mfma_f32_16x16x32_bf16 v[180:183], v[120:123], v[32:35], v[180:183]
    ds_read_b64_tr_b16 v[74:75], v157 offset:8704
    s_waitcnt lgkmcnt(4)
    v_mfma_f32_16x16x32_bf16 v[176:179], v[124:127], v[48:51], v[176:179]
    ds_read_b64_tr_b16 v[88:89], v156 offset:12288
    ds_read_b64_tr_b16 v[90:91], v156 offset:12800
    ds_read_b64_tr_b16 v[92:93], v157 offset:12288
    v_mfma_f32_16x16x32_bf16 v[180:183], v[124:127], v[52:55], v[180:183]
    ds_read_b64_tr_b16 v[94:95], v157 offset:12800
    s_add_u32 s40, s40, 1
    s_cmp_eq_u32 s40, 4
    s_mov_b32 s42, 36864
    s_cselect_b32 s42, 0xfffe5000, s42
    s_cselect_b32 s40, 0, s40
    v_add_u32 v96, s42, v96
    v_add_u32 v97, s42, v97
    v_add_u32 v98, s42, v98
    v_add_u32 v99, s42, v99
    v_add_u32 v100, s42, v100
    v_add_u32 v101, s42, v101
    v_add_u32 v102, s42, v102
    v_add_u32 v156, s42, v156
    v_add_u32 v157, s42, v157
    s_waitcnt lgkmcnt(0)
    s_barrier
    v_mfma_f32_16x16x32_bf16 v[176:179], v[128:131], v[68:71], v[176:179]
    ds_read_b64_tr_b16 v[28:29], v101 offset:0
    ds_read_b64_tr_b16 v[30:31], v101 offset:512
    ds_read_b64_tr_b16 v[32:33], v102 offset:0
    v_mfma_f32_16x16x32_bf16 v[180:183], v[128:131], v[72:75], v[180:183]
    ds_read_b64_tr_b16 v[34:35], v102 offset:512
    ds_read_b64_tr_b16 v[48:49], v101 offset:4096
    ds_read_b64_tr_b16 v[50:51], v101 offset:4608
    v_mfma_f32_16x16x32_bf16 v[184:187], v[112:115], v[88:91], v[184:187]
    ds_read_b64_tr_b16 v[52:53], v102 offset:4096
    ds_read_b64_tr_b16 v[54:55], v102 offset:4608
    v_mfma_f32_16x16x32_bf16 v[188:191], v[112:115], v[92:95], v[188:191]
    s_waitcnt lgkmcnt(4)
    v_mfma_f32_16x16x32_bf16 v[184:187], v[116:119], v[28:31], v[184:187]
    ds_read_b64_tr_b16 v[68:69], v101 offset:8192
    ds_read_b64_tr_b16 v[70:71], v101 offset:8704
    ds_read_b64_tr_b16 v[72:73], v102 offset:8192
    v_mfma_f32_16x16x32_bf16 v[188:191], v[116:119], v[32:35], v[188:191]
    ds_read_b64_tr_b16 v[74:75], v102 offset:8704
    s_waitcnt lgkmcnt(4)
    v_mfma_f32_16x16x32_bf16 v[184:187], v[120:123], v[48:51], v[184:187]
    ds_read_b64_tr_b16 v[88:89], v101 offset:12288
    ds_read_b64_tr_b16 v[90:91], v101 offset:12800
    ds_read_b64_tr_b16 v[92:93], v102 offset:12288
    v_mfma_f32_16x16x32_bf16 v[188:191], v[120:123], v[52:55], v[188:191]
    ds_read_b64_tr_b16 v[94:95], v102 offset:12800
    s_waitcnt lgkmcnt(0)
    v_mfma_f32_16x16x32_bf16 v[184:187], v[124:127], v[68:71], v[184:187]
    v_mfma_f32_16x16x32_bf16 v[188:191], v[124:127], v[72:75], v[188:191]
    v_mfma_f32_16x16x32_bf16 v[184:187], v[128:131], v[88:91], v[184:187]
    v_mfma_f32_16x16x32_bf16 v[188:191], v[128:131], v[92:95], v[188:191]
    s_nop 7
    s_nop 3
    s_waitcnt vmcnt(0)
    v_mul_f32 v132, v105, v132
    v_mul_f32 v133, v105, v133
    v_mul_f32 v134, v105, v134
    v_mul_f32 v135, v105, v135
    v_fmac_f32 v132, v104, v160
    v_fmac_f32 v133, v104, v168
    v_fmac_f32 v134, v104, v176
    v_fmac_f32 v135, v104, v184
    v_cvt_pk_bf16_f32 v16, v132, v133
    v_cvt_pk_bf16_f32 v17, v134, v135
    buffer_store_dwordx2 v[16:17], v110, s[24:27], 0 offen offset:0
    v_mul_f32 v140, v105, v140
    v_mul_f32 v141, v105, v141
    v_mul_f32 v142, v105, v142
    v_mul_f32 v143, v105, v143
    v_fmac_f32 v140, v104, v161
    v_fmac_f32 v141, v104, v169
    v_fmac_f32 v142, v104, v177
    v_fmac_f32 v143, v104, v185
    v_cvt_pk_bf16_f32 v20, v140, v141
    v_cvt_pk_bf16_f32 v21, v142, v143
    buffer_store_dwordx2 v[20:21], v110, s[24:27], 0 offen offset:32
    v_mul_f32 v148, v105, v148
    v_mul_f32 v149, v105, v149
    v_mul_f32 v150, v105, v150
    v_mul_f32 v151, v105, v151
    v_fmac_f32 v148, v104, v162
    v_fmac_f32 v149, v104, v170
    v_fmac_f32 v150, v104, v178
    v_fmac_f32 v151, v104, v186
    v_cvt_pk_bf16_f32 v24, v148, v149
    v_cvt_pk_bf16_f32 v25, v150, v151
    buffer_store_dwordx2 v[24:25], v110, s[24:27], 0 offen offset:64
    v_mul_f32 v136, v107, v136
    v_mul_f32 v137, v107, v137
    v_mul_f32 v138, v107, v138
    v_mul_f32 v139, v107, v139
    v_fmac_f32 v136, v106, v164
    v_fmac_f32 v137, v106, v172
    v_fmac_f32 v138, v106, v180
    v_fmac_f32 v139, v106, v188
    v_cvt_pk_bf16_f32 v18, v136, v137
    v_cvt_pk_bf16_f32 v19, v138, v139
    buffer_store_dwordx2 v[18:19], v111, s[24:27], 0 offen offset:0
    v_mul_f32 v144, v107, v144
    v_mul_f32 v145, v107, v145
    v_mul_f32 v146, v107, v146
    v_mul_f32 v147, v107, v147
    v_fmac_f32 v144, v106, v165
    v_fmac_f32 v145, v106, v173
    v_fmac_f32 v146, v106, v181
    v_fmac_f32 v147, v106, v189
    v_cvt_pk_bf16_f32 v22, v144, v145
    v_cvt_pk_bf16_f32 v23, v146, v147
    buffer_store_dwordx2 v[22:23], v111, s[24:27], 0 offen offset:32
    v_mul_f32 v152, v107, v152
    v_mul_f32 v153, v107, v153
    v_mul_f32 v154, v107, v154
    v_mul_f32 v155, v107, v155
    v_fmac_f32 v152, v106, v166
    v_fmac_f32 v153, v106, v174
    v_fmac_f32 v154, v106, v182
    v_fmac_f32 v155, v106, v190
    v_cvt_pk_bf16_f32 v26, v152, v153
    v_cvt_pk_bf16_f32 v27, v154, v155
    buffer_store_dwordx2 v[26:27], v111, s[24:27], 0 offen offset:64
    s_endpgm
L_dh1_98:
    s_mov_b32 s40, 0
    s_barrier
    ds_read_b128 v[28:31], v97 offset:0
    ds_read_b128 v[32:35], v97 offset:4096
    ds_read_b64_tr_b16 v[16:17], v96 offset:0
    ds_read_b64_tr_b16 v[18:19], v96 offset:1280
    ds_read_b64_tr_b16 v[20:21], v96 offset:32
    ds_read_b64_tr_b16 v[22:23], v96 offset:1312
    ds_read_b128 v[48:51], v98 offset:0
    ds_read_b128 v[52:55], v98 offset:4096
    ds_read_b64_tr_b16 v[36:37], v96 offset:5120
    ds_read_b64_tr_b16 v[38:39], v96 offset:6400
    ds_read_b64_tr_b16 v[40:41], v96 offset:5152
    ds_read_b64_tr_b16 v[42:43], v96 offset:6432
    s_mov_b32 s41, 11
L_cl_100:
    s_waitcnt lgkmcnt(6)
    v_mfma_f32_16x16x32_bf16 v[132:135], v[16:19], v[28:31], v[132:135]
    ds_read_b128 v[68:71], v99 offset:0
    ds_read_b128 v[72:75], v99 offset:4096
    ds_read_b64_tr_b16 v[56:57], v96 offset:10240
    v_mfma_f32_16x16x32_bf16 v[136:139], v[16:19], v[32:35], v[136:139]
    ds_read_b64_tr_b16 v[58:59], v96 offset:11520
    ds_read_b64_tr_b16 v[60:61], v96 offset:10272
    ds_read_b64_tr_b16 v[62:63], v96 offset:11552
    v_mfma_f32_16x16x32_bf16 v[140:143], v[20:23], v[28:31], v[140:143]
    v_mfma_f32_16x16x32_bf16 v[144:147], v[20:23], v[32:35], v[144:147]
    s_waitcnt lgkmcnt(6)
    v_mfma_f32_16x16x32_bf16 v[132:135], v[36:39], v[48:51], v[132:135]
    ds_read_b128 v[88:91], v100 offset:0
    ds_read_b128 v[92:95], v100 offset:4096
    ds_read_b64_tr_b16 v[76:77], v96 offset:15360
    v_mfma_f32_16x16x32_bf16 v[136:139], v[36:39], v[52:55], v[136:139]
    ds_read_b64_tr_b16 v[78:79], v96 offset:16640
    ds_read_b64_tr_b16 v[80:81], v96 offset:15392
    ds_read_b64_tr_b16 v[82:83], v96 offset:16672
    v_mfma_f32_16x16x32_bf16 v[140:143], v[40:43], v[48:51], v[140:143]
    s_add_u32 s40, s40, 1
    s_cmp_eq_u32 s40, 4
    s_mov_b32 s42, 36864
    v_mfma_f32_16x16x32_bf16 v[144:147], v[40:43], v[52:55], v[144:147]
    s_cselect_b32 s42, 0xfffe5000, s42
    s_cselect_b32 s40, 0, s40
    v_add_u32 v96, s42, v96
    v_add_u32 v97, s42, v97
    v_add_u32 v98, s42, v98
    v_add_u32 v99, s42, v99
    v_add_u32 v100, s42, v100
    v_add_u32 v101, s42, v101
    v_add_u32 v102, s42, v102
    v_add_u32 v156, s42, v156
    v_add_u32 v157, s42, v157
    s_waitcnt lgkmcnt(0)
    s_barrier
    v_mfma_f32_16x16x32_bf16 v[132:135], v[56:59], v[68:71], v[132:135]
    ds_read_b128 v[28:31], v97 offset:0
    ds_read_b128 v[32:35], v97 offset:4096
    ds_read_b64_tr_b16 v[16:17], v96 offset:0
    v_mfma_f32_16x16x32_bf16 v[136:139], v[56:59], v[72:75], v[136:139]
    ds_read_b64_tr_b16 v[18:19], v96 offset:1280
    ds_read_b64_tr_b16 v[20:21], v96 offset:32
    ds_read_b64_tr_b16 v[22:23], v96 offset:1312
    v_mfma_f32_16x16x32_bf16 v[140:143], v[60:63], v[68:71], v[140:143]
    ds_read_b128 v[48:51], v98 offset:0
    ds_read_b128 v[52:55], v98 offset:4096
    ds_read_b64_tr_b16 v[36:37], v96 offset:5120
    v_mfma_f32_16x16x32_bf16 v[144:147], v[60:63], v[72:75], v[144:147]
    ds_read_b64_tr_b16 v[38:39], v96 offset:6400
    ds_read_b64_tr_b16 v[40:41], v96 offset:5152
    ds_read_b64_tr_b16 v[42:43], v96 offset:6432
    v_mfma_f32_16x16x32_bf16 v[132:135], v[76:79], v[88:91], v[132:135]
    v_mfma_f32_16x16x32_bf16 v[136:139], v[76:79], v[92:95], v[136:139]
    v_mfma_f32_16x16x32_bf16 v[140:143], v[80:83], v[88:91], v[140:143]
    v_mfma_f32_16x16x32_bf16 v[144:147], v[80:83], v[92:95], v[144:147]
    s_sub_u32 s41, s41, 1
    s_cmp_lg_u32 s41, 0
    s_cbranch_scc1 L_cl_100
    s_waitcnt lgkmcnt(6)
    v_mfma_f32_16x16x32_bf16 v[132:135], v[16:19], v[28:31], v[132:135]
    ds_read_b128 v[68:71], v99 offset:0
    ds_read_b128 v[72:75], v99 offset:4096
    ds_read_b64_tr_b16 v[56:57], v96 offset:10240
    v_mfma_f32_16x16x32_bf16 v[136:139], v[16:19], v[32:35], v[136:139]
    ds_read_b64_tr_b16 v[58:59], v96 offset:11520
    ds_read_b64_tr_b16 v[60:61], v96 offset:10272
    ds_read_b64_tr_b16 v[62:63], v96 offset:11552
    v_mfma_f32_16x16x32_bf16 v[140:143], v[20:23], v[28:31], v[140:143]
    v_mfma_f32_16x16x32_bf16 v[144:147], v[20:23], v[32:35], v[144:147]
    s_waitcnt lgkmcnt(6)
    v_mfma_f32_16x16x32_bf16 v[132:135], v[36:39], v[48:51], v[132:135]
    ds_read_b128 v[88:91], v100 offset:0
    ds_read_b128 v[92:95], v100 offset:4096
    ds_read_b64_tr_b16 v[76:77], v96 offset:15360
    v_mfma_f32_16x16x32_bf16 v[136:139], v[36:39], v[52:55], v[136:139]
    ds_read_b64_tr_b16 v[78:79], v96 offset:16640
    ds_read_b64_tr_b16 v[80:81], v96 offset:15392
    ds_read_b64_tr_b16 v[82:83], v96 offset:16672
    v_mfma_f32_16x16x32_bf16 v[140:143], v[40:43], v[48:51], v[140:143]
    s_add_u32 s40, s40, 1
    s_cmp_eq_u32 s40, 4
    s_mov_b32 s42, 36864
    v_mfma_f32_16x16x32_bf16 v[144:147], v[40:43], v[52:55], v[144:147]
    s_cselect_b32 s42, 0xfffe5000, s42
    s_cselect_b32 s40, 0, s40
    v_add_u32 v96, s42, v96
    v_add_u32 v97, s42, v97
    v_add_u32 v98, s42, v98
    v_add_u32 v99, s42, v99
    v_add_u32 v100, s42, v100
    v_add_u32 v101, s42, v101
    v_add_u32 v102, s42, v102
    v_add_u32 v156, s42, v156
    v_add_u32 v157, s42, v157
    s_waitcnt vmcnt(0)
    s_waitcnt lgkmcnt(0)
    s_barrier
    v_mfma_f32_16x16x32_bf16 v[132:135], v[56:59], v[68:71], v[132:135]
    ds_read_b64_tr_b16 v[28:29], v101 offset:0
    ds_read_b64_tr_b16 v[30:31], v101 offset:512
    ds_read_b64_tr_b16 v[32:33], v102 offset:0
    v_mfma_f32_16x16x32_bf16 v[136:139], v[56:59], v[72:75], v[136:139]
    ds_read_b64_tr_b16 v[34:35], v102 offset:512
    ds_read_b64_tr_b16 v[48:49], v101 offset:4096
    ds_read_b64_tr_b16 v[50:51], v101 offset:4608
    v_mfma_f32_16x16x32_bf16 v[140:143], v[60:63], v[68:71], v[140:143]
    ds_read_b64_tr_b16 v[52:53], v102 offset:4096
    ds_read_b64_tr_b16 v[54:55], v102 offset:4608
    v_mfma_f32_16x16x32_bf16 v[144:147], v[60:63], v[72:75], v[144:147]
    v_mfma_f32_16x16x32_bf16 v[132:135], v[76:79], v[88:91], v[132:135]
    v_mfma_f32_16x16x32_bf16 v[136:139], v[76:79], v[92:95], v[136:139]
    v_mfma_f32_16x16x32_bf16 v[140:143], v[80:83], v[88:91], v[140:143]
    v_mfma_f32_16x16x32_bf16 v[144:147], v[80:83], v[92:95], v[144:147]
    s_waitcnt lgkmcnt(4)
    v_mfma_f32_16x16x32_bf16 v[160:163], v[112:115], v[28:31], v[160:163]
    ds_read_b64_tr_b16 v[68:69], v101 offset:8192
    ds_read_b64_tr_b16 v[70:71], v101 offset:8704
    ds_read_b64_tr_b16 v[72:73], v102 offset:8192
    v_mfma_f32_16x16x32_bf16 v[164:167], v[112:115], v[32:35], v[164:167]
    ds_read_b64_tr_b16 v[74:75], v102 offset:8704
    s_waitcnt lgkmcnt(4)
    v_mfma_f32_16x16x32_bf16 v[160:163], v[116:119], v[48:51], v[160:163]
    ds_read_b64_tr_b16 v[88:89], v101 offset:12288
    ds_read_b64_tr_b16 v[90:91], v101 offset:12800
    ds_read_b64_tr_b16 v[92:93], v102 offset:12288
    v_mfma_f32_16x16x32_bf16 v[164:167], v[116:119], v[52:55], v[164:167]
    ds_read_b64_tr_b16 v[94:95], v102 offset:12800
    s_waitcnt lgkmcnt(0)
    v_mfma_f32_16x16x32_bf16 v[160:163], v[120:123], v[68:71], v[160:163]
    ds_read_b64_tr_b16 v[28:29], v156 offset:0
    ds_read_b64_tr_b16 v[30:31], v156 offset:512
    ds_read_b64_tr_b16 v[32:33], v157 offset:0
    v_mfma_f32_16x16x32_bf16 v[164:167], v[120:123], v[72:75], v[164:167]
    ds_read_b64_tr_b16 v[34:35], v157 offset:512
    ds_read_b64_tr_b16 v[48:49], v156 offset:4096
    ds_read_b64_tr_b16 v[50:51], v156 offset:4608
    v_mfma_f32_16x16x32_bf16 v[160:163], v[124:127], v[88:91], v[160:163]
    ds_read_b64_tr_b16 v[52:53], v157 offset:4096
    ds_read_b64_tr_b16 v[54:55], v157 offset:4608
    v_mfma_f32_16x16x32_bf16 v[164:167], v[124:127], v[92:95], v[164:167]
    s_waitcnt lgkmcnt(4)
    v_mfma_f32_16x16x32_bf16 v[160:163], v[128:131], v[28:31], v[160:163]
    ds_read_b64_tr_b16 v[68:69], v156 offset:8192
    ds_read_b64_tr_b16 v[70:71], v156 offset:8704
    ds_read_b64_tr_b16 v[72:73], v157 offset:8192
    v_mfma_f32_16x16x32_bf16 v[164:167], v[128:131], v[32:35], v[164:167]
    ds_read_b64_tr_b16 v[74:75], v157 offset:8704
    s_waitcnt lgkmcnt(4)
    v_mfma_f32_16x16x32_bf16 v[168:171], v[112:115], v[48:51], v[168:171]
    ds_read_b64_tr_b16 v[88:89], v156 offset:12288
    ds_read_b64_tr_b16 v[90:91], v156 offset:12800
    ds_read_b64_tr_b16 v[92:93], v157 offset:12288
    v_mfma_f32_16x16x32_bf16 v[172:175], v[112:115], v[52:55], v[172:175]
    ds_read_b64_tr_b16 v[94:95], v157 offset:12800
    s_add_u32 s40, s40, 1
    s_cmp_eq_u32 s40, 4
    s_mov_b32 s42, 36864
    s_cselect_b32 s42, 0xfffe5000, s42
    s_cselect_b32 s40, 0, s40
    v_add_u32 v96, s42, v96
    v_add_u32 v97, s42, v97
    v_add_u32 v98, s42, v98
    v_add_u32 v99, s42, v99
    v_add_u32 v100, s42, v100
    v_add_u32 v101, s42, v101
    v_add_u32 v102, s42, v102
    v_add_u32 v156, s42, v156
    v_add_u32 v157, s42, v157
    buffer_load_dwordx2 v[104:105], v108, s[20:23], 0 offen sc1
    buffer_load_dwordx2 v[106:107], v109, s[20:23], 0 offen sc1
    s_waitcnt lgkmcnt(0)
    s_barrier
    v_mfma_f32_16x16x32_bf16 v[168:171], v[116:119], v[68:71], v[168:171]
    ds_read_b64_tr_b16 v[28:29], v101 offset:0
    ds_read_b64_tr_b16 v[30:31], v101 offset:512
    ds_read_b64_tr_b16 v[32:33], v102 offset:0
    v_mfma_f32_16x16x32_bf16 v[172:175], v[116:119], v[72:75], v[172:175]
    ds_read_b64_tr_b16 v[34:35], v102 offset:512
    ds_read_b64_tr_b16 v[48:49], v101 offset:4096
    ds_read_b64_tr_b16 v[50:51], v101 offset:4608
    v_mfma_f32_16x16x32_bf16 v[168:171], v[120:123], v[88:91], v[168:171]
    ds_read_b64_tr_b16 v[52:53], v102 offset:4096
    ds_read_b64_tr_b16 v[54:55], v102 offset:4608
    v_mfma_f32_16x16x32_bf16 v[172:175], v[120:123], v[92:95], v[172:175]
    s_waitcnt lgkmcnt(4)
    v_mfma_f32_16x16x32_bf16 v[168:171], v[124:127], v[28:31], v[168:171]
    ds_read_b64_tr_b16 v[68:69], v101 offset:8192
    ds_read_b64_tr_b16 v[70:71], v101 offset:8704
    ds_read_b64_tr_b16 v[72:73], v102 offset:8192
    v_mfma_f32_16x16x32_bf16 v[172:175], v[124:127], v[32:35], v[172:175]
    ds_read_b64_tr_b16 v[74:75], v102 offset:8704
    s_waitcnt lgkmcnt(4)
    v_mfma_f32_16x16x32_bf16 v[168:171], v[128:131], v[48:51], v[168:171]
    ds_read_b64_tr_b16 v[88:89], v101 offset:12288
    ds_read_b64_tr_b16 v[90:91], v101 offset:12800
    ds_read_b64_tr_b16 v[92:93], v102 offset:12288
    v_mfma_f32_16x16x32_bf16 v[172:175], v[128:131], v[52:55], v[172:175]
    ds_read_b64_tr_b16 v[94:95], v102 offset:12800
    s_waitcnt lgkmcnt(0)
    v_mfma_f32_16x16x32_bf16 v[176:179], v[112:115], v[68:71], v[176:179]
    ds_read_b64_tr_b16 v[28:29], v156 offset:0
    ds_read_b64_tr_b16 v[30:31], v156 offset:512
    ds_read_b64_tr_b16 v[32:33], v157 offset:0
    v_mfma_f32_16x16x32_bf16 v[180:183], v[112:115], v[72:75], v[180:183]
    ds_read_b64_tr_b16 v[34:35], v157 offset:512
    ds_read_b64_tr_b16 v[48:49], v156 offset:4096
    ds_read_b64_tr_b16 v[50:51], v156 offset:4608
    v_mfma_f32_16x16x32_bf16 v[176:179], v[116:119], v[88:91], v[176:179]
    ds_read_b64_tr_b16 v[52:53], v157 offset:4096
    ds_read_b64_tr_b16 v[54:55], v157 offset:4608
    v_mfma_f32_16x16x32_bf16 v[180:183], v[116:119], v[92:95], v[180:183]
    s_waitcnt lgkmcnt(4)
    v_mfma_f32_16x16x32_bf16 v[176:179], v[120:123], v[28:31], v[176:179]
    ds_read_b64_tr_b16 v[68:69], v156 offset:8192
    ds_read_b64_tr_b16 v[70:71], v156 offset:8704
    ds_read_b64_tr_b16 v[72:73], v157 offset:8192
    v_mfma_f32_16x16x32_bf16 v[180:183], v[120:123], v[32:35], v[180:183]
    ds_read_b64_tr_b16 v[74:75], v157 offset:8704
    s_waitcnt lgkmcnt(4)
    v_mfma_f32_16x16x32_bf16 v[176:179], v[124:127], v[48:51], v[176:179]
    ds_read_b64_tr_b16 v[88:89], v156 offset:12288
    ds_read_b64_tr_b16 v[90:91], v156 offset:12800
    ds_read_b64_tr_b16 v[92:93], v157 offset:12288
    v_mfma_f32_16x16x32_bf16 v[180:183], v[124:127], v[52:55], v[180:183]
    ds_read_b64_tr_b16 v[94:95], v157 offset:12800
    s_add_u32 s40, s40, 1
    s_cmp_eq_u32 s40, 4
    s_mov_b32 s42, 36864
    s_cselect_b32 s42, 0xfffe5000, s42
    s_cselect_b32 s40, 0, s40
    v_add_u32 v96, s42, v96
    v_add_u32 v97, s42, v97
    v_add_u32 v98, s42, v98
    v_add_u32 v99, s42, v99
    v_add_u32 v100, s42, v100
    v_add_u32 v101, s42, v101
    v_add_u32 v102, s42, v102
    v_add_u32 v156, s42, v156
    v_add_u32 v157, s42, v157
    s_waitcnt lgkmcnt(0)
    s_barrier
    v_mfma_f32_16x16x32_bf16 v[176:179], v[128:131], v[68:71], v[176:179]
    ds_read_b64_tr_b16 v[28:29], v101 offset:0
    ds_read_b64_tr_b16 v[30:31], v101 offset:512
    ds_read_b64_tr_b16 v[32:33], v102 offset:0
    v_mfma_f32_16x16x32_bf16 v[180:183], v[128:131], v[72:75], v[180:183]
    ds_read_b64_tr_b16 v[34:35], v102 offset:512
    ds_read_b64_tr_b16 v[48:49], v101 offset:4096
    ds_read_b64_tr_b16 v[50:51], v101 offset:4608
    v_mfma_f32_16x16x32_bf16 v[184:187], v[112:115], v[88:91], v[184:187]
    ds_read_b64_tr_b16 v[52:53], v102 offset:4096
    ds_read_b64_tr_b16 v[54:55], v102 offset:4608
    v_mfma_f32_16x16x32_bf16 v[188:191], v[112:115], v[92:95], v[188:191]
    s_waitcnt lgkmcnt(4)
    v_mfma_f32_16x16x32_bf16 v[184:187], v[116:119], v[28:31], v[184:187]
    ds_read_b64_tr_b16 v[68:69], v101 offset:8192
    ds_read_b64_tr_b16 v[70:71], v101 offset:8704
    ds_read_b64_tr_b16 v[72:73], v102 offset:8192
    v_mfma_f32_16x16x32_bf16 v[188:191], v[116:119], v[32:35], v[188:191]
    ds_read_b64_tr_b16 v[74:75], v102 offset:8704
    s_waitcnt lgkmcnt(4)
    v_mfma_f32_16x16x32_bf16 v[184:187], v[120:123], v[48:51], v[184:187]
    ds_read_b64_tr_b16 v[88:89], v101 offset:12288
    ds_read_b64_tr_b16 v[90:91], v101 offset:12800
    ds_read_b64_tr_b16 v[92:93], v102 offset:12288
    v_mfma_f32_16x16x32_bf16 v[188:191], v[120:123], v[52:55], v[188:191]
    ds_read_b64_tr_b16 v[94:95], v102 offset:12800
    s_waitcnt lgkmcnt(0)
    v_mfma_f32_16x16x32_bf16 v[184:187], v[124:127], v[68:71], v[184:187]
    v_mfma_f32_16x16x32_bf16 v[188:191], v[124:127], v[72:75], v[188:191]
    v_mfma_f32_16x16x32_bf16 v[184:187], v[128:131], v[88:91], v[184:187]
    v_mfma_f32_16x16x32_bf16 v[188:191], v[128:131], v[92:95], v[188:191]
    s_nop 7
    s_nop 3
    s_waitcnt vmcnt(0)
    v_mul_f32 v132, v105, v132
    v_mul_f32 v133, v105, v133
    v_mul_f32 v134, v105, v134
    v_mul_f32 v135, v105, v135
    v_fmac_f32 v132, v104, v160
    v_fmac_f32 v133, v104, v168
    v_fmac_f32 v134, v104, v176
    v_fmac_f32 v135, v104, v184
    v_cvt_pk_bf16_f32 v16, v132, v133
    v_cvt_pk_bf16_f32 v17, v134, v135
    buffer_store_dwordx2 v[16:17], v110, s[24:27], 0 offen offset:0
    v_mul_f32 v140, v105, v140
    v_mul_f32 v141, v105, v141
    v_mul_f32 v142, v105, v142
    v_mul_f32 v143, v105, v143
    v_fmac_f32 v140, v104, v161
    v_fmac_f32 v141, v104, v169
    v_fmac_f32 v142, v104, v177
    v_fmac_f32 v143, v104, v185
    v_cvt_pk_bf16_f32 v20, v140, v141
    v_cvt_pk_bf16_f32 v21, v142, v143
    buffer_store_dwordx2 v[20:21], v110, s[24:27], 0 offen offset:32
    v_mul_f32 v136, v107, v136
    v_mul_f32 v137, v107, v137
    v_mul_f32 v138, v107, v138
    v_mul_f32 v139, v107, v139
    v_fmac_f32 v136, v106, v164
    v_fmac_f32 v137, v106, v172
    v_fmac_f32 v138, v106, v180
    v_fmac_f32 v139, v106, v188
    v_cvt_pk_bf16_f32 v18, v136, v137
    v_cvt_pk_bf16_f32 v19, v138, v139
    buffer_store_dwordx2 v[18:19], v111, s[24:27], 0 offen offset:0
    v_mul_f32 v144, v107, v144
    v_mul_f32 v145, v107, v145
    v_mul_f32 v146, v107, v146
    v_mul_f32 v147, v107, v147
    v_fmac_f32 v144, v106, v165
    v_fmac_f32 v145, v106, v173
    v_fmac_f32 v146, v106, v181
    v_fmac_f32 v147, v106, v189
    v_cvt_pk_bf16_f32 v22, v144, v145
    v_cvt_pk_bf16_f32 v23, v146, v147
    buffer_store_dwordx2 v[22:23], v111, s[24:27], 0 offen offset:32
    s_endpgm
L_finload_4:
    v_mbcnt_lo_u32_b32 v0, -1, 0
    v_mbcnt_hi_u32_b32 v0, -1, v0
    s_sub_u32 s35, s28, 4
    s_add_u32 s24, s76, 29360128
    s_addc_u32 s25, s77, 0
    s_mov_b32 s26, 16384
    s_mov_b32 s27, 0x20000
    v_lshlrev_b32 v25, 3, v0
    v_add_u32 v25, 10240, v25
    s_add_u32 s12, s76, 20971520
    s_addc_u32 s13, s77, 0
    s_mov_b32 s14, 1966080
    s_mov_b32 s15, 0x20000
    s_mov_b32 s16, s76
    s_mov_b32 s17, s77
    s_mov_b32 s18, 6553600
    s_mov_b32 s19, 0x20000
    s_add_u32 s20, s76, 12582912
    s_addc_u32 s21, s77, 0
    s_mov_b32 s22, 2703360
    s_mov_b32 s23, 0x20000
    s_mul_i32 s37, s30, 245760
    s_mul_i32 s38, s35, 5120
    s_add_u32 s37, s37, s38
    v_lshlrev_b32 v8, 4, v0
    v_add_u32 v8, s37, v8
    v_lshrrev_b32 v2, 3, v0
    v_and_b32 v3, 2, v2
    v_xor_b32 v3, v3, v0
    v_and_b32 v3, 7, v3
    v_lshlrev_b32 v3, 4, v3
    v_mul_u32_u24 v4, 4224, v2
    s_mul_i32 s37, s35, 135168
    s_lshl_b32 s39, s29, 7
    s_add_u32 s37, s37, s39
    v_add_u32 v4, s37, v4
    v_xor_b32 v5, 64, v3
    v_add_u32 v6, 0, v4
    v_add_u32 v18, v6, v3
    v_add_u32 v6, 32768, v4
    v_add_u32 v19, v6, v5
    v_add_u32 v6, 65536, v4
    v_add_u32 v20, v6, v5
    v_add_u32 v6, 98304, v4
    v_add_u32 v21, v6, v3
    v_lshrrev_b32 v2, 4, v0
    v_and_b32 v3, 15, v0
    v_xor_b32 v3, v3, v2
    s_lshr_b32 s37, s35, 1
    s_lshl_b32 s37, s37, 5
    s_and_b32 s38, s35, 1
    s_lshl_b32 s38, s38, 2
    s_add_u32 s37, s37, s38
    s_lshl_b32 s38, s29, 6
    s_add_u32 s37, s37, s38
    v_add_u32 v2, s37, v2
    v_mul_u32_u24 v4, 3200, v2
    v_xor_b32 v5, 0, v3
    v_lshl_add_u32 v5, v5, 4, v4
    v_mov_b32 v14, v5
    v_xor_b32 v5, 4, v3
    v_lshl_add_u32 v5, v5, 4, v4
    v_add_u32 v15, 24576, v5
    v_xor_b32 v5, 8, v3
    v_lshl_add_u32 v5, v5, 4, v4
    v_add_u32 v16, 49152, v5
    v_xor_b32 v5, 12, v3
    v_lshl_add_u32 v5, v5, 4, v4
    v_add_u32 v17, 73728, v5
    s_mov_b32 s50, 0x7fffff
    s_mov_b32 s51, 0
    s_cmp_eq_u32 s62, 1
    s_cbranch_scc1 L_nob2_106
    s_barrier
L_nob2_106:
    s_cmp_eq_u32 s54, 0
    s_cbranch_scc1 L_wdm_105
    s_cmp_eq_u32 s62, 0
    s_cbranch_scc1 L_wdspin_104
    s_waitcnt vmcnt(8)
    v_cmp_eq_u32 vcc, s78, v212
    v_cmp_eq_u32 s[52:53], s79, v213
    s_nop 3
    s_and_b64 vcc, vcc, s[52:53]
    s_and_b64 vcc, vcc, s[50:51]
    s_cmp_eq_u64 vcc, s[50:51]
    s_cbranch_scc0 L_wdspin_104
    s_branch L_wdok_103
L_wdm_105:
    v_mov_b32 v26, 147456
    ds_read_b32 v27, v26
    s_waitcnt lgkmcnt(0)
    v_readfirstlane_b32 s52, v27
    s_nop 3
    s_cmp_eq_u32 s52, 1
    s_cbranch_scc1 L_wdok_103
L_wdspin_104:
    s_mov_b32 s54, 65536
L_wf_107:
    buffer_load_dwordx2 v[26:27], v25, s[24:27], 0 offen sc1
    s_waitcnt vmcnt(0)
    v_cmp_eq_u32 vcc, s78, v26
    v_cmp_eq_u32 s[52:53], s79, v27
    s_nop 3
    s_and_b64 vcc, vcc, s[52:53]
    s_and_b64 vcc, vcc, s[50:51]
    s_cmp_eq_u64 vcc, s[50:51]
    s_cbranch_scc1 L_wfd_108
    s_sleep 16
    s_sub_u32 s54, s54, 1
    s_cmp_lg_u32 s54, 0
    s_cbranch_scc1 L_wf_107
L_wfd_108:
    s_waitcnt vmcnt(0)
L_wdok_103:
    v_lshlrev_b32 v25, 3, v0
    s_lshr_b32 s37, s29, 1
    s_lshl_b32 s37, s37, 7
    v_add_u32 v33, s37, v25
    v_add_u32 v25, 9216, v25
    s_mul_i32 s40, s35, 5120
    s_lshl_b32 s42, s35, 12
    s_add_u32 s42, s42, 20480
    s_mov_b32 s43, 0
    s_mov_b32 s44, 0
    s_mov_b32 s45, 0
    s_mov_b32 s46, 0
    s_mov_b32 s48, 0
    s_cmp_eq_u32 s62, 1
    s_cbranch_scc1 L_colwg_109
    s_mov_b32 m0, s40
    s_add_u32 s49, s43, 4096
    buffer_load_dwordx4 v8, s[12:15], s43 offen offset:0 sc1 lds
    buffer_load_dwordx4 v8, s[12:15], s43 offen offset:1024 sc1 lds
    buffer_load_dwordx4 v8, s[12:15], s43 offen offset:2048 sc1 lds
    buffer_load_dwordx4 v8, s[12:15], s43 offen offset:3072 sc1 lds
    s_add_u32 m0, s40, 4096
    s_add_u32 s43, s43, 20480
    buffer_load_dwordx4 v8, s[12:15], s49 offen sc1 lds
    s_add_u32 s46, s46, 1
    s_cmp_eq_u32 s46, 4
    s_mov_b32 s47, 36864
    s_cselect_b32 s47, 0xfffe5000, s47
    s_cselect_b32 s46, 0, s46
    s_add_u32 s40, s40, s47
    s_mov_b32 m0, s40
    s_add_u32 s49, s43, 4096
    buffer_load_dwordx4 v8, s[12:15], s43 offen offset:0 sc1 lds
    buffer_load_dwordx4 v8, s[12:15], s43 offen offset:1024 sc1 lds
    buffer_load_dwordx4 v8, s[12:15], s43 offen offset:2048 sc1 lds
    buffer_load_dwordx4 v8, s[12:15], s43 offen offset:3072 sc1 lds
    s_add_u32 m0, s40, 4096
    s_add_u32 s43, s43, 20480
    buffer_load_dwordx4 v8, s[12:15], s49 offen sc1 lds
    s_add_u32 s46, s46, 1
    s_cmp_eq_u32 s46, 4
    s_mov_b32 s47, 36864
    s_cselect_b32 s47, 0xfffe5000, s47
    s_cselect_b32 s46, 0, s46
    s_add_u32 s40, s40, s47
    s_mov_b32 m0, s40
    s_add_u32 s49, s43, 4096
    buffer_load_dwordx4 v8, s[12:15], s43 offen offset:0 sc1 lds
    buffer_load_dwordx4 v8, s[12:15], s43 offen offset:1024 sc1 lds
    buffer_load_dwordx4 v8, s[12:15], s43 offen offset:2048 sc1 lds
    buffer_load_dwordx4 v8, s[12:15], s43 offen offset:3072 sc1 lds
    s_add_u32 m0, s40, 4096
    s_add_u32 s43, s43, 20480
    buffer_load_dwordx4 v8, s[12:15], s49 offen sc1 lds
    s_add_u32 s46, s46, 1
    s_cmp_eq_u32 s46, 4
    s_mov_b32 s47, 36864
    s_cselect_b32 s47, 0xfffe5000, s47
    s_cselect_b32 s46, 0, s46
    s_add_u32 s40, s40, s47
    s_mov_b32 m0, s40
    s_add_u32 s49, s43, 4096
    buffer_load_dwordx4 v8, s[12:15], s43 offen offset:0 sc1 lds
    buffer_load_dwordx4 v8, s[12:15], s43 offen offset:1024 sc1 lds
    buffer_load_dwordx4 v8, s[12:15], s43 offen offset:2048 sc1 lds
    buffer_load_dwordx4 v8, s[12:15], s43 offen offset:3072 sc1 lds
    s_add_u32 m0, s40, 4096
    s_add_u32 s43, s43, 20480
    buffer_load_dwordx4 v8, s[12:15], s49 offen sc1 lds
    s_add_u32 s46, s46, 1
    s_cmp_eq_u32 s46, 4
    s_mov_b32 s47, 36864
    s_cselect_b32 s47, 0xfffe5000, s47
    s_cselect_b32 s46, 0, s46
    s_add_u32 s40, s40, s47
    s_lshr_b32 s37, s2, 3
    s_lshl_b32 s37, s37, 2
    s_add_u32 s37, s37, s35
    s_mul_i32 s37, s37, 60
    s_and_b32 s38, s2, 7
    s_lshr_b32 s38, s38, 2
    s_mul_i32 s38, s38, 983040
    v_add_u32 v2, s37, v0
    v_lshlrev_b32 v2, 7, v2
    v_add_u32 v2, s38, v2
    v_cmp_gt_u32 vcc, 60, v0
    v_mov_b32 v3, 0x7f000000
    s_nop 1
    v_cndmask_b32 v2, v3, v2, vcc
    buffer_load_dword v32, v2, s[12:15], 0 offen sc1
    s_barrier
    s_mov_b32 m0, s42
    s_nop 0
    buffer_load_dwordx4 v14, s[16:19], s44 offen offset:0 sc1 lds
    buffer_load_dwordx4 v15, s[16:19], s44 offen offset:1024 sc1 lds
    buffer_load_dwordx4 v16, s[16:19], s44 offen offset:2048 sc1 lds
    buffer_load_dwordx4 v17, s[16:19], s44 offen offset:3072 sc1 lds
    s_add_u32 s44, s44, 256
    s_add_u32 s48, s48, 1
    s_cmp_eq_u32 s48, 4
    s_mov_b32 s47, 36864
    s_cselect_b32 s47, 0xfffe5000, s47
    s_cselect_b32 s48, 0, s48
    s_add_u32 s42, s42, s47
    s_mov_b32 m0, s42
    s_nop 0
    buffer_load_dwordx4 v14, s[16:19], s44 offen offset:0 sc1 lds
    buffer_load_dwordx4 v15, s[16:19], s44 offen offset:1024 sc1 lds
    buffer_load_dwordx4 v16, s[16:19], s44 offen offset:2048 sc1 lds
    buffer_load_dwordx4 v17, s[16:19], s44 offen offset:3072 sc1 lds
    s_add_u32 s44, s44, 256
    s_add_u32 s48, s48, 1
    s_cmp_eq_u32 s48, 4
    s_mov_b32 s47, 36864
    s_cselect_b32 s47, 0xfffe5000, s47
    s_cselect_b32 s48, 0, s48
    s_add_u32 s42, s42, s47
    s_waitcnt vmcnt(4)
    s_barrier
    s_mov_b32 m0, s42
    s_nop 0
    buffer_load_dwordx4 v14, s[16:19], s44 offen offset:0 sc1 lds
    buffer_load_dwordx4 v15, s[16:19], s44 offen offset:1024 sc1 lds
    buffer_load_dwordx4 v16, s[16:19], s44 offen offset:2048 sc1 lds
    buffer_load_dwordx4 v17, s[16:19], s44 offen offset:3072 sc1 lds
    s_add_u32 s44, s44, 256
    s_add_u32 s48, s48, 1
    s_cmp_eq_u32 s48, 4
    s_mov_b32 s47, 36864
    s_cselect_b32 s47, 0xfffe5000, s47
    s_cselect_b32 s48, 0, s48
    s_add_u32 s42, s42, s47
    s_mov_b32 m0, s42
    s_nop 0
    buffer_load_dwordx4 v14, s[16:19], s44 offen offset:0 sc1 lds
    buffer_load_dwordx4 v15, s[16:19], s44 offen offset:1024 sc1 lds
    buffer_load_dwordx4 v16, s[16:19], s44 offen offset:2048 sc1 lds
    buffer_load_dwordx4 v17, s[16:19], s44 offen offset:3072 sc1 lds
    s_add_u32 s44, s44, 256
    s_add_u32 s48, s48, 1
    s_cmp_eq_u32 s48, 4
    s_mov_b32 s47, 36864
    s_cselect_b32 s47, 0xfffe5000, s47
    s_cselect_b32 s48, 0, s48
    s_add_u32 s42, s42, s47
    s_waitcnt vmcnt(8)
    s_barrier
    s_mov_b32 m0, s42
    s_nop 0
    buffer_load_dwordx4 v14, s[16:19], s44 offen offset:0 sc1 lds
    buffer_load_dwordx4 v15, s[16:19], s44 offen offset:1024 sc1 lds
    buffer_load_dwordx4 v16, s[16:19], s44 offen offset:2048 sc1 lds
    buffer_load_dwordx4 v17, s[16:19], s44 offen offset:3072 sc1 lds
    s_add_u32 s44, s44, 256
    s_add_u32 s48, s48, 1
    s_cmp_eq_u32 s48, 4
    s_mov_b32 s47, 36864
    s_cselect_b32 s47, 0xfffe5000, s47
    s_cselect_b32 s48, 0, s48
    s_add_u32 s42, s42, s47
    s_mov_b32 m0, s40
    s_add_u32 s49, s43, 4096
    buffer_load_dwordx4 v8, s[12:15], s43 offen offset:0 sc1 lds
    buffer_load_dwordx4 v8, s[12:15], s43 offen offset:1024 sc1 lds
    buffer_load_dwordx4 v8, s[12:15], s43 offen offset:2048 sc1 lds
    buffer_load_dwordx4 v8, s[12:15], s43 offen offset:3072 sc1 lds
    s_add_u32 m0, s40, 4096
    s_add_u32 s43, s43, 20480
    buffer_load_dwordx4 v8, s[12:15], s49 offen sc1 lds
    s_add_u32 s46, s46, 1
    s_cmp_eq_u32 s46, 4
    s_mov_b32 s47, 36864
    s_cselect_b32 s47, 0xfffe5000, s47
    s_cselect_b32 s46, 0, s46
    s_add_u32 s40, s40, s47
    s_waitcnt vmcnt(13)
    s_barrier
    s_mov_b32 m0, s42
    s_nop 0
    buffer_load_dwordx4 v14, s[16:19], s44 offen offset:0 sc1 lds
    buffer_load_dwordx4 v15, s[16:19], s44 offen offset:1024 sc1 lds
    buffer_load_dwordx4 v16, s[16:19], s44 offen offset:2048 sc1 lds
    buffer_load_dwordx4 v17, s[16:19], s44 offen offset:3072 sc1 lds
    s_add_u32 s44, s44, 256
    s_add_u32 s48, s48, 1
    s_cmp_eq_u32 s48, 4
    s_mov_b32 s47, 36864
    s_cselect_b32 s47, 0xfffe5000, s47
    s_cselect_b32 s48, 0, s48
    s_add_u32 s42, s42, s47
    s_mov_b32 m0, s40
    s_add_u32 s49, s43, 4096
    buffer_load_dwordx4 v8, s[12:15], s43 offen offset:0 sc1 lds
    buffer_load_dwordx4 v8, s[12:15], s43 offen offset:1024 sc1 lds
    buffer_load_dwordx4 v8, s[12:15], s43 offen offset:2048 sc1 lds
    buffer_load_dwordx4 v8, s[12:15], s43 offen offset:3072 sc1 lds
    s_add_u32 m0, s40, 4096
    s_add_u32 s43, s43, 20480
    buffer_load_dwordx4 v8, s[12:15], s49 offen sc1 lds
    s_add_u32 s46, s46, 1
    s_cmp_eq_u32 s46, 4
    s_mov_b32 s47, 36864
    s_cselect_b32 s47, 0xfffe5000, s47
    s_cselect_b32 s46, 0, s46
    s_add_u32 s40, s40, s47
    s_waitcnt vmcnt(18)
    s_barrier
    s_mov_b32 m0, s42
    s_nop 0
    buffer_load_dwordx4 v14, s[16:19], s44 offen offset:0 sc1 lds
    buffer_load_dwordx4 v15, s[16:19], s44 offen offset:1024 sc1 lds
    buffer_load_dwordx4 v16, s[16:19], s44 offen offset:2048 sc1 lds
    buffer_load_dwordx4 v17, s[16:19], s44 offen offset:3072 sc1 lds
    s_add_u32 s44, s44, 256
    s_add_u32 s48, s48, 1
    s_cmp_eq_u32 s48, 4
    s_mov_b32 s47, 36864
    s_cselect_b32 s47, 0xfffe5000, s47
    s_cselect_b32 s48, 0, s48
    s_add_u32 s42, s42, s47
    s_mov_b32 m0, s40
    s_add_u32 s49, s43, 4096
    buffer_load_dwordx4 v8, s[12:15], s43 offen offset:0 sc1 lds
    buffer_load_dwordx4 v8, s[12:15], s43 offen offset:1024 sc1 lds
    buffer_load_dwordx4 v8, s[12:15], s43 offen offset:2048 sc1 lds
    buffer_load_dwordx4 v8, s[12:15], s43 offen offset:3072 sc1 lds
    s_add_u32 m0, s40, 4096
    s_add_u32 s43, s43, 20480
    buffer_load_dwordx4 v8, s[12:15], s49 offen sc1 lds
    s_add_u32 s46, s46, 1
    s_cmp_eq_u32 s46, 4
    s_mov_b32 s47, 36864
    s_cselect_b32 s47, 0xfffe5000, s47
    s_cselect_b32 s46, 0, s46
    s_add_u32 s40, s40, s47
    s_waitcnt vmcnt(18)
    s_barrier
    s_mov_b32 m0, s42
    s_nop 0
    buffer_load_dwordx4 v14, s[16:19], s44 offen offset:0 sc1 lds
    buffer_load_dwordx4 v15, s[16:19], s44 offen offset:1024 sc1 lds
    buffer_load_dwordx4 v16, s[16:19], s44 offen offset:2048 sc1 lds
    buffer_load_dwordx4 v17, s[16:19], s44 offen offset:3072 sc1 lds
    s_add_u32 s44, s44, 256
    s_add_u32 s48, s48, 1
    s_cmp_eq_u32 s48, 4
    s_mov_b32 s47, 36864
    s_cselect_b32 s47, 0xfffe5000, s47
    s_cselect_b32 s48, 0, s48
    s_add_u32 s42, s42, s47
    s_mov_b32 m0, s40
    s_add_u32 s49, s43, 4096
    buffer_load_dwordx4 v8, s[12:15], s43 offen offset:0 sc1 lds
    buffer_load_dwordx4 v8, s[12:15], s43 offen offset:1024 sc1 lds
    buffer_load_dwordx4 v8, s[12:15], s43 offen offset:2048 sc1 lds
    buffer_load_dwordx4 v8, s[12:15], s43 offen offset:3072 sc1 lds
    s_add_u32 m0, s40, 4096
    s_add_u32 s43, s43, 20480
    buffer_load_dwordx4 v8, s[12:15], s49 offen sc1 lds
    s_add_u32 s46, s46, 1
    s_cmp_eq_u32 s46, 4
    s_mov_b32 s47, 36864
    s_cselect_b32 s47, 0xfffe5000, s47
    s_cselect_b32 s46, 0, s46
    s_add_u32 s40, s40, s47
    s_waitcnt vmcnt(18)
    s_barrier
    s_mov_b32 m0, s42
    s_nop 0
    buffer_load_dwordx4 v14, s[16:19], s44 offen offset:0 sc1 lds
    buffer_load_dwordx4 v15, s[16:19], s44 offen offset:1024 sc1 lds
    buffer_load_dwordx4 v16, s[16:19], s44 offen offset:2048 sc1 lds
    buffer_load_dwordx4 v17, s[16:19], s44 offen offset:3072 sc1 lds
    s_add_u32 s44, s44, 256
    s_add_u32 s48, s48, 1
    s_cmp_eq_u32 s48, 4
    s_mov_b32 s47, 36864
    s_cselect_b32 s47, 0xfffe5000, s47
    s_cselect_b32 s48, 0, s48
    s_add_u32 s42, s42, s47
    s_mov_b32 m0, s40
    s_add_u32 s49, s43, 4096
    buffer_load_dwordx4 v8, s[12:15], s43 offen offset:0 sc1 lds
    buffer_load_dwordx4 v8, s[12:15], s43 offen offset:1024 sc1 lds
    buffer_load_dwordx4 v8, s[12:15], s43 offen offset:2048 sc1 lds
    buffer_load_dwordx4 v8, s[12:15], s43 offen offset:3072 sc1 lds
    s_add_u32 m0, s40, 4096
    s_add_u32 s43, s43, 20480
    buffer_load_dwordx4 v8, s[12:15], s49 offen sc1 lds
    s_add_u32 s46, s46, 1
    s_cmp_eq_u32 s46, 4
    s_mov_b32 s47, 36864
    s_cselect_b32 s47, 0xfffe5000, s47
    s_cselect_b32 s46, 0, s46
    s_add_u32 s40, s40, s47
    s_waitcnt vmcnt(18)
    s_barrier
    s_mov_b32 m0, s42
    s_nop 0
    buffer_load_dwordx4 v14, s[16:19], s44 offen offset:0 sc1 lds
    buffer_load_dwordx4 v15, s[16:19], s44 offen offset:1024 sc1 lds
    buffer_load_dwordx4 v16, s[16:19], s44 offen offset:2048 sc1 lds
    buffer_load_dwordx4 v17, s[16:19], s44 offen offset:3072 sc1 lds
    s_add_u32 s44, s44, 256
    s_add_u32 s48, s48, 1
    s_cmp_eq_u32 s48, 4
    s_mov_b32 s47, 36864
    s_cselect_b32 s47, 0xfffe5000, s47
    s_cselect_b32 s48, 0, s48
    s_add_u32 s42, s42, s47
    s_mov_b32 m0, s40
    s_add_u32 s49, s43, 4096
    buffer_load_dwordx4 v8, s[12:15], s43 offen offset:0 sc1 lds
    buffer_load_dwordx4 v8, s[12:15], s43 offen offset:1024 sc1 lds
    buffer_load_dwordx4 v8, s[12:15], s43 offen offset:2048 sc1 lds
    buffer_load_dwordx4 v8, s[12:15], s43 offen offset:3072 sc1 lds
    s_add_u32 m0, s40, 4096
    s_add_u32 s43, s43, 20480
    buffer_load_dwordx4 v8, s[12:15], s49 offen sc1 lds
    s_add_u32 s46, s46, 1
    s_cmp_eq_u32 s46, 4
    s_mov_b32 s47, 36864
    s_cselect_b32 s47, 0xfffe5000, s47
    s_cselect_b32 s46, 0, s46
    s_add_u32 s40, s40, s47
    s_waitcnt vmcnt(18)
    s_barrier
    buffer_load_dwordx2 v[26:27], v25, s[24:27], 0 offen sc1
    s_mov_b32 m0, s42
    s_nop 0
    buffer_load_dwordx4 v14, s[16:19], s44 offen offset:0 sc1 lds
    buffer_load_dwordx4 v15, s[16:19], s44 offen offset:1024 sc1 lds
    buffer_load_dwordx4 v16, s[16:19], s44 offen offset:2048 sc1 lds
    buffer_load_dwordx4 v17, s[16:19], s44 offen offset:3072 sc1 lds
    s_add_u32 s44, s44, 256
    s_add_u32 s48, s48, 1
    s_cmp_eq_u32 s48, 4
    s_mov_b32 s47, 36864
    s_cselect_b32 s47, 0xfffe5000, s47
    s_cselect_b32 s48, 0, s48
    s_add_u32 s42, s42, s47
    s_mov_b32 m0, s40
    s_add_u32 s49, s43, 4096
    buffer_load_dwordx4 v8, s[12:15], s43 offen offset:0 sc1 lds
    buffer_load_dwordx4 v8, s[12:15], s43 offen offset:1024 sc1 lds
    buffer_load_dwordx4 v8, s[12:15], s43 offen offset:2048 sc1 lds
    buffer_load_dwordx4 v8, s[12:15], s43 offen offset:3072 sc1 lds
    s_add_u32 m0, s40, 4096
    s_add_u32 s43, s43, 20480
    buffer_load_dwordx4 v8, s[12:15], s49 offen sc1 lds
    s_add_u32 s46, s46, 1
    s_cmp_eq_u32 s46, 4
    s_mov_b32 s47, 36864
    s_cselect_b32 s47, 0xfffe5000, s47
    s_cselect_b32 s46, 0, s46
    s_add_u32 s40, s40, s47
    s_waitcnt vmcnt(19)
    s_barrier
    s_mov_b32 m0, s42
    s_nop 0
    buffer_load_dwordx4 v14, s[16:19], s44 offen offset:0 sc1 lds
    buffer_load_dwordx4 v15, s[16:19], s44 offen offset:1024 sc1 lds
    buffer_load_dwordx4 v16, s[16:19], s44 offen offset:2048 sc1 lds
    buffer_load_dwordx4 v17, s[16:19], s44 offen offset:3072 sc1 lds
    s_add_u32 s44, s44, 256
    s_add_u32 s48, s48, 1
    s_cmp_eq_u32 s48, 4
    s_mov_b32 s47, 36864
    s_cselect_b32 s47, 0xfffe5000, s47
    s_cselect_b32 s48, 0, s48
    s_add_u32 s42, s42, s47
    s_mov_b32 m0, s40
    s_add_u32 s49, s43, 4096
    buffer_load_dwordx4 v8, s[12:15], s43 offen offset:0 sc1 lds
    buffer_load_dwordx4 v8, s[12:15], s43 offen offset:1024 sc1 lds
    buffer_load_dwordx4 v8, s[12:15], s43 offen offset:2048 sc1 lds
    buffer_load_dwordx4 v8, s[12:15], s43 offen offset:3072 sc1 lds
    s_add_u32 m0, s40, 4096
    s_add_u32 s43, s43, 20480
    buffer_load_dwordx4 v8, s[12:15], s49 offen sc1 lds
    s_add_u32 s46, s46, 1
    s_cmp_eq_u32 s46, 4
    s_mov_b32 s47, 36864
    s_cselect_b32 s47, 0xfffe5000, s47
    s_cselect_b32 s46, 0, s46
    s_add_u32 s40, s40, s47
    s_waitcnt vmcnt(19)
    s_barrier
    s_mov_b32 s50, -1
    s_mov_b32 s51, 0x1ff
    s_waitcnt vmcnt(18)
    v_cmp_eq_u32 vcc, s78, v26
    v_cmp_eq_u32 s[52:53], s79, v27
    s_nop 3
    s_and_b64 vcc, vcc, s[52:53]
    s_and_b64 vcc, vcc, s[50:51]
    s_cmp_eq_u64 vcc, s[50:51]
    s_cbranch_scc1 L_uok_111
    s_mov_b32 s54, 65536
L_wf_112:
    buffer_load_dwordx2 v[26:27], v25, s[24:27], 0 offen sc1
    s_waitcnt vmcnt(0)
    v_cmp_eq_u32 vcc, s78, v26
    v_cmp_eq_u32 s[52:53], s79, v27
    s_nop 3
    s_and_b64 vcc, vcc, s[52:53]
    s_and_b64 vcc, vcc, s[50:51]
    s_cmp_eq_u64 vcc, s[50:51]
    s_cbranch_scc1 L_wfd_113
    s_sleep 4
    s_sub_u32 s54, s54, 1
    s_cmp_lg_u32 s54, 0
    s_cbranch_scc1 L_wf_112
L_wfd_113:
    s_waitcnt vmcnt(0)
L_uok_111:
    s_mov_b32 m0, s42
    s_nop 0
    buffer_load_dwordx4 v18, s[20:23], s45 offen offset:0 sc1 lds
    buffer_load_dwordx4 v19, s[20:23], s45 offen offset:1024 sc1 lds
    buffer_load_dwordx4 v20, s[20:23], s45 offen offset:2048 sc1 lds
    buffer_load_dwordx4 v21, s[20:23], s45 offen offset:3072 sc1 lds
    s_add_u32 s45, s45, 540672
    s_sub_u32 m0, s42, 20480
    s_nop 0
    buffer_load_dwordx4 v18, s[20:23], s45 offen offset:0 sc1 lds
    buffer_load_dwordx4 v19, s[20:23], s45 offen offset:1024 sc1 lds
    buffer_load_dwordx4 v20, s[20:23], s45 offen offset:2048 sc1 lds
    buffer_load_dwordx4 v21, s[20:23], s45 offen offset:3072 sc1 lds
    s_add_u32 s45, s45, 540672
    s_add_u32 s48, s48, 1
    s_cmp_eq_u32 s48, 4
    s_mov_b32 s47, 36864
    s_cselect_b32 s47, 0xfffe5000, s47
    s_cselect_b32 s48, 0, s48
    s_add_u32 s42, s42, s47
    s_waitcnt vmcnt(17)
    s_barrier
    s_mov_b32 m0, s42
    s_nop 0
    buffer_load_dwordx4 v18, s[20:23], s45 offen offset:0 sc1 lds
    buffer_load_dwordx4 v19, s[20:23], s45 offen offset:1024 sc1 lds
    buffer_load_dwordx4 v20, s[20:23], s45 offen offset:2048 sc1 lds
    buffer_load_dwordx4 v21, s[20:23], s45 offen offset:3072 sc1 lds
    s_add_u32 s45, s45, 540672
    s_sub_u32 m0, s42, 20480
    s_nop 0
    buffer_load_dwordx4 v18, s[20:23], s45 offen offset:0 sc1 lds
    buffer_load_dwordx4 v19, s[20:23], s45 offen offset:1024 sc1 lds
    buffer_load_dwordx4 v20, s[20:23], s45 offen offset:2048 sc1 lds
    buffer_load_dwordx4 v21, s[20:23], s45 offen offset:3072 sc1 lds
    s_add_u32 s45, s45, 540672
    s_add_u32 s48, s48, 1
    s_cmp_eq_u32 s48, 4
    s_mov_b32 s47, 36864
    s_cselect_b32 s47, 0xfffe5000, s47
    s_cselect_b32 s48, 0, s48
    s_add_u32 s42, s42, s47
    s_waitcnt vmcnt(16)
    s_barrier
    s_mov_b32 m0, s42
    s_nop 0
    buffer_load_dwordx4 v18, s[20:23], s45 offen offset:0 sc1 lds
    buffer_load_dwordx4 v19, s[20:23], s45 offen offset:1024 sc1 lds
    buffer_load_dwordx4 v20, s[20:23], s45 offen offset:2048 sc1 lds
    buffer_load_dwordx4 v21, s[20:23], s45 offen offset:3072 sc1 lds
    s_add_u32 s45, s45, 540672
    s_add_u32 s48, s48, 1
    s_cmp_eq_u32 s48, 4
    s_mov_b32 s47, 36864
    s_cselect_b32 s47, 0xfffe5000, s47
    s_cselect_b32 s48, 0, s48
    s_add_u32 s42, s42, s47
    s_waitcnt vmcnt(12)
    s_barrier
    s_waitcnt vmcnt(4)
    s_barrier
    s_waitcnt vmcnt(0)
    s_barrier
    s_branch L_lend_110
L_colwg_109:
    s_mov_b32 m0, s40
    s_add_u32 s49, s43, 4096
    buffer_load_dwordx4 v8, s[12:15], s43 offen offset:0 sc1 lds
    buffer_load_dwordx4 v8, s[12:15], s43 offen offset:1024 sc1 lds
    buffer_load_dwordx4 v8, s[12:15], s43 offen offset:2048 sc1 lds
    buffer_load_dwordx4 v8, s[12:15], s43 offen offset:3072 sc1 lds
    s_add_u32 m0, s40, 4096
    s_add_u32 s43, s43, 20480
    buffer_load_dwordx4 v8, s[12:15], s49 offen sc1 lds
    s_add_u32 s46, s46, 1
    s_cmp_eq_u32 s46, 4
    s_mov_b32 s47, 36864
    s_cselect_b32 s47, 0xfffe5000, s47
    s_cselect_b32 s46, 0, s46
    s_add_u32 s40, s40, s47
    s_barrier
    s_barrier
    s_barrier
    s_mov_b32 m0, s42
    s_nop 0
    buffer_load_dwordx4 v14, s[16:19], s44 offen offset:0 sc1 lds
    buffer_load_dwordx4 v15, s[16:19], s44 offen offset:1024 sc1 lds
    buffer_load_dwordx4 v16, s[16:19], s44 offen offset:2048 sc1 lds
    buffer_load_dwordx4 v17, s[16:19], s44 offen offset:3072 sc1 lds
    s_add_u32 s44, s44, 256
    s_add_u32 s48, s48, 1
    s_cmp_eq_u32 s48, 4
    s_mov_b32 s47, 36864
    s_cselect_b32 s47, 0xfffe5000, s47
    s_cselect_b32 s48, 0, s48
    s_add_u32 s42, s42, s47
    s_waitcnt vmcnt(9)
    s_lshl_b32 s52, s55, 3
    s_add_u32 s52, s52, 9216
    v_mov_b32 v28, 147464
    v_mov_b32 v29, 1
    s_mov_b64 s[36:37], exec
    s_mov_b64 exec, 1
    ds_add_rtn_u32 v30, v28, v29
    s_mov_b64 exec, s[36:37]
    s_waitcnt lgkmcnt(0)
    v_readfirstlane_b32 s36, v30
    s_nop 3
    s_cmp_lg_u32 s36, 7
    s_cbranch_scc1 L_arr_114
    s_add_u32 s24, s76, 29360128
    s_addc_u32 s25, s77, 0
    s_mov_b32 s26, 16384
    s_mov_b32 s27, 0x20000
    v_mov_b32 v28, s78
    v_mov_b32 v29, s79
    v_mov_b32 v30, s52
    s_mov_b64 s[36:37], exec
    s_mov_b64 exec, 1
    buffer_store_dwordx2 v[28:29], v30, s[24:27], 0 offen sc1
    s_mov_b64 exec, s[36:37]
L_arr_114:
    s_mov_b32 m0, s40
    s_add_u32 s49, s43, 4096
    buffer_load_dwordx4 v8, s[12:15], s43 offen offset:0 sc1 lds
    buffer_load_dwordx4 v8, s[12:15], s43 offen offset:1024 sc1 lds
    buffer_load_dwordx4 v8, s[12:15], s43 offen offset:2048 sc1 lds
    buffer_load_dwordx4 v8, s[12:15], s43 offen offset:3072 sc1 lds
    s_add_u32 m0, s40, 4096
    s_add_u32 s43, s43, 20480
    buffer_load_dwordx4 v8, s[12:15], s49 offen sc1 lds
    s_add_u32 s46, s46, 1
    s_cmp_eq_u32 s46, 4
    s_mov_b32 s47, 36864
    s_cselect_b32 s47, 0xfffe5000, s47
    s_cselect_b32 s46, 0, s46
    s_add_u32 s40, s40, s47
    s_mov_b32 m0, s42
    s_nop 0
    buffer_load_dwordx4 v14, s[16:19], s44 offen offset:0 sc1 lds
    buffer_load_dwordx4 v15, s[16:19], s44 offen offset:1024 sc1 lds
    buffer_load_dwordx4 v16, s[16:19], s44 offen offset:2048 sc1 lds
    buffer_load_dwordx4 v17, s[16:19], s44 offen offset:3072 sc1 lds
    s_add_u32 s44, s44, 256
    s_add_u32 s48, s48, 1
    s_cmp_eq_u32 s48, 4
    s_mov_b32 s47, 36864
    s_cselect_b32 s47, 0xfffe5000, s47
    s_cselect_b32 s48, 0, s48
    s_add_u32 s42, s42, s47
    s_waitcnt vmcnt(9)
    s_barrier
    s_mov_b32 m0, s42
    s_nop 0
    buffer_load_dwordx4 v14, s[16:19], s44 offen offset:0 sc1 lds
    buffer_load_dwordx4 v15, s[16:19], s44 offen offset:1024 sc1 lds
    buffer_load_dwordx4 v16, s[16:19], s44 offen offset:2048 sc1 lds
    buffer_load_dwordx4 v17, s[16:19], s44 offen offset:3072 sc1 lds
    s_add_u32 s44, s44, 256
    s_add_u32 s48, s48, 1
    s_cmp_eq_u32 s48, 4
    s_mov_b32 s47, 36864
    s_cselect_b32 s47, 0xfffe5000, s47
    s_cselect_b32 s48, 0, s48
    s_add_u32 s42, s42, s47
    s_mov_b32 m0, s40
    s_add_u32 s49, s43, 4096
    buffer_load_dwordx4 v8, s[12:15], s43 offen offset:0 sc1 lds
    buffer_load_dwordx4 v8, s[12:15], s43 offen offset:1024 sc1 lds
    buffer_load_dwordx4 v8, s[12:15], s43 offen offset:2048 sc1 lds
    buffer_load_dwordx4 v8, s[12:15], s43 offen offset:3072 sc1 lds
    s_add_u32 m0, s40, 4096
    s_add_u32 s43, s43, 20480
    buffer_load_dwordx4 v8, s[12:15], s49 offen sc1 lds
    s_add_u32 s46, s46, 1
    s_cmp_eq_u32 s46, 4
    s_mov_b32 s47, 36864
    s_cselect_b32 s47, 0xfffe5000, s47
    s_cselect_b32 s46, 0, s46
    s_add_u32 s40, s40, s47
    s_mov_b32 m0, s42
    s_nop 0
    buffer_load_dwordx4 v14, s[16:19], s44 offen offset:0 sc1 lds
    buffer_load_dwordx4 v15, s[16:19], s44 offen offset:1024 sc1 lds
    buffer_load_dwordx4 v16, s[16:19], s44 offen offset:2048 sc1 lds
    buffer_load_dwordx4 v17, s[16:19], s44 offen offset:3072 sc1 lds
    s_add_u32 s44, s44, 256
    s_add_u32 s48, s48, 1
    s_cmp_eq_u32 s48, 4
    s_mov_b32 s47, 36864
    s_cselect_b32 s47, 0xfffe5000, s47
    s_cselect_b32 s48, 0, s48
    s_add_u32 s42, s42, s47
    s_mov_b32 m0, s40
    s_add_u32 s49, s43, 4096
    buffer_load_dwordx4 v8, s[12:15], s43 offen offset:0 sc1 lds
    buffer_load_dwordx4 v8, s[12:15], s43 offen offset:1024 sc1 lds
    buffer_load_dwordx4 v8, s[12:15], s43 offen offset:2048 sc1 lds
    buffer_load_dwordx4 v8, s[12:15], s43 offen offset:3072 sc1 lds
    s_add_u32 m0, s40, 4096
    s_add_u32 s43, s43, 20480
    buffer_load_dwordx4 v8, s[12:15], s49 offen sc1 lds
    s_add_u32 s46, s46, 1
    s_cmp_eq_u32 s46, 4
    s_mov_b32 s47, 36864
    s_cselect_b32 s47, 0xfffe5000, s47
    s_cselect_b32 s46, 0, s46
    s_add_u32 s40, s40, s47
    s_waitcnt vmcnt(18)
    s_barrier
    s_mov_b32 m0, s42
    s_nop 0
    buffer_load_dwordx4 v14, s[16:19], s44 offen offset:0 sc1 lds
    buffer_load_dwordx4 v15, s[16:19], s44 offen offset:1024 sc1 lds
    buffer_load_dwordx4 v16, s[16:19], s44 offen offset:2048 sc1 lds
    buffer_load_dwordx4 v17, s[16:19], s44 offen offset:3072 sc1 lds
    s_add_u32 s44, s44, 256
    s_add_u32 s48, s48, 1
    s_cmp_eq_u32 s48, 4
    s_mov_b32 s47, 36864
    s_cselect_b32 s47, 0xfffe5000, s47
    s_cselect_b32 s48, 0, s48
    s_add_u32 s42, s42, s47
    s_mov_b32 m0, s40
    s_add_u32 s49, s43, 4096
    buffer_load_dwordx4 v8, s[12:15], s43 offen offset:0 sc1 lds
    buffer_load_dwordx4 v8, s[12:15], s43 offen offset:1024 sc1 lds
    buffer_load_dwordx4 v8, s[12:15], s43 offen offset:2048 sc1 lds
    buffer_load_dwordx4 v8, s[12:15], s43 offen offset:3072 sc1 lds
    s_add_u32 m0, s40, 4096
    s_add_u32 s43, s43, 20480
    buffer_load_dwordx4 v8, s[12:15], s49 offen sc1 lds
    s_add_u32 s46, s46, 1
    s_cmp_eq_u32 s46, 4
    s_mov_b32 s47, 36864
    s_cselect_b32 s47, 0xfffe5000, s47
    s_cselect_b32 s46, 0, s46
    s_add_u32 s40, s40, s47
    s_waitcnt vmcnt(18)
    s_barrier
    s_mov_b32 m0, s42
    s_nop 0
    buffer_load_dwordx4 v14, s[16:19], s44 offen offset:0 sc1 lds
    buffer_load_dwordx4 v15, s[16:19], s44 offen offset:1024 sc1 lds
    buffer_load_dwordx4 v16, s[16:19], s44 offen offset:2048 sc1 lds
    buffer_load_dwordx4 v17, s[16:19], s44 offen offset:3072 sc1 lds
    s_add_u32 s44, s44, 256
    s_add_u32 s48, s48, 1
    s_cmp_eq_u32 s48, 4
    s_mov_b32 s47, 36864
    s_cselect_b32 s47, 0xfffe5000, s47
    s_cselect_b32 s48, 0, s48
    s_add_u32 s42, s42, s47
    s_mov_b32 m0, s40
    s_add_u32 s49, s43, 4096
    buffer_load_dwordx4 v8, s[12:15], s43 offen offset:0 sc1 lds
    buffer_load_dwordx4 v8, s[12:15], s43 offen offset:1024 sc1 lds
    buffer_load_dwordx4 v8, s[12:15], s43 offen offset:2048 sc1 lds
    buffer_load_dwordx4 v8, s[12:15], s43 offen offset:3072 sc1 lds
    s_add_u32 m0, s40, 4096
    s_add_u32 s43, s43, 20480
    buffer_load_dwordx4 v8, s[12:15], s49 offen sc1 lds
    s_add_u32 s46, s46, 1
    s_cmp_eq_u32 s46, 4
    s_mov_b32 s47, 36864
    s_cselect_b32 s47, 0xfffe5000, s47
    s_cselect_b32 s46, 0, s46
    s_add_u32 s40, s40, s47
    s_waitcnt vmcnt(18)
    s_barrier
    s_mov_b32 m0, s42
    s_nop 0
    buffer_load_dwordx4 v14, s[16:19], s44 offen offset:0 sc1 lds
    buffer_load_dwordx4 v15, s[16:19], s44 offen offset:1024 sc1 lds
    buffer_load_dwordx4 v16, s[16:19], s44 offen offset:2048 sc1 lds
    buffer_load_dwordx4 v17, s[16:19], s44 offen offset:3072 sc1 lds
    s_add_u32 s44, s44, 256
    s_add_u32 s48, s48, 1
    s_cmp_eq_u32 s48, 4
    s_mov_b32 s47, 36864
    s_cselect_b32 s47, 0xfffe5000, s47
    s_cselect_b32 s48, 0, s48
    s_add_u32 s42, s42, s47
    s_mov_b32 m0, s40
    s_add_u32 s49, s43, 4096
    buffer_load_dwordx4 v8, s[12:15], s43 offen offset:0 sc1 lds
    buffer_load_dwordx4 v8, s[12:15], s43 offen offset:1024 sc1 lds
    buffer_load_dwordx4 v8, s[12:15], s43 offen offset:2048 sc1 lds
    buffer_load_dwordx4 v8, s[12:15], s43 offen offset:3072 sc1 lds
    s_add_u32 m0, s40, 4096
    s_add_u32 s43, s43, 20480
    buffer_load_dwordx4 v8, s[12:15], s49 offen sc1 lds
    s_add_u32 s46, s46, 1
    s_cmp_eq_u32 s46, 4
    s_mov_b32 s47, 36864
    s_cselect_b32 s47, 0xfffe5000, s47
    s_cselect_b32 s46, 0, s46
    s_add_u32 s40, s40, s47
    s_waitcnt vmcnt(18)
    s_barrier
    s_mov_b32 m0, s42
    s_nop 0
    buffer_load_dwordx4 v14, s[16:19], s44 offen offset:0 sc1 lds
    buffer_load_dwordx4 v15, s[16:19], s44 offen offset:1024 sc1 lds
    buffer_load_dwordx4 v16, s[16:19], s44 offen offset:2048 sc1 lds
    buffer_load_dwordx4 v17, s[16:19], s44 offen offset:3072 sc1 lds
    s_add_u32 s44, s44, 256
    s_add_u32 s48, s48, 1
    s_cmp_eq_u32 s48, 4
    s_mov_b32 s47, 36864
    s_cselect_b32 s47, 0xfffe5000, s47
    s_cselect_b32 s48, 0, s48
    s_add_u32 s42, s42, s47
    s_mov_b32 m0, s40
    s_add_u32 s49, s43, 4096
    buffer_load_dwordx4 v8, s[12:15], s43 offen offset:0 sc1 lds
    buffer_load_dwordx4 v8, s[12:15], s43 offen offset:1024 sc1 lds
    buffer_load_dwordx4 v8, s[12:15], s43 offen offset:2048 sc1 lds
    buffer_load_dwordx4 v8, s[12:15], s43 offen offset:3072 sc1 lds
    s_add_u32 m0, s40, 4096
    s_add_u32 s43, s43, 20480
    buffer_load_dwordx4 v8, s[12:15], s49 offen sc1 lds
    s_add_u32 s46, s46, 1
    s_cmp_eq_u32 s46, 4
    s_mov_b32 s47, 36864
    s_cselect_b32 s47, 0xfffe5000, s47
    s_cselect_b32 s46, 0, s46
    s_add_u32 s40, s40, s47
    s_waitcnt vmcnt(18)
    s_barrier
    s_mov_b32 m0, s42
    s_nop 0
    buffer_load_dwordx4 v14, s[16:19], s44 offen offset:0 sc1 lds
    buffer_load_dwordx4 v15, s[16:19], s44 offen offset:1024 sc1 lds
    buffer_load_dwordx4 v16, s[16:19], s44 offen offset:2048 sc1 lds
    buffer_load_dwordx4 v17, s[16:19], s44 offen offset:3072 sc1 lds
    s_add_u32 s44, s44, 256
    s_add_u32 s48, s48, 1
    s_cmp_eq_u32 s48, 4
    s_mov_b32 s47, 36864
    s_cselect_b32 s47, 0xfffe5000, s47
    s_cselect_b32 s48, 0, s48
    s_add_u32 s42, s42, s47
    s_mov_b32 m0, s40
    s_add_u32 s49, s43, 4096
    buffer_load_dwordx4 v8, s[12:15], s43 offen offset:0 sc1 lds
    buffer_load_dwordx4 v8, s[12:15], s43 offen offset:1024 sc1 lds
    buffer_load_dwordx4 v8, s[12:15], s43 offen offset:2048 sc1 lds
    buffer_load_dwordx4 v8, s[12:15], s43 offen offset:3072 sc1 lds
    s_add_u32 m0, s40, 4096
    s_add_u32 s43, s43, 20480
    buffer_load_dwordx4 v8, s[12:15], s49 offen sc1 lds
    s_add_u32 s46, s46, 1
    s_cmp_eq_u32 s46, 4
    s_mov_b32 s47, 36864
    s_cselect_b32 s47, 0xfffe5000, s47
    s_cselect_b32 s46, 0, s46
    s_add_u32 s40, s40, s47
    s_waitcnt vmcnt(18)
    s_barrier
    s_mov_b32 m0, s42
    s_nop 0
    buffer_load_dwordx4 v14, s[16:19], s44 offen offset:0 sc1 lds
    buffer_load_dwordx4 v15, s[16:19], s44 offen offset:1024 sc1 lds
    buffer_load_dwordx4 v16, s[16:19], s44 offen offset:2048 sc1 lds
    buffer_load_dwordx4 v17, s[16:19], s44 offen offset:3072 sc1 lds
    s_add_u32 s44, s44, 256
    s_add_u32 s48, s48, 1
    s_cmp_eq_u32 s48, 4
    s_mov_b32 s47, 36864
    s_cselect_b32 s47, 0xfffe5000, s47
    s_cselect_b32 s48, 0, s48
    s_add_u32 s42, s42, s47
    s_mov_b32 m0, s40
    s_add_u32 s49, s43, 4096
    buffer_load_dwordx4 v8, s[12:15], s43 offen offset:0 sc1 lds
    buffer_load_dwordx4 v8, s[12:15], s43 offen offset:1024 sc1 lds
    buffer_load_dwordx4 v8, s[12:15], s43 offen offset:2048 sc1 lds
    buffer_load_dwordx4 v8, s[12:15], s43 offen offset:3072 sc1 lds
    s_add_u32 m0, s40, 4096
    s_add_u32 s43, s43, 20480
    buffer_load_dwordx4 v8, s[12:15], s49 offen sc1 lds
    s_add_u32 s46, s46, 1
    s_cmp_eq_u32 s46, 4
    s_mov_b32 s47, 36864
    s_cselect_b32 s47, 0xfffe5000, s47
    s_cselect_b32 s46, 0, s46
    s_add_u32 s40, s40, s47
    s_waitcnt vmcnt(18)
    s_barrier
    buffer_load_dwordx2 v[26:27], v25, s[24:27], 0 offen sc1
    s_mov_b32 m0, s42
    s_nop 0
    buffer_load_dwordx4 v14, s[16:19], s44 offen offset:0 sc1 lds
    buffer_load_dwordx4 v15, s[16:19], s44 offen offset:1024 sc1 lds
    buffer_load_dwordx4 v16, s[16:19], s44 offen offset:2048 sc1 lds
    buffer_load_dwordx4 v17, s[16:19], s44 offen offset:3072 sc1 lds
    s_add_u32 s44, s44, 256
    s_add_u32 s48, s48, 1
    s_cmp_eq_u32 s48, 4
    s_mov_b32 s47, 36864
    s_cselect_b32 s47, 0xfffe5000, s47
    s_cselect_b32 s48, 0, s48
    s_add_u32 s42, s42, s47
    s_mov_b32 m0, s40
    s_add_u32 s49, s43, 4096
    buffer_load_dwordx4 v8, s[12:15], s43 offen offset:0 sc1 lds
    buffer_load_dwordx4 v8, s[12:15], s43 offen offset:1024 sc1 lds
    buffer_load_dwordx4 v8, s[12:15], s43 offen offset:2048 sc1 lds
    buffer_load_dwordx4 v8, s[12:15], s43 offen offset:3072 sc1 lds
    s_add_u32 m0, s40, 4096
    s_add_u32 s43, s43, 20480
    buffer_load_dwordx4 v8, s[12:15], s49 offen sc1 lds
    s_add_u32 s46, s46, 1
    s_cmp_eq_u32 s46, 4
    s_mov_b32 s47, 36864
    s_cselect_b32 s47, 0xfffe5000, s47
    s_cselect_b32 s46, 0, s46
    s_add_u32 s40, s40, s47
    s_waitcnt vmcnt(19)
    s_barrier
    s_mov_b32 m0, s42
    s_nop 0
    buffer_load_dwordx4 v14, s[16:19], s44 offen offset:0 sc1 lds
    buffer_load_dwordx4 v15, s[16:19], s44 offen offset:1024 sc1 lds
    buffer_load_dwordx4 v16, s[16:19], s44 offen offset:2048 sc1 lds
    buffer_load_dwordx4 v17, s[16:19], s44 offen offset:3072 sc1 lds
    s_add_u32 s44, s44, 256
    s_add_u32 s48, s48, 1
    s_cmp_eq_u32 s48, 4
    s_mov_b32 s47, 36864
    s_cselect_b32 s47, 0xfffe5000, s47
    s_cselect_b32 s48, 0, s48
    s_add_u32 s42, s42, s47
    s_mov_b32 m0, s40
    s_add_u32 s49, s43, 4096
    buffer_load_dwordx4 v8, s[12:15], s43 offen offset:0 sc1 lds
    buffer_load_dwordx4 v8, s[12:15], s43 offen offset:1024 sc1 lds
    buffer_load_dwordx4 v8, s[12:15], s43 offen offset:2048 sc1 lds
    buffer_load_dwordx4 v8, s[12:15], s43 offen offset:3072 sc1 lds
    s_add_u32 m0, s40, 4096
    s_add_u32 s43, s43, 20480
    buffer_load_dwordx4 v8, s[12:15], s49 offen sc1 lds
    s_add_u32 s46, s46, 1
    s_cmp_eq_u32 s46, 4
    s_mov_b32 s47, 36864
    s_cselect_b32 s47, 0xfffe5000, s47
    s_cselect_b32 s46, 0, s46
    s_add_u32 s40, s40, s47
    s_waitcnt vmcnt(19)
    s_barrier
    s_mov_b32 s50, -1
    s_mov_b32 s51, 0x1ff
    s_waitcnt vmcnt(18)
    v_cmp_eq_u32 vcc, s78, v26
    v_cmp_eq_u32 s[52:53], s79, v27
    s_nop 3
    s_and_b64 vcc, vcc, s[52:53]
    s_and_b64 vcc, vcc, s[50:51]
    s_cmp_eq_u64 vcc, s[50:51]
    s_cbranch_scc1 L_uok_115
    s_mov_b32 s54, 65536
L_wf_116:
    buffer_load_dwordx2 v[26:27], v25, s[24:27], 0 offen sc1
    s_waitcnt vmcnt(0)
    v_cmp_eq_u32 vcc, s78, v26
    v_cmp_eq_u32 s[52:53], s79, v27
    s_nop 3
    s_and_b64 vcc, vcc, s[52:53]
    s_and_b64 vcc, vcc, s[50:51]
    s_cmp_eq_u64 vcc, s[50:51]
    s_cbranch_scc1 L_wfd_117
    s_sleep 4
    s_sub_u32 s54, s54, 1
    s_cmp_lg_u32 s54, 0
    s_cbranch_scc1 L_wf_116
L_wfd_117:
    s_waitcnt vmcnt(0)
L_uok_115:
    s_mov_b32 m0, s42
    s_nop 0
    buffer_load_dwordx4 v18, s[20:23], s45 offen offset:0 sc1 lds
    buffer_load_dwordx4 v19, s[20:23], s45 offen offset:1024 sc1 lds
    buffer_load_dwordx4 v20, s[20:23], s45 offen offset:2048 sc1 lds
    buffer_load_dwordx4 v21, s[20:23], s45 offen offset:3072 sc1 lds
    s_add_u32 s45, s45, 540672
    s_sub_u32 m0, s42, 20480
    s_nop 0
    buffer_load_dwordx4 v18, s[20:23], s45 offen offset:0 sc1 lds
    buffer_load_dwordx4 v19, s[20:23], s45 offen offset:1024 sc1 lds
    buffer_load_dwordx4 v20, s[20:23], s45 offen offset:2048 sc1 lds
    buffer_load_dwordx4 v21, s[20:23], s45 offen offset:3072 sc1 lds
    s_add_u32 s45, s45, 540672
    s_add_u32 s48, s48, 1
    s_cmp_eq_u32 s48, 4
    s_mov_b32 s47, 36864
    s_cselect_b32 s47, 0xfffe5000, s47
    s_cselect_b32 s48, 0, s48
    s_add_u32 s42, s42, s47
    s_waitcnt vmcnt(17)
    s_barrier
    s_mov_b32 m0, s42
    s_nop 0
    buffer_load_dwordx4 v18, s[20:23], s45 offen offset:0 sc1 lds
    buffer_load_dwordx4 v19, s[20:23], s45 offen offset:1024 sc1 lds
    buffer_load_dwordx4 v20, s[20:23], s45 offen offset:2048 sc1 lds
    buffer_load_dwordx4 v21, s[20:23], s45 offen offset:3072 sc1 lds
    s_add_u32 s45, s45, 540672
    s_sub_u32 m0, s42, 20480
    s_nop 0
    buffer_load_dwordx4 v18, s[20:23], s45 offen offset:0 sc1 lds
    buffer_load_dwordx4 v19, s[20:23], s45 offen offset:1024 sc1 lds
    buffer_load_dwordx4 v20, s[20:23], s45 offen offset:2048 sc1 lds
    buffer_load_dwordx4 v21, s[20:23], s45 offen offset:3072 sc1 lds
    s_add_u32 s45, s45, 540672
    s_add_u32 s48, s48, 1
    s_cmp_eq_u32 s48, 4
    s_mov_b32 s47, 36864
    s_cselect_b32 s47, 0xfffe5000, s47
    s_cselect_b32 s48, 0, s48
    s_add_u32 s42, s42, s47
    s_waitcnt vmcnt(16)
    s_barrier
    s_mov_b32 m0, s42
    s_nop 0
    buffer_load_dwordx4 v18, s[20:23], s45 offen offset:0 sc1 lds
    buffer_load_dwordx4 v19, s[20:23], s45 offen offset:1024 sc1 lds
    buffer_load_dwordx4 v20, s[20:23], s45 offen offset:2048 sc1 lds
    buffer_load_dwordx4 v21, s[20:23], s45 offen offset:3072 sc1 lds
    s_add_u32 s45, s45, 540672
    s_add_u32 s48, s48, 1
    s_cmp_eq_u32 s48, 4
    s_mov_b32 s47, 36864
    s_cselect_b32 s47, 0xfffe5000, s47
    s_cselect_b32 s48, 0, s48
    s_add_u32 s42, s42, s47
    s_waitcnt vmcnt(12)
    s_barrier
    s_waitcnt vmcnt(4)
    s_barrier
    s_waitcnt vmcnt(0)
    s_barrier
L_lend_110:
L_end_1:
    s_endpgm
code_end_label:
.section .rodata,"a"
.p2align 6
.amdhsa_kernel gated_mix__spectral_gfnet__swiglu_ffn__prompt_kernel
  .amdhsa_next_free_vgpr 256
  .amdhsa_next_free_sgpr 102
  .amdhsa_accum_offset 256
  .amdhsa_group_segment_fixed_size 0
  .amdhsa_kernarg_size 88
  .amdhsa_user_sgpr_count 2
  .amdhsa_user_sgpr_kernarg_segment_ptr 1
  .amdhsa_system_sgpr_workgroup_id_x 1
  .amdhsa_float_denorm_mode_32 3
.end_amdhsa_kernel
.p2align 8
tbl_p2:
.long 0x3f803f80,0x3f803f80,0x3f803f80,0x3f803f80,0x3f7b3f80,0x3f553f6d,0xbe48248d,0xbf0ebec4,0x3f6d3f80,0x3ec43f35,0xbf6dbf80,0xbec4bf35,0x3f553f80,0xbe483ec4,0x3f0ea554,0x3f7b3f6d
.long 0x3f353f80,0xbf35248d,0x3f353f80,0xbf3525b0,0x3f0e3f80,0xbf7bbec4,0xbf5525b0,0xbe48bf6d,0x3ec43f80,0xbf6dbf35,0xbec4bf80,0x3f6d3f35,0x3e483f80,0xbf0ebf6d,0x3f7ba5f7,0xbf553ec4
.long 0x248d3f80,0xa554bf80,0x261f3f80,0xa731bf80,0xbe483f80,0x3f0ebf6d,0xbf7b261f,0x3f553ec4,0xbec43f80,0x3f6dbf35,0x3ec4bf80,0xbf6d3f35,0xbf0e3f80,0x3f7bbec4,0x3f55a731,0x3e48bf6d
.long 0xbf353f80,0x3f35a554,0xbf353f80,0x3f35a742,0xbf553f80,0x3e483ec4,0xbf0ea68d,0xbf7b3f6d,0xbf6d3f80,0xbec43f35,0x3f6dbf80,0x3ec4bf35,0xbf7b3f80,0xbf553f6d,0x3e48a742,0x3f0ebec4
.long 0xbf803f80,0xbf803f80,0xbf803f80,0xbf803f80,0xbf7b3f80,0xbf553f6d,0x3e48a654,0x3f0ebec4,0xbf6d3f80,0xbec43f35,0x3f6dbf80,0x3ec4bf35,0xbf553f80,0x3e483ec4,0xbf0ea754,0xbf7b3f6d
.long 0xbf353f80,0x3f3525b0,0xbf353f80,0x3f35a58e,0xbf0e3f80,0x3f7bbec4,0x3f55a60d,0x3e48bf6d,0xbec43f80,0x3f6dbf35,0x3ec4bf80,0xbf6d3f35,0xbe483f80,0x3f0ebf6d,0xbf7ba765,0x3f553ec4
.long 0xa5543f80,0x261fbf80,0xa7773f80,0x258dbf80,0x3e483f80,0xbf0ebf6d,0x3f7ba58e,0xbf553ec4,0x3ec43f80,0xbf6dbf35,0xbec4bf80,0x3f6d3f35,0x3f0e3f80,0xbf7bbec4,0xbf55a777,0xbe48bf6d
.long 0x3f353f80,0xbf35a5f7,0x3f353f80,0xbf35a78d,0x3f553f80,0xbe483ec4,0x3f0ea137,0x3f7b3f6d,0x3f6d3f80,0x3ec43f35,0xbf6dbf80,0xbec4bf35,0x3f7b3f80,0x3f553f6d,0xbe48a784,0xbf0ebec4
.long 0x3f803f80,0x3f803f80,0x3f803f80,0x3f803f80,0x3f0e3f35,0x3e483ec4,0xbf55bf35,0xbf7bbf6d,0xbec4248d,0xbf6dbf35,0x3ec4a554,0x3f6d3f35,0xbf7bbf35,0xbf0ebf6d,0x3e483f35,0xbf55bec4
.long 0xbf35bf80,0x3f35a554,0xbf35bf80,0x3f35a5f7,0x3e48bf35,0x3f553f6d,0x3f7b3f35,0xbf0e3ec4,0x3f6da554,0xbec43f35,0xbf6d261f,0x3ec4bf35,0x3f553f35,0xbf7bbec4,0x3f0ebf35,0xbe483f6d
.long 0x25b03f80,0xa5f7bf80,0xa68d3f80,0xa742bf80,0xbf553f35,0x3f7bbec4,0xbf0ebf35,0x3e483f6d,0xbf6d25b0,0x3ec43f35,0x3f6da742,0xbec4bf35,0xbe48bf35,0xbf553f6d,0xbf7b3f35,0x3f0e3ec4
.long 0x3f35bf80,0xbf35261f,0x3f35bf80,0xbf35a60d,0x3f7bbf35,0x3f0ebf6d,0xbe483f35,0x3f55bec4,0x3ec4a5f7,0x3f6dbf35,0xbec4a60d,0xbf6d3f35,0xbf0e3f35,0xbe483ec4,0x3f55bf35,0x3f7bbf6d
.long 0xbf803f80,0xbf803f80,0xbf803f80,0xbf803f80,0xbf0e3f35,0xbe483ec4,0x3f55bf35,0x3f7bbf6d,0x3ec4261f,0x3f6dbf35,0xbec4a777,0xbf6d3f35,0x3f7bbf35,0x3f0ebf6d,0xbe483f35,0x3f55bec4
.long 0x3f35bf80,0xbf35a742,0x3f35bf80,0xbf35a78d,0xbe48bf35,0xbf553f6d,0xbf7b3f35,0x3f0e3ec4,0xbf6da731,0x3ec43f35,0x3f6d2804,0xbec4bf35,0xbf553f35,0x3f7bbec4,0xbf0ebf35,0x3e483f6d
.long 0xa7423f80,0xa60dbf80,0xa7963f80,0x268dbf80,0x3f553f35,0xbf7bbec4,0x3f0ebf35,0xbe483f6d,0x3f6da68d,0xbec43f35,0xbf6d2754,0x3ec4bf35,0x3e48bf35,0x3f553f6d,0x3f7b3f35,0xbf0e3ec4
.long 0xbf35bf80,0x3f35a60d,0xbf35bf80,0x3f352816,0xbf7bbf35,0xbf0ebf6d,0x3e483f35,0xbf55bec4,0xbec4a742,0xbf6dbf35,0x3ec42889,0x3f6d3f35,0x3f0e3f35,0x3e483ec4,0xbf55bf35,0xbf7bbf6d
.long 0x3f803f80,0x3f803f80,0x3f803f80,0x3f803f80,0xbf7bbf80,0xbf55bf6d,0x3e48a554,0x3f0e3ec4,0x3f6d3f80,0x3ec43f35,0xbf6dbf80,0xbec4bf35,0xbf55bf80,0x3e48bec4,0xbf0e261f,0xbf7bbf6d
.long 0x3f353f80,0xbf35261f,0x3f353f80,0xbf35a68d,0xbf0ebf80,0x3f7b3ec4,0x3f55a742,0x3e483f6d,0x3ec43f80,0xbf6dbf35,0xbec4bf80,0x3f6d3f35,0xbe48bf80,0x3f0e3f6d,0xbf7ba60d,0x3f55bec4
.long 0xa6543f80,0xa754bf80,0xa58e3f80,0xa777bf80,0x3e48bf80,0xbf0e3f6d,0x3f7ba777,0xbf55bec4,0xbec43f80,0x3f6dbf35,0x3ec4bf80,0xbf6d3f35,0x3f0ebf80,0xbf7b3ec4,0xbf552804,0xbe483f6d
.long 0xbf353f80,0x3f35a777,0xbf353f80,0x3f35a796,0x3f55bf80,0xbe48bec4,0x3f0e2754,0x3f7bbf6d,0xbf6d3f80,0xbec43f35,0x3f6dbf80,0x3ec4bf35,0x3f7bbf80,0x3f55bf6d,0xbe482889,0xbf0e3ec4
.long 0xbf803f80,0xbf803f80,0xbf803f80,0xbf803f80,0x3f7bbf80,0x3f55bf6d,0xbe482828,0xbf0e3ec4,0xbf6d3f80,0xbec43f35,0x3f6dbf80,0x3ec4bf35,0x3f55bf80,0xbe48bec4,0x3f0e281f,0x3f7bbf6d
.long 0xbf353f80,0x3f35268d,0xbf353f80,0x3f352828,0x3f0ebf80,0xbf7b3ec4,0xbf5526d4,0xbe483f6d,0xbec43f80,0x3f6dbf35,0x3ec4bf80,0xbf6d3f35,0x3e48bf80,0xbf0e3f6d,0x3f7b2730,0xbf55bec4
.long 0xa7b13f80,0x281fbf80,0xa7e53f80,0x2839bf80,0xbe48bf80,0x3f0e3f6d,0xbf7ba7e5,0x3f55bec4,0x3ec43f80,0xbf6dbf35,0xbec4bf80,0x3f6d3f35,0xbf0ebf80,0x3f7b3ec4,0x3f552839,0x3e483f6d
.long 0x3f353f80,0xbf3526d4,0x3f353f80,0xbf35a804,0xbf55bf80,0x3e48bec4,0xbf0ea880,0xbf7bbf6d,0x3f6d3f80,0x3ec43f35,0xbf6dbf80,0xbec4bf35,0xbf7bbf80,0xbf55bf6d,0x3e4828a3,0x3f0e3ec4
.long 0x3f803f80,0x3f803f80,0x3f803f80,0x3f803f80,0xbf0ebf35,0xbe48bec4,0x3f553f35,0x3f7b3f6d,0xbec425b0,0xbf6dbf35,0x3ec4a5f7,0x3f6d3f35,0x3f7b3f35,0x3f0e3f6d,0xbe48bf35,0x3f553ec4
.long 0xbf35bf80,0x3f35a731,0xbf35bf80,0x3f35a742,0xbe483f35,0xbf55bf6d,0xbf7bbf35,0x3f0ebec4,0x3f6da742,0xbec43f35,0xbf6da60d,0x3ec4bf35,0xbf55bf35,0x3f7b3ec4,0xbf0e3f35,0x3e48bf6d
.long 0xa60d3f80,0xa765bf80,0xa1373f80,0xa784bf80,0x3f55bf35,0xbf7b3ec4,0x3f0e3f35,0xbe48bf6d,0xbf6da58e,0x3ec43f35,0x3f6da78d,0xbec4bf35,0x3e483f35,0x3f55bf6d,0x3f7bbf35,0xbf0ebec4
.long 0x3f35bf80,0xbf35258d,0x3f35bf80,0xbf35268d,0xbf7b3f35,0xbf0e3f6d,0x3e48bf35,0xbf553ec4,0x3ec4a78d,0x3f6dbf35,0xbec42816,0xbf6d3f35,0x3f0ebf35,0x3e48bec4,0xbf553f35,0xbf7b3f6d
.long 0xbf803f80,0xbf803f80,0xbf803f80,0xbf803f80,0x3f0ebf35,0x3e48bec4,0xbf553f35,0xbf7b3f6d,0x3ec4268d,0x3f6dbf35,0xbec426d4,0xbf6d3f35,0xbf7b3f35,0xbf0e3f6d,0x3e48bf35,0xbf553ec4
.long 0x3f35bf80,0xbf35270d,0x3f35bf80,0xbf35a7e5,0x3e483f35,0x3f55bf6d,0x3f7bbf35,0xbf0ebec4,0xbf6da85d,0x3ec43f35,0x3f6d289a,0xbec4bf35,0x3f55bf35,0xbf7b3ec4,0x3f0e3f35,0xbe48bf6d
.long 0x26d43f80,0x2730bf80,0xa8803f80,0x28a3bf80,0xbf55bf35,0x3f7b3ec4,0xbf0e3f35,0x3e48bf6d,0x3f6da7b1,0xbec43f35,0xbf6d28be,0x3ec4bf35,0xbe483f35,0xbf55bf6d,0xbf7bbf35,0x3f0ebec4
.long 0xbf35bf80,0x3f352754,0xbf35bf80,0x3f35a731,0x3f7b3f35,0x3f0e3f6d,0xbe48bf35,0x3f553ec4,0xbec4a7e5,0xbf6dbf35,0x3ec428ea,0x3f6d3f35,0xbf0ebf35,0xbe48bec4,0x3f553f35,0x3f7b3f6d
.long 0x0,0x0,0x0,0x0,0x3e480000,0x3f0e3ec4,0x3f7b3f80,0x3f553f6d,0x3ec40000,0x3f6d3f35,0xbec4250d,0xbf6dbf35,0x3f0e0000,0x3f7b3f6d,0xbf55bf80,0x3e48bec4
.long 0x3f350000,0x3f353f80,0x3f35a58d,0x3f353f80,0x3f550000,0x3e483f6d,0x3f0e3f80,0xbf7bbec4,0x3f6d0000,0xbec43f35,0xbf6d25d4,0x3ec4bf35,0x3f7b0000,0xbf553ec4,0xbe48bf80,0x3f0e3f6d
.long 0x3f800000,0xbf80250d,0x3f80a60d,0xbf802630,0x3f7b0000,0xbf55bec4,0xbe483f80,0x3f0ebf6d,0x3f6d0000,0xbec4bf35,0xbf6d2630,0x3ec43f35,0x3f550000,0x3e48bf6d,0x3f0ebf80,0xbf7b3ec4
.long 0x3f350000,0x3f35bf80,0x3f35a654,0x3f35bf80,0x3f0e0000,0x3f7bbf6d,0xbf553f80,0x3e483ec4,0x3ec40000,0x3f6dbf35,0xbec42677,0xbf6d3f35,0x3e480000,0x3f0ebec4,0x3f7bbf80,0x3f55bf6d
.long 0x250d0000,0x25d4a58d,0x269fa68d,0x27b1a6b0,0xbe480000,0xbf0e3ec4,0xbf7b3f80,0xbf553f6d,0xbec40000,0xbf6d3f35,0x3ec4269f,0x3f6dbf35,0xbf0e0000,0xbf7b3f6d,0x3f55bf80,0xbe48bec4
.long 0xbf350000,0xbf353f80,0xbf35a6b0,0xbf353f80,0xbf550000,0xbe483f6d,0xbf0e3f80,0x3f7bbec4,0xbf6d0000,0x3ec43f35,0x3f6d27b1,0xbec4bf35,0xbf7b0000,0x3f553ec4,0x3e48bf80,0xbf0e3f6d
.long 0xbf800000,0x3f8025d4,0xbf80a6d4,0x3f8027c2,0xbf7b0000,0x3f55bec4,0x3e483f80,0xbf0ebf6d,0xbf6d0000,0x3ec4bf35,0x3f6da70d,0xbec43f35,0xbf550000,0xbe48bf6d,0xbf0ebf80,0x3f7b3ec4
.long 0xbf350000,0xbf35bf80,0xbf35a6f7,0xbf35bf80,0xbf0e0000,0xbf7bbf6d,0x3f553f80,0xbe483ec4,0xbec40000,0xbf6dbf35,0x3ec427c2,0x3f6d3f35,0xbe480000,0xbf0ebec4,0xbf7bbf80,0xbf55bf6d
.long 0x0,0x0,0x0,0x0,0x3f553f35,0x3f7b3f6d,0x3f0e3f35,0x3e483ec4,0x3f6d3f80,0x3ec43f35,0xbf6dbf80,0xbec4bf35,0x3e483f35,0xbf55bec4,0x3f7b3f35,0x3f0e3f6d
.long 0xbf35250d,0xbf35bf80,0xbf3525d4,0xbf35bf80,0xbf7bbf35,0x3f0ebec4,0x3e48bf35,0x3f553f6d,0xbec4bf80,0x3f6d3f35,0x3ec43f80,0xbf6dbf35,0x3f0ebf35,0xbe483f6d,0xbf55bf35,0x3f7b3ec4
.long 0x3f80a58d,0xbf8025d4,0x3f80a654,0xbf802677,0x3f0e3f35,0xbe48bf6d,0xbf553f35,0x3f7bbec4,0xbec43f80,0x3f6dbf35,0x3ec4bf80,0xbf6d3f35,0xbf7b3f35,0x3f0e3ec4,0x3e483f35,0x3f55bf6d
.long 0xbf3525d4,0xbf353f80,0xbf35269f,0xbf353f80,0x3e48bf35,0xbf553ec4,0x3f7bbf35,0x3f0ebf6d,0x3f6dbf80,0x3ec4bf35,0xbf6d3f80,0xbec43f35,0x3f55bf35,0x3f7bbf6d,0x3f0ebf35,0x3e48bec4
.long 0x2630a60d,0x2677a654,0xa70da6d4,0x27c2a6f7,0xbf553f35,0xbf7b3f6d,0xbf0e3f35,0xbe483ec4,0xbf6d3f80,0xbec43f35,0x3f6dbf80,0x3ec4bf35,0xbe483f35,0x3f55bec4,0xbf7b3f35,0xbf0e3f6d
.long 0x3f352630,0x3f35bf80,0x3f3527c2,0x3f35bf80,0x3f7bbf35,0xbf0ebec4,0xbe48bf35,0xbf553f6d,0x3ec4bf80,0xbf6d3f35,0xbec43f80,0x3f6dbf35,0xbf0ebf35,0x3e483f6d,0x3f55bf35,0xbf7b3ec4
.long 0xbf80a654,0x3f80269f,0xbf80a71f,0x3f80a68d,0xbf0e3f35,0x3e48bf6d,0x3f553f35,0xbf7bbec4,0x3ec43f80,0xbf6dbf35,0xbec4bf80,0x3f6d3f35,0x3f7b3f35,0xbf0e3ec4,0xbe483f35,0xbf55bf6d
.long 0x3f352677,0x3f353f80,0x3f35a68d,0x3f353f80,0xbe48bf35,0x3f553ec4,0xbf7bbf35,0xbf0ebf6d,0xbf6dbf80,0xbec4bf35,0x3f6d3f80,0x3ec43f35,0xbf55bf35,0xbf7bbf6d,0xbf0ebf35,0xbe48bec4
.long 0x0,0x0,0x0,0x0,0xbe48250d,0xbf0ebec4,0xbf7bbf80,0xbf55bf6d,0x3ec4a58d,0x3f6d3f35,0xbec425d4,0xbf6dbf35,0xbf0e25d4,0xbf7bbf6d,0x3f553f80,0xbe483ec4
.long 0x3f35a60d,0x3f353f80,0x3f35a654,0x3f353f80,0xbf552630,0xbe48bf6d,0xbf0ebf80,0x3f7b3ec4,0x3f6da654,0xbec43f35,0xbf6d269f,0x3ec4bf35,0xbf7b2677,0x3f55bec4,0x3e483f80,0xbf0ebf6d
.long 0x3f80a68d,0xbf80269f,0x3f80a6d4,0xbf80a70d,0xbf7b269f,0x3f553ec4,0x3e48bf80,0xbf0e3f6d,0x3f6da6b0,0xbec4bf35,0xbf6d27c2,0x3ec43f35,0xbf5527b1,0xbe483f6d,0xbf0e3f80,0x3f7bbec4
.long 0x3f35a6d4,0x3f35bf80,0x3f35a71f,0x3f35bf80,0xbf0ea70d,0xbf7b3f6d,0x3f55bf80,0xbe48bec4,0x3ec4a6f7,0x3f6dbf35,0xbec4a68d,0xbf6d3f35,0xbe4827c2,0xbf0e3ec4,0xbf7b3f80,0xbf553f6d
.long 0xa6d4a70d,0x27d4a71f,0xa60ea754,0x27f7278d,0x3e48a6d4,0x3f0ebec4,0x3f7bbf80,0x3f55bf6d,0xbec4a71f,0xbf6d3f35,0x3ec427f7,0x3f6dbf35,0x3f0e27d4,0x3f7bbf6d,0xbf553f80,0x3e483ec4
.long 0xbf35a730,0xbf353f80,0xbf35a842,0xbf353f80,0x3f55a68d,0x3e48bf6d,0x3f0ebf80,0xbf7b3ec4,0xbf6da831,0x3ec43f35,0x3f6d2884,0xbec4bf35,0x3f7b27e5,0xbf55bec4,0xbe483f80,0x3f0ebf6d
.long 0xbf80a754,0x3f8027f7,0xbf80a79f,0x3f802816,0x3f7ba60e,0xbf553ec4,0xbe48bf80,0x3f0e3f6d,0xbf6d278d,0x3ec4bf35,0x3f6da7d4,0xbec43f35,0x3f5527f7,0x3e483f6d,0x3f0e3f80,0xbf7bbec4
.long 0xbf35a777,0xbf35bf80,0xbf35270d,0xbf35bf80,0x3f0ea1b7,0x3f7b3f6d,0xbf55bf80,0x3e48bec4,0xbec4a842,0xbf6dbf35,0x3ec42909,0x3f6d3f35,0x3e482804,0x3f0e3ec4,0x3f7b3f80,0x3f553f6d
.long 0x0,0x0,0x0,0x0,0xbf55bf35,0xbf7bbf6d,0xbf0ebf35,0xbe48bec4,0x3f6d3f80,0x3ec43f35,0xbf6dbf80,0xbec4bf35,0xbe48bf35,0x3f553ec4,0xbf7bbf35,0xbf0ebf6d
.long 0xbf352630,0xbf35bf80,0xbf352677,0xbf35bf80,0x3f7b3f35,0xbf0e3ec4,0xbe483f35,0xbf55bf6d,0xbec4bf80,0x3f6d3f35,0x3ec43f80,0xbf6dbf35,0xbf0e3f35,0x3e48bf6d,0x3f553f35,0xbf7bbec4
.long 0x3f80a6b0,0xbf8027b1,0x3f80a6f7,0xbf8027c2,0xbf0ebf35,0x3e483f6d,0x3f55bf35,0xbf7b3ec4,0xbec43f80,0x3f6dbf35,0x3ec4bf80,0xbf6d3f35,0x3f7bbf35,0xbf0ebec4,0xbe48bf35,0xbf553f6d
.long 0xbf3527c2,0xbf353f80,0xbf35a68d,0xbf353f80,0xbe483f35,0x3f55bec4,0xbf7b3f35,0xbf0e3f6d,0x3f6dbf80,0x3ec4bf35,0xbf6d3f80,0xbec43f35,0xbf553f35,0xbf7b3f6d,0xbf0e3f35,0xbe483ec4
.long 0xa68da730,0x27e5a831,0xa1b7a777,0x2804a842,0x3f55bf35,0x3f7bbf6d,0x3f0ebf35,0x3e48bec4,0xbf6d3f80,0xbec43f35,0x3f6dbf80,0x3ec4bf35,0x3e48bf35,0xbf553ec4,0x3f7bbf35,0x3f0ebf6d
.long 0x3f35a60e,0x3f35bf80,0x3f35280d,0x3f35bf80,0xbf7b3f35,0x3f0e3ec4,0x3e483f35,0x3f55bf6d,0x3ec4bf80,0xbf6d3f35,0xbec43f80,0x3f6dbf35,0x3f0e3f35,0xbe48bf6d,0xbf553f35,0x3f7bbec4
.long 0xbf80a842,0x3f80260d,0xbf80270d,0x3f80270d,0x3f0ebf35,0xbe483f6d,0xbf55bf35,0x3f7b3ec4,0x3ec43f80,0xbf6dbf35,0xbec4bf80,0x3f6d3f35,0xbf7bbf35,0x3f0ebec4,0x3e48bf35,0x3f553f6d
.long 0x3f35280d,0x3f353f80,0x3f352896,0x3f353f80,0x3e483f35,0xbf55bec4,0x3f7b3f35,0x3f0e3f6d,0xbf6dbf80,0xbec4bf35,0x3f6d3f80,0x3ec43f35,0x3f553f35,0x3f7b3f6d,0x3f0e3f35,0x3e483ec4
.long 0x80008000,0x80008000,0x80008000,0x80008000,0xbe488000,0xbf0ebec4,0xbf7bbf80,0xbf55bf6d,0xbec48000,0xbf6dbf35,0x3ec4a50d,0x3f6d3f35,0xbf0e8000,0xbf7bbf6d,0x3f553f80,0xbe483ec4
.long 0xbf358000,0xbf35bf80,0xbf35258d,0xbf35bf80,0xbf558000,0xbe48bf6d,0xbf0ebf80,0x3f7b3ec4,0xbf6d8000,0x3ec4bf35,0x3f6da5d4,0xbec43f35,0xbf7b8000,0x3f55bec4,0x3e483f80,0xbf0ebf6d
.long 0xbf808000,0x3f80a50d,0xbf80260d,0x3f80a630,0xbf7b8000,0x3f553ec4,0x3e48bf80,0xbf0e3f6d,0xbf6d8000,0x3ec43f35,0x3f6da630,0xbec4bf35,0xbf558000,0xbe483f6d,0xbf0e3f80,0x3f7bbec4
.long 0xbf358000,0xbf353f80,0xbf352654,0xbf353f80,0xbf0e8000,0xbf7b3f6d,0x3f55bf80,0xbe48bec4,0xbec48000,0xbf6d3f35,0x3ec4a677,0x3f6dbf35,0xbe488000,0xbf0e3ec4,0xbf7b3f80,0xbf553f6d
.long 0xa50d8000,0xa5d4258d,0xa69f268d,0xa7b126b0,0x3e488000,0x3f0ebec4,0x3f7bbf80,0x3f55bf6d,0x3ec48000,0x3f6dbf35,0xbec4a69f,0xbf6d3f35,0x3f0e8000,0x3f7bbf6d,0xbf553f80,0x3e483ec4
.long 0x3f358000,0x3f35bf80,0x3f3526b0,0x3f35bf80,0x3f558000,0x3e48bf6d,0x3f0ebf80,0xbf7b3ec4,0x3f6d8000,0xbec4bf35,0xbf6da7b1,0x3ec43f35,0x3f7b8000,0xbf55bec4,0xbe483f80,0x3f0ebf6d
.long 0x3f808000,0xbf80a5d4,0x3f8026d4,0xbf80a7c2,0x3f7b8000,0xbf553ec4,0xbe48bf80,0x3f0e3f6d,0x3f6d8000,0xbec43f35,0xbf6d270d,0x3ec4bf35,0x3f558000,0x3e483f6d,0x3f0e3f80,0xbf7bbec4
.long 0x3f358000,0x3f353f80,0x3f3526f7,0x3f353f80,0x3f0e8000,0x3f7b3f6d,0xbf55bf80,0x3e48bec4,0x3ec48000,0x3f6d3f35,0xbec4a7c2,0xbf6dbf35,0x3e488000,0x3f0e3ec4,0x3f7b3f80,0x3f553f6d
.long 0x80008000,0x80008000,0x80008000,0x80008000,0xbf55bf35,0xbf7bbf6d,0xbf0ebf35,0xbe48bec4,0xbf6dbf80,0xbec4bf35,0x3f6d3f80,0x3ec43f35,0xbe48bf35,0x3f553ec4,0xbf7bbf35,0xbf0ebf6d
.long 0x3f35a50d,0x3f353f80,0x3f35a5d4,0x3f353f80,0x3f7b3f35,0xbf0e3ec4,0xbe483f35,0xbf55bf6d,0x3ec43f80,0xbf6dbf35,0xbec4bf80,0x3f6d3f35,0xbf0e3f35,0x3e48bf6d,0x3f553f35,0xbf7bbec4
.long 0xbf80258d,0x3f80a5d4,0xbf802654,0x3f80a677,0xbf0ebf35,0x3e483f6d,0x3f55bf35,0xbf7b3ec4,0x3ec4bf80,0xbf6d3f35,0xbec43f80,0x3f6dbf35,0x3f7bbf35,0xbf0ebec4,0xbe48bf35,0xbf553f6d
.long 0x3f35a5d4,0x3f35bf80,0x3f35a69f,0x3f35bf80,0xbe483f35,0x3f55bec4,0xbf7b3f35,0xbf0e3f6d,0xbf6d3f80,0xbec43f35,0x3f6dbf80,0x3ec4bf35,0xbf553f35,0xbf7b3f6d,0xbf0e3f35,0xbe483ec4
.long 0xa630260d,0xa6772654,0x270d26d4,0xa7c226f7,0x3f55bf35,0x3f7bbf6d,0x3f0ebf35,0x3e48bec4,0x3f6dbf80,0x3ec4bf35,0xbf6d3f80,0xbec43f35,0x3e48bf35,0xbf553ec4,0x3f7bbf35,0x3f0ebf6d
.long 0xbf35a630,0xbf353f80,0xbf35a7c2,0xbf353f80,0xbf7b3f35,0x3f0e3ec4,0x3e483f35,0x3f55bf6d,0xbec43f80,0x3f6dbf35,0x3ec4bf80,0xbf6d3f35,0x3f0e3f35,0xbe48bf6d,0xbf553f35,0x3f7bbec4
.long 0x3f802654,0xbf80a69f,0x3f80271f,0xbf80268d,0x3f0ebf35,0xbe483f6d,0xbf55bf35,0x3f7b3ec4,0xbec4bf80,0x3f6d3f35,0x3ec43f80,0xbf6dbf35,0xbf7bbf35,0x3f0ebec4,0x3e48bf35,0x3f553f6d
.long 0xbf35a677,0xbf35bf80,0xbf35268d,0xbf35bf80,0x3e483f35,0xbf55bec4,0x3f7b3f35,0x3f0e3f6d,0x3f6d3f80,0x3ec43f35,0xbf6dbf80,0xbec4bf35,0x3f553f35,0x3f7b3f6d,0x3f0e3f35,0x3e483ec4
.long 0x80008000,0x80008000,0x80008000,0x80008000,0x3e48a50d,0x3f0e3ec4,0x3f7b3f80,0x3f553f6d,0xbec4258d,0xbf6dbf35,0x3ec4a5d4,0x3f6d3f35,0x3f0ea5d4,0x3f7b3f6d,0xbf55bf80,0x3e48bec4
.long 0xbf35260d,0xbf35bf80,0xbf352654,0xbf35bf80,0x3f55a630,0x3e483f6d,0x3f0e3f80,0xbf7bbec4,0xbf6d2654,0x3ec4bf35,0x3f6da69f,0xbec43f35,0x3f7ba677,0xbf553ec4,0xbe48bf80,0x3f0e3f6d
.long 0xbf80268d,0x3f80a69f,0xbf8026d4,0x3f80270d,0x3f7ba69f,0xbf55bec4,0xbe483f80,0x3f0ebf6d,0xbf6d26b0,0x3ec43f35,0x3f6da7c2,0xbec4bf35,0x3f55a7b1,0x3e48bf6d,0x3f0ebf80,0xbf7b3ec4
.long 0xbf3526d4,0xbf353f80,0xbf35271f,0xbf353f80,0x3f0e270d,0x3f7bbf6d,0xbf553f80,0x3e483ec4,0xbec426f7,0xbf6d3f35,0x3ec4268d,0x3f6dbf35,0x3e48a7c2,0x3f0ebec4,0x3f7bbf80,0x3f55bf6d
.long 0x26d4270d,0xa7d4271f,0x260e2754,0xa7f7a78d,0xbe4826d4,0xbf0e3ec4,0xbf7b3f80,0xbf553f6d,0x3ec4271f,0x3f6dbf35,0xbec4a7f7,0xbf6d3f35,0xbf0ea7d4,0xbf7b3f6d,0x3f55bf80,0xbe48bec4
.long 0x3f352730,0x3f35bf80,0x3f352842,0x3f35bf80,0xbf55268d,0xbe483f6d,0xbf0e3f80,0x3f7bbec4,0x3f6d2831,0xbec4bf35,0xbf6da884,0x3ec43f35,0xbf7ba7e5,0x3f553ec4,0x3e48bf80,0xbf0e3f6d
.long 0x3f802754,0xbf80a7f7,0x3f80279f,0xbf80a816,0xbf7b260e,0x3f55bec4,0x3e483f80,0xbf0ebf6d,0x3f6da78d,0xbec43f35,0xbf6d27d4,0x3ec4bf35,0xbf55a7f7,0xbe48bf6d,0xbf0ebf80,0x3f7b3ec4
.long 0x3f352777,0x3f353f80,0x3f35a70d,0x3f353f80,0xbf0e21b7,0xbf7bbf6d,0x3f553f80,0xbe483ec4,0x3ec42842,0x3f6d3f35,0xbec4a909,0xbf6dbf35,0xbe48a804,0xbf0ebec4,0xbf7bbf80,0xbf55bf6d
.long 0x80008000,0x80008000,0x80008000,0x80008000,0x3f553f35,0x3f7b3f6d,0x3f0e3f35,0x3e483ec4,0xbf6dbf80,0xbec4bf35,0x3f6d3f80,0x3ec43f35,0x3e483f35,0xbf55bec4,0x3f7b3f35,0x3f0e3f6d
.long 0x3f35a630,0x3f353f80,0x3f35a677,0x3f353f80,0xbf7bbf35,0x3f0ebec4,0x3e48bf35,0x3f553f6d,0x3ec43f80,0xbf6dbf35,0xbec4bf80,0x3f6d3f35,0x3f0ebf35,0xbe483f6d,0xbf55bf35,0x3f7b3ec4
.long 0xbf8026b0,0x3f80a7b1,0xbf8026f7,0x3f80a7c2,0x3f0e3f35,0xbe48bf6d,0xbf553f35,0x3f7bbec4,0x3ec4bf80,0xbf6d3f35,0xbec43f80,0x3f6dbf35,0xbf7b3f35,0x3f0e3ec4,0x3e483f35,0x3f55bf6d
.long 0x3f35a7c2,0x3f35bf80,0x3f35268d,0x3f35bf80,0x3e48bf35,0xbf553ec4,0x3f7bbf35,0x3f0ebf6d,0xbf6d3f80,0xbec43f35,0x3f6dbf80,0x3ec4bf35,0x3f55bf35,0x3f7bbf6d,0x3f0ebf35,0x3e48bec4
.long 0x268d2730,0xa7e52831,0x21b72777,0xa8042842,0xbf553f35,0xbf7b3f6d,0xbf0e3f35,0xbe483ec4,0x3f6dbf80,0x3ec4bf35,0xbf6d3f80,0xbec43f35,0xbe483f35,0x3f55bec4,0xbf7b3f35,0xbf0e3f6d
.long 0xbf35260e,0xbf353f80,0xbf35a80d,0xbf353f80,0x3f7bbf35,0xbf0ebec4,0xbe48bf35,0xbf553f6d,0xbec43f80,0x3f6dbf35,0x3ec4bf80,0xbf6d3f35,0xbf0ebf35,0x3e483f6d,0x3f55bf35,0xbf7b3ec4
.long 0x3f802842,0xbf80a60d,0x3f80a70d,0xbf80a70d,0xbf0e3f35,0x3e48bf6d,0x3f553f35,0xbf7bbec4,0xbec4bf80,0x3f6d3f35,0x3ec43f80,0xbf6dbf35,0x3f7b3f35,0xbf0e3ec4,0xbe483f35,0xbf55bf6d
.long 0xbf35a80d,0xbf35bf80,0xbf35a896,0xbf35bf80,0xbe48bf35,0x3f553ec4,0xbf7bbf35,0xbf0ebf6d,0x3f6d3f80,0x3ec43f35,0xbf6dbf80,0xbec4bf35,0xbf55bf35,0xbf7bbf6d,0xbf0ebf35,0xbe48bec4
.long 0x3f7f3f80,0x3f753f7b,0x3f223f35,0x3ef13f0e,0x3f753f80,0x3f223f55,0xbf62bf35,0xbf7fbf7b,0x3f623f80,0x3dc93f0e,0xbe95bf35,0x3f223e48,0x3f463f80,0xbef13e48,0x3f7f3f35,0x3e953f55
.long 0x3f223f80,0xbf62be48,0xbdc93f35,0xbf75bf55,0x3ef13f80,0xbf7fbf0e,0xbf75bf35,0x3f46be48,0x3e953f80,0xbf46bf55,0x3ef1bf35,0x3dc93f7b,0x3dc93f80,0xbe95bf7b,0x3f463f35,0xbf62bf0e
.long 0xbdc93f80,0x3e95bf7b,0xbf463f35,0x3f62bf0e,0xbe953f80,0x3f46bf55,0xbef1bf35,0xbdc93f7b,0xbef13f80,0x3f7fbf0e,0x3f75bf35,0xbf46be48,0xbf223f80,0x3f62be48,0x3dc93f35,0x3f75bf55
.long 0xbf463f80,0x3ef13e48,0xbf7f3f35,0xbe953f55,0xbf623f80,0xbdc93f0e,0x3e95bf35,0xbf223e48,0xbf753f80,0xbf223f55,0x3f62bf35,0x3f7fbf7b,0xbf7f3f80,0xbf753f7b,0xbf223f35,0xbef13f0e
.long 0xbf7f3f80,0xbf753f7b,0xbf223f35,0xbef13f0e,0xbf753f80,0xbf223f55,0x3f62bf35,0x3f7fbf7b,0xbf623f80,0xbdc93f0e,0x3e95bf35,0xbf223e48,0xbf463f80,0x3ef13e48,0xbf7f3f35,0xbe953f55
.long 0xbf223f80,0x3f62be48,0x3dc93f35,0x3f75bf55,0xbef13f80,0x3f7fbf0e,0x3f75bf35,0xbf46be48,0xbe953f80,0x3f46bf55,0xbef1bf35,0xbdc93f7b,0xbdc93f80,0x3e95bf7b,0xbf463f35,0x3f62bf0e
.long 0x3dc93f80,0xbe95bf7b,0x3f463f35,0xbf62bf0e,0x3e953f80,0xbf46bf55,0x3ef1bf35,0x3dc93f7b,0x3ef13f80,0xbf7fbf0e,0xbf75bf35,0x3f46be48,0x3f223f80,0xbf62be48,0xbdc93f35,0xbf75bf55
.long 0x3f463f80,0xbef13e48,0x3f7f3f35,0x3e953f55,0x3f623f80,0x3dc93f0e,0xbe95bf35,0x3f223e48,0x3f753f80,0x3f223f55,0xbf62bf35,0xbf7fbf7b,0x3f7f3f80,0x3f753f7b,0x3f223f35,0x3ef13f0e
.long 0x3f623f6d,0x3f463f55,0x3e953ec4,0x3dc93e48,0x3dc93ec4,0xbef1be48,0xbf46bf6d,0xbe95bf0e,0xbf46bec4,0xbf75bf7b,0x3f7f3f6d,0x3ef13f55,0xbf75bf6d,0x3dc9bf0e,0xbf62bec4,0xbf22bf7b
.long 0xbe95bf6d,0x3f7f3f0e,0x3ef1bec4,0x3f463f7b,0x3f22bec4,0x3e953f7b,0x3dc93f6d,0xbf62bf55,0x3f7f3ec4,0xbf623e48,0xbf22bf6d,0x3f753f0e,0x3ef13f6d,0xbf22bf55,0x3f753ec4,0xbf7fbe48
.long 0xbef13f6d,0x3f22bf55,0xbf753ec4,0x3f7fbe48,0xbf7f3ec4,0x3f623e48,0x3f22bf6d,0xbf753f0e,0xbf22bec4,0xbe953f7b,0xbdc93f6d,0x3f62bf55,0x3e95bf6d,0xbf7f3f0e,0xbef1bec4,0xbf463f7b
.long 0x3f75bf6d,0xbdc9bf0e,0x3f62bec4,0x3f22bf7b,0x3f46bec4,0x3f75bf7b,0xbf7f3f6d,0xbef13f55,0xbdc93ec4,0x3ef1be48,0x3f46bf6d,0x3e95bf0e,0xbf623f6d,0xbf463f55,0xbe953ec4,0xbdc93e48
.long 0xbf623f6d,0xbf463f55,0xbe953ec4,0xbdc93e48,0xbdc93ec4,0x3ef1be48,0x3f46bf6d,0x3e95bf0e,0x3f46bec4,0x3f75bf7b,0xbf7f3f6d,0xbef13f55,0x3f75bf6d,0xbdc9bf0e,0x3f62bec4,0x3f22bf7b
.long 0x3e95bf6d,0xbf7f3f0e,0xbef1bec4,0xbf463f7b,0xbf22bec4,0xbe953f7b,0xbdc93f6d,0x3f62bf55,0xbf7f3ec4,0x3f623e48,0x3f22bf6d,0xbf753f0e,0xbef13f6d,0x3f22bf55,0xbf753ec4,0x3f7fbe48
.long 0x3ef13f6d,0xbf22bf55,0x3f753ec4,0xbf7fbe48,0x3f7f3ec4,0xbf623e48,0xbf22bf6d,0x3f753f0e,0x3f22bec4,0x3e953f7b,0x3dc93f6d,0xbf62bf55,0xbe95bf6d,0x3f7f3f0e,0x3ef1bec4,0x3f463f7b
.long 0xbf75bf6d,0x3dc9bf0e,0xbf62bec4,0xbf22bf7b,0xbf46bec4,0xbf75bf7b,0x3f7f3f6d,0x3ef13f55,0x3dc93ec4,0xbef1be48,0xbf46bf6d,0xbe95bf0e,0x3f623f6d,0x3f463f55,0x3e953ec4,0x3dc93e48
.long 0xbdc9248d,0xbe95be48,0xbf46bf35,0xbf62bf55,0x3e95a554,0x3f463f0e,0x3ef13f35,0xbdc93e48,0xbef125b0,0xbf7fbf55,0x3f753f35,0x3f463f7b,0x3f22a5f7,0x3f623f7b,0xbdc9bf35,0x3f753f0e
.long 0xbf46261f,0xbef1bf7b,0xbf7fbf35,0x3e95bf0e,0x3f62a731,0xbdc93f55,0xbe953f35,0xbf22bf7b,0xbf75a68d,0x3f22bf0e,0x3f623f35,0xbf7fbe48,0x3f7fa742,0xbf753e48,0x3f22bf35,0xbef13f55
.long 0xbf7fa654,0x3f753e48,0xbf22bf35,0x3ef13f55,0x3f75a754,0xbf22bf0e,0xbf623f35,0x3f7fbe48,0xbf62a60d,0x3dc93f55,0x3e953f35,0x3f22bf7b,0x3f46a765,0x3ef1bf7b,0x3f7fbf35,0xbe95bf0e
.long 0xbf22a58e,0xbf623f7b,0x3dc9bf35,0xbf753f0e,0x3ef1a777,0x3f7fbf55,0xbf753f35,0xbf463f7b,0xbe95a137,0xbf463f0e,0xbef13f35,0x3dc93e48,0x3dc9a784,0x3e95be48,0x3f46bf35,0x3f62bf55
.long 0x3dc9258d,0x3e95be48,0x3f46bf35,0x3f62bf55,0xbe95a78d,0xbf463f0e,0xbef13f35,0x3dc93e48,0x3ef1260d,0x3f7fbf55,0xbf753f35,0xbf463f7b,0xbf22a796,0xbf623f7b,0x3dc9bf35,0xbf753f0e
.long 0x3f46280d,0x3ef1bf7b,0x3f7fbf35,0xbe95bf0e,0xbf62a79f,0x3dc93f55,0x3e953f35,0x3f22bf7b,0x3f75268d,0xbf22bf0e,0xbf623f35,0x3f7fbe48,0xbf7f2731,0x3f753e48,0xbf22bf35,0x3ef13f55
.long 0x3f7f2816,0xbf753e48,0x3f22bf35,0xbef13f55,0xbf75a7b1,0x3f22bf0e,0x3f623f35,0xbf7fbe48,0x3f6226d4,0xbdc93f55,0xbe953f35,0xbf22bf7b,0xbf46270d,0xbef1bf7b,0xbf7fbf35,0x3e95bf0e
.long 0x3f22281f,0x3f623f7b,0xbdc9bf35,0x3f753f0e,0xbef1a7c2,0xbf7fbf55,0x3f753f35,0x3f463f7b,0x3e95270d,0x3f463f0e,0x3ef13f35,0xbdc93e48,0xbdc926d4,0xbe95be48,0xbf46bf35,0xbf62bf55
.long 0xbef1bec4,0xbf22bf0e,0xbf75bf6d,0xbf7fbf7b,0x3f7f3f6d,0x3f623f7b,0xbf22bec4,0xbf75bf55,0xbf22bf6d,0x3e95be48,0xbdc93ec4,0xbf62bf0e,0xbe953ec4,0xbf7fbf55,0x3ef13f6d,0xbf46be48
.long 0x3f753ec4,0x3dc93f55,0x3f623f6d,0xbf223e48,0xbf46bf6d,0x3f753e48,0x3f7f3ec4,0xbef13f0e,0xbdc93f6d,0xbef1bf7b,0x3f46bec4,0xbe953f55,0x3f62bec4,0xbf463f0e,0x3e95bf6d,0xbdc93f7b
.long 0xbf62bec4,0x3f463f0e,0xbe95bf6d,0x3dc93f7b,0x3dc93f6d,0x3ef1bf7b,0xbf46bec4,0x3e953f55,0x3f46bf6d,0xbf753e48,0xbf7f3ec4,0x3ef13f0e,0xbf753ec4,0xbdc93f55,0xbf623f6d,0x3f223e48
.long 0x3e953ec4,0x3f7fbf55,0xbef13f6d,0x3f46be48,0x3f22bf6d,0xbe95be48,0x3dc93ec4,0x3f62bf0e,0xbf7f3f6d,0xbf623f7b,0x3f22bec4,0x3f75bf55,0x3ef1bec4,0x3f22bf0e,0x3f75bf6d,0x3f7fbf7b
.long 0x3ef1bec4,0x3f22bf0e,0x3f75bf6d,0x3f7fbf7b,0xbf7f3f6d,0xbf623f7b,0x3f22bec4,0x3f75bf55,0x3f22bf6d,0xbe95be48,0x3dc93ec4,0x3f62bf0e,0x3e953ec4,0x3f7fbf55,0xbef13f6d,0x3f46be48
.long 0xbf753ec4,0xbdc93f55,0xbf623f6d,0x3f223e48,0x3f46bf6d,0xbf753e48,0xbf7f3ec4,0x3ef13f0e,0x3dc93f6d,0x3ef1bf7b,0xbf46bec4,0x3e953f55,0xbf62bec4,0x3f463f0e,0xbe95bf6d,0x3dc93f7b
.long 0x3f62bec4,0xbf463f0e,0x3e95bf6d,0xbdc93f7b,0xbdc93f6d,0xbef1bf7b,0x3f46bec4,0xbe953f55,0xbf46bf6d,0x3f753e48,0x3f7f3ec4,0xbef13f0e,0x3f753ec4,0x3dc93f55,0x3f623f6d,0xbf223e48
.long 0xbe953ec4,0xbf7fbf55,0x3ef13f6d,0xbf46be48,0xbf22bf6d,0x3e95be48,0xbdc93ec4,0xbf62bf0e,0x3f7f3f6d,0x3f623f7b,0xbf22bec4,0xbf75bf55,0xbef1bec4,0xbf22bf0e,0xbf75bf6d,0xbf7fbf7b
.long 0x3dc90000,0x3e953e48,0x3f463f35,0x3f623f55,0x3e950000,0x3f463f0e,0x3ef13f35,0xbdc93e48,0x3ef10000,0x3f7f3f55,0xbf75bf35,0xbf46bf7b,0x3f220000,0x3f623f7b,0xbdc9bf35,0x3f753f0e
.long 0x3f460000,0x3ef13f7b,0x3f7f3f35,0xbe953f0e,0x3f620000,0xbdc93f55,0xbe953f35,0xbf22bf7b,0x3f750000,0xbf223f0e,0xbf62bf35,0x3f7f3e48,0x3f7f0000,0xbf753e48,0x3f22bf35,0xbef13f55
.long 0x3f7f0000,0xbf75be48,0x3f223f35,0xbef1bf55,0x3f750000,0xbf22bf0e,0xbf623f35,0x3f7fbe48,0x3f620000,0xbdc9bf55,0xbe95bf35,0xbf223f7b,0x3f460000,0x3ef1bf7b,0x3f7fbf35,0xbe95bf0e
.long 0x3f220000,0x3f62bf7b,0xbdc93f35,0x3f75bf0e,0x3ef10000,0x3f7fbf55,0xbf753f35,0xbf463f7b,0x3e950000,0x3f46bf0e,0x3ef1bf35,0xbdc9be48,0x3dc90000,0x3e95be48,0x3f46bf35,0x3f62bf55
.long 0xbdc90000,0xbe953e48,0xbf463f35,0xbf623f55,0xbe950000,0xbf463f0e,0xbef13f35,0x3dc93e48,0xbef10000,0xbf7f3f55,0x3f75bf35,0x3f46bf7b,0xbf220000,0xbf623f7b,0x3dc9bf35,0xbf753f0e
.long 0xbf460000,0xbef13f7b,0xbf7f3f35,0x3e953f0e,0xbf620000,0x3dc93f55,0x3e953f35,0x3f22bf7b,0xbf750000,0x3f223f0e,0x3f62bf35,0xbf7f3e48,0xbf7f0000,0x3f753e48,0xbf22bf35,0x3ef13f55
.long 0xbf7f0000,0x3f75be48,0xbf223f35,0x3ef1bf55,0xbf750000,0x3f22bf0e,0x3f623f35,0xbf7fbe48,0xbf620000,0x3dc9bf55,0x3e95bf35,0x3f223f7b,0xbf460000,0xbef1bf7b,0xbf7fbf35,0x3e95bf0e
.long 0xbf220000,0xbf62bf7b,0x3dc93f35,0xbf75bf0e,0xbef10000,0xbf7fbf55,0x3f753f35,0x3f463f7b,0xbe950000,0xbf46bf0e,0xbef1bf35,0x3dc9be48,0xbdc90000,0xbe95be48,0xbf46bf35,0xbf62bf55
.long 0x3ef13ec4,0x3f223f0e,0x3f753f6d,0x3f7f3f7b,0x3f7f3f6d,0x3f623f7b,0xbf22bec4,0xbf75bf55,0x3f223f6d,0xbe953e48,0x3dc9bec4,0x3f623f0e,0xbe953ec4,0xbf7fbf55,0x3ef13f6d,0xbf46be48
.long 0xbf75bec4,0xbdc9bf55,0xbf62bf6d,0x3f22be48,0xbf46bf6d,0x3f753e48,0x3f7f3ec4,0xbef13f0e,0x3dc9bf6d,0x3ef13f7b,0xbf463ec4,0x3e95bf55,0x3f62bec4,0xbf463f0e,0x3e95bf6d,0xbdc93f7b
.long 0x3f623ec4,0xbf46bf0e,0x3e953f6d,0xbdc9bf7b,0x3dc93f6d,0x3ef1bf7b,0xbf46bec4,0x3e953f55,0xbf463f6d,0x3f75be48,0x3f7fbec4,0xbef1bf0e,0xbf753ec4,0xbdc93f55,0xbf623f6d,0x3f223e48
.long 0xbe95bec4,0xbf7f3f55,0x3ef1bf6d,0xbf463e48,0x3f22bf6d,0xbe95be48,0x3dc93ec4,0x3f62bf0e,0x3f7fbf6d,0x3f62bf7b,0xbf223ec4,0xbf753f55,0x3ef1bec4,0x3f22bf0e,0x3f75bf6d,0x3f7fbf7b
.long 0xbef13ec4,0xbf223f0e,0xbf753f6d,0xbf7f3f7b,0xbf7f3f6d,0xbf623f7b,0x3f22bec4,0x3f75bf55,0xbf223f6d,0x3e953e48,0xbdc9bec4,0xbf623f0e,0x3e953ec4,0x3f7fbf55,0xbef13f6d,0x3f46be48
.long 0x3f75bec4,0x3dc9bf55,0x3f62bf6d,0xbf22be48,0x3f46bf6d,0xbf753e48,0xbf7f3ec4,0x3ef13f0e,0xbdc9bf6d,0xbef13f7b,0x3f463ec4,0xbe95bf55,0xbf62bec4,0x3f463f0e,0xbe95bf6d,0x3dc93f7b
.long 0xbf623ec4,0x3f46bf0e,0xbe953f6d,0x3dc9bf7b,0xbdc93f6d,0xbef1bf7b,0x3f46bec4,0xbe953f55,0x3f463f6d,0xbf75be48,0xbf7fbec4,0x3ef1bf0e,0x3f753ec4,0x3dc93f55,0x3f623f6d,0xbf223e48
.long 0x3e95bec4,0x3f7f3f55,0xbef1bf6d,0x3f463e48,0xbf22bf6d,0x3e95be48,0xbdc93ec4,0xbf62bf0e,0xbf7fbf6d,0xbf62bf7b,0x3f223ec4,0x3f753f55,0xbef1bec4,0xbf22bf0e,0xbf75bf6d,0xbf7fbf7b
.long 0x3f7f3f80,0x3f753f7b,0x3f223f35,0x3ef13f0e,0xbf75bf80,0xbf22bf55,0x3f623f35,0x3f7f3f7b,0x3f623f80,0x3dc93f0e,0xbe95bf35,0x3f223e48,0xbf46bf80,0x3ef1be48,0xbf7fbf35,0xbe95bf55
.long 0x3f223f80,0xbf62be48,0xbdc93f35,0xbf75bf55,0xbef1bf80,0x3f7f3f0e,0x3f753f35,0xbf463e48,0x3e953f80,0xbf46bf55,0x3ef1bf35,0x3dc93f7b,0xbdc9bf80,0x3e953f7b,0xbf46bf35,0x3f623f0e
.long 0xbdc93f80,0x3e95bf7b,0xbf463f35,0x3f62bf0e,0x3e95bf80,0xbf463f55,0x3ef13f35,0x3dc9bf7b,0xbef13f80,0x3f7fbf0e,0x3f75bf35,0xbf46be48,0x3f22bf80,0xbf623e48,0xbdc9bf35,0xbf753f55
.long 0xbf463f80,0x3ef13e48,0xbf7f3f35,0xbe953f55,0x3f62bf80,0x3dc9bf0e,0xbe953f35,0x3f22be48,0xbf753f80,0xbf223f55,0x3f62bf35,0x3f7fbf7b,0x3f7fbf80,0x3f75bf7b,0x3f22bf35,0x3ef1bf0e
.long 0xbf7f3f80,0xbf753f7b,0xbf223f35,0xbef13f0e,0x3f75bf80,0x3f22bf55,0xbf623f35,0xbf7f3f7b,0xbf623f80,0xbdc93f0e,0x3e95bf35,0xbf223e48,0x3f46bf80,0xbef1be48,0x3f7fbf35,0x3e95bf55
.long 0xbf223f80,0x3f62be48,0x3dc93f35,0x3f75bf55,0x3ef1bf80,0xbf7f3f0e,0xbf753f35,0x3f463e48,0xbe953f80,0x3f46bf55,0xbef1bf35,0xbdc93f7b,0x3dc9bf80,0xbe953f7b,0x3f46bf35,0xbf623f0e
.long 0x3dc93f80,0xbe95bf7b,0x3f463f35,0xbf62bf0e,0xbe95bf80,0x3f463f55,0xbef13f35,0xbdc9bf7b,0x3ef13f80,0xbf7fbf0e,0xbf75bf35,0x3f46be48,0xbf22bf80,0x3f623e48,0x3dc9bf35,0x3f753f55
.long 0x3f463f80,0xbef13e48,0x3f7f3f35,0x3e953f55,0xbf62bf80,0xbdc9bf0e,0x3e953f35,0xbf22be48,0x3f753f80,0x3f223f55,0xbf62bf35,0xbf7fbf7b,0xbf7fbf80,0xbf75bf7b,0xbf22bf35,0xbef1bf0e
.long 0x3f623f6d,0x3f463f55,0x3e953ec4,0x3dc93e48,0xbdc9bec4,0x3ef13e48,0x3f463f6d,0x3e953f0e,0xbf46bec4,0xbf75bf7b,0x3f7f3f6d,0x3ef13f55,0x3f753f6d,0xbdc93f0e,0x3f623ec4,0x3f223f7b
.long 0xbe95bf6d,0x3f7f3f0e,0x3ef1bec4,0x3f463f7b,0xbf223ec4,0xbe95bf7b,0xbdc9bf6d,0x3f623f55,0x3f7f3ec4,0xbf623e48,0xbf22bf6d,0x3f753f0e,0xbef1bf6d,0x3f223f55,0xbf75bec4,0x3f7f3e48
.long 0xbef13f6d,0x3f22bf55,0xbf753ec4,0x3f7fbe48,0x3f7fbec4,0xbf62be48,0xbf223f6d,0x3f75bf0e,0xbf22bec4,0xbe953f7b,0xbdc93f6d,0x3f62bf55,0xbe953f6d,0x3f7fbf0e,0x3ef13ec4,0x3f46bf7b
.long 0x3f75bf6d,0xbdc9bf0e,0x3f62bec4,0x3f22bf7b,0xbf463ec4,0xbf753f7b,0x3f7fbf6d,0x3ef1bf55,0xbdc93ec4,0x3ef1be48,0x3f46bf6d,0x3e95bf0e,0x3f62bf6d,0x3f46bf55,0x3e95bec4,0x3dc9be48
.long 0xbf623f6d,0xbf463f55,0xbe953ec4,0xbdc93e48,0x3dc9bec4,0xbef13e48,0xbf463f6d,0xbe953f0e,0x3f46bec4,0x3f75bf7b,0xbf7f3f6d,0xbef13f55,0xbf753f6d,0x3dc93f0e,0xbf623ec4,0xbf223f7b
.long 0x3e95bf6d,0xbf7f3f0e,0xbef1bec4,0xbf463f7b,0x3f223ec4,0x3e95bf7b,0x3dc9bf6d,0xbf623f55,0xbf7f3ec4,0x3f623e48,0x3f22bf6d,0xbf753f0e,0x3ef1bf6d,0xbf223f55,0x3f75bec4,0xbf7f3e48
.long 0x3ef13f6d,0xbf22bf55,0x3f753ec4,0xbf7fbe48,0xbf7fbec4,0x3f62be48,0x3f223f6d,0xbf75bf0e,0x3f22bec4,0x3e953f7b,0x3dc93f6d,0xbf62bf55,0x3e953f6d,0xbf7fbf0e,0xbef13ec4,0xbf46bf7b
.long 0xbf75bf6d,0x3dc9bf0e,0xbf62bec4,0xbf22bf7b,0x3f463ec4,0x3f753f7b,0xbf7fbf6d,0xbef1bf55,0x3dc93ec4,0xbef1be48,0xbf46bf6d,0xbe95bf0e,0xbf62bf6d,0xbf46bf55,0xbe95bec4,0xbdc9be48
.long 0xbdc98000,0xbe95be48,0xbf46bf35,0xbf62bf55,0xbe958000,0xbf46bf0e,0xbef1bf35,0x3dc9be48,0xbef18000,0xbf7fbf55,0x3f753f35,0x3f463f7b,0xbf228000,0xbf62bf7b,0x3dc93f35,0xbf75bf0e
.long 0xbf468000,0xbef1bf7b,0xbf7fbf35,0x3e95bf0e,0xbf628000,0x3dc9bf55,0x3e95bf35,0x3f223f7b,0xbf758000,0x3f22bf0e,0x3f623f35,0xbf7fbe48,0xbf7f8000,0x3f75be48,0xbf223f35,0x3ef1bf55
.long 0xbf7f8000,0x3f753e48,0xbf22bf35,0x3ef13f55,0xbf758000,0x3f223f0e,0x3f62bf35,0xbf7f3e48,0xbf628000,0x3dc93f55,0x3e953f35,0x3f22bf7b,0xbf468000,0xbef13f7b,0xbf7f3f35,0x3e953f0e
.long 0xbf228000,0xbf623f7b,0x3dc9bf35,0xbf753f0e,0xbef18000,0xbf7f3f55,0x3f75bf35,0x3f46bf7b,0xbe958000,0xbf463f0e,0xbef13f35,0x3dc93e48,0xbdc98000,0xbe953e48,0xbf463f35,0xbf623f55
.long 0x3dc98000,0x3e95be48,0x3f46bf35,0x3f62bf55,0x3e958000,0x3f46bf0e,0x3ef1bf35,0xbdc9be48,0x3ef18000,0x3f7fbf55,0xbf753f35,0xbf463f7b,0x3f228000,0x3f62bf7b,0xbdc93f35,0x3f75bf0e
.long 0x3f468000,0x3ef1bf7b,0x3f7fbf35,0xbe95bf0e,0x3f628000,0xbdc9bf55,0xbe95bf35,0xbf223f7b,0x3f758000,0xbf22bf0e,0xbf623f35,0x3f7fbe48,0x3f7f8000,0xbf75be48,0x3f223f35,0xbef1bf55
.long 0x3f7f8000,0xbf753e48,0x3f22bf35,0xbef13f55,0x3f758000,0xbf223f0e,0xbf62bf35,0x3f7f3e48,0x3f628000,0xbdc93f55,0xbe953f35,0xbf22bf7b,0x3f468000,0x3ef13f7b,0x3f7f3f35,0xbe953f0e
.long 0x3f228000,0x3f623f7b,0xbdc9bf35,0x3f753f0e,0x3ef18000,0x3f7f3f55,0xbf75bf35,0xbf46bf7b,0x3e958000,0x3f463f0e,0x3ef13f35,0xbdc93e48,0x3dc98000,0x3e953e48,0x3f463f35,0x3f623f55
.long 0xbef1bec4,0xbf22bf0e,0xbf75bf6d,0xbf7fbf7b,0xbf7fbf6d,0xbf62bf7b,0x3f223ec4,0x3f753f55,0xbf22bf6d,0x3e95be48,0xbdc93ec4,0xbf62bf0e,0x3e95bec4,0x3f7f3f55,0xbef1bf6d,0x3f463e48
.long 0x3f753ec4,0x3dc93f55,0x3f623f6d,0xbf223e48,0x3f463f6d,0xbf75be48,0xbf7fbec4,0x3ef1bf0e,0xbdc93f6d,0xbef1bf7b,0x3f46bec4,0xbe953f55,0xbf623ec4,0x3f46bf0e,0xbe953f6d,0x3dc9bf7b
.long 0xbf62bec4,0x3f463f0e,0xbe95bf6d,0x3dc93f7b,0xbdc9bf6d,0xbef13f7b,0x3f463ec4,0xbe95bf55,0x3f46bf6d,0xbf753e48,0xbf7f3ec4,0x3ef13f0e,0x3f75bec4,0x3dc9bf55,0x3f62bf6d,0xbf22be48
.long 0x3e953ec4,0x3f7fbf55,0xbef13f6d,0x3f46be48,0xbf223f6d,0x3e953e48,0xbdc9bec4,0xbf623f0e,0xbf7f3f6d,0xbf623f7b,0x3f22bec4,0x3f75bf55,0xbef13ec4,0xbf223f0e,0xbf753f6d,0xbf7f3f7b
.long 0x3ef1bec4,0x3f22bf0e,0x3f75bf6d,0x3f7fbf7b,0x3f7fbf6d,0x3f62bf7b,0xbf223ec4,0xbf753f55,0x3f22bf6d,0xbe95be48,0x3dc93ec4,0x3f62bf0e,0xbe95bec4,0xbf7f3f55,0x3ef1bf6d,0xbf463e48
.long 0xbf753ec4,0xbdc93f55,0xbf623f6d,0x3f223e48,0xbf463f6d,0x3f75be48,0x3f7fbec4,0xbef1bf0e,0x3dc93f6d,0x3ef1bf7b,0xbf46bec4,0x3e953f55,0x3f623ec4,0xbf46bf0e,0x3e953f6d,0xbdc9bf7b
.long 0x3f62bec4,0xbf463f0e,0x3e95bf6d,0xbdc93f7b,0x3dc9bf6d,0x3ef13f7b,0xbf463ec4,0x3e95bf55,0xbf46bf6d,0x3f753e48,0x3f7f3ec4,0xbef13f0e,0xbf75bec4,0xbdc9bf55,0xbf62bf6d,0x3f22be48
.long 0xbe953ec4,0xbf7fbf55,0x3ef13f6d,0xbf46be48,0x3f223f6d,0xbe953e48,0x3dc9bec4,0x3f623f0e,0x3f7f3f6d,0x3f623f7b,0xbf22bec4,0xbf75bf55,0x3ef13ec4,0x3f223f0e,0x3f753f6d,0x3f7f3f7b
.long 0xbf7fbf80,0xbf75bf7b,0xbf22bf35,0xbef1bf0e,0x3f753f80,0x3f223f55,0xbf62bf35,0xbf7fbf7b,0xbf62bf80,0xbdc9bf0e,0x3e953f35,0xbf22be48,0x3f463f80,0xbef13e48,0x3f7f3f35,0x3e953f55
.long 0xbf22bf80,0x3f623e48,0x3dc9bf35,0x3f753f55,0x3ef13f80,0xbf7fbf0e,0xbf75bf35,0x3f46be48,0xbe95bf80,0x3f463f55,0xbef13f35,0xbdc9bf7b,0x3dc93f80,0xbe95bf7b,0x3f463f35,0xbf62bf0e
.long 0x3dc9bf80,0xbe953f7b,0x3f46bf35,0xbf623f0e,0xbe953f80,0x3f46bf55,0xbef1bf35,0xbdc93f7b,0x3ef1bf80,0xbf7f3f0e,0xbf753f35,0x3f463e48,0xbf223f80,0x3f62be48,0x3dc93f35,0x3f75bf55
.long 0x3f46bf80,0xbef1be48,0x3f7fbf35,0x3e95bf55,0xbf623f80,0xbdc93f0e,0x3e95bf35,0xbf223e48,0x3f75bf80,0x3f22bf55,0xbf623f35,0xbf7f3f7b,0xbf7f3f80,0xbf753f7b,0xbf223f35,0xbef13f0e
.long 0x3f7fbf80,0x3f75bf7b,0x3f22bf35,0x3ef1bf0e,0xbf753f80,0xbf223f55,0x3f62bf35,0x3f7fbf7b,0x3f62bf80,0x3dc9bf0e,0xbe953f35,0x3f22be48,0xbf463f80,0x3ef13e48,0xbf7f3f35,0xbe953f55
.long 0x3f22bf80,0xbf623e48,0xbdc9bf35,0xbf753f55,0xbef13f80,0x3f7fbf0e,0x3f75bf35,0xbf46be48,0x3e95bf80,0xbf463f55,0x3ef13f35,0x3dc9bf7b,0xbdc93f80,0x3e95bf7b,0xbf463f35,0x3f62bf0e
.long 0xbdc9bf80,0x3e953f7b,0xbf46bf35,0x3f623f0e,0x3e953f80,0xbf46bf55,0x3ef1bf35,0x3dc93f7b,0xbef1bf80,0x3f7f3f0e,0x3f753f35,0xbf463e48,0x3f223f80,0xbf62be48,0xbdc93f35,0xbf75bf55
.long 0xbf46bf80,0x3ef1be48,0xbf7fbf35,0xbe95bf55,0x3f623f80,0x3dc93f0e,0xbe95bf35,0x3f223e48,0xbf75bf80,0xbf22bf55,0x3f623f35,0x3f7f3f7b,0x3f7f3f80,0x3f753f7b,0x3f223f35,0x3ef13f0e
.long 0xbf62bf6d,0xbf46bf55,0xbe95bec4,0xbdc9be48,0x3dc93ec4,0xbef1be48,0xbf46bf6d,0xbe95bf0e,0x3f463ec4,0x3f753f7b,0xbf7fbf6d,0xbef1bf55,0xbf75bf6d,0x3dc9bf0e,0xbf62bec4,0xbf22bf7b
.long 0x3e953f6d,0xbf7fbf0e,0xbef13ec4,0xbf46bf7b,0x3f22bec4,0x3e953f7b,0x3dc93f6d,0xbf62bf55,0xbf7fbec4,0x3f62be48,0x3f223f6d,0xbf75bf0e,0x3ef13f6d,0xbf22bf55,0x3f753ec4,0xbf7fbe48
.long 0x3ef1bf6d,0xbf223f55,0x3f75bec4,0xbf7f3e48,0xbf7f3ec4,0x3f623e48,0x3f22bf6d,0xbf753f0e,0x3f223ec4,0x3e95bf7b,0x3dc9bf6d,0xbf623f55,0x3e95bf6d,0xbf7f3f0e,0xbef1bec4,0xbf463f7b
.long 0xbf753f6d,0x3dc93f0e,0xbf623ec4,0xbf223f7b,0x3f46bec4,0x3f75bf7b,0xbf7f3f6d,0xbef13f55,0x3dc9bec4,0xbef13e48,0xbf463f6d,0xbe953f0e,0xbf623f6d,0xbf463f55,0xbe953ec4,0xbdc93e48
.long 0x3f62bf6d,0x3f46bf55,0x3e95bec4,0x3dc9be48,0xbdc93ec4,0x3ef1be48,0x3f46bf6d,0x3e95bf0e,0xbf463ec4,0xbf753f7b,0x3f7fbf6d,0x3ef1bf55,0x3f75bf6d,0xbdc9bf0e,0x3f62bec4,0x3f22bf7b
.long 0xbe953f6d,0x3f7fbf0e,0x3ef13ec4,0x3f46bf7b,0xbf22bec4,0xbe953f7b,0xbdc93f6d,0x3f62bf55,0x3f7fbec4,0xbf62be48,0xbf223f6d,0x3f75bf0e,0xbef13f6d,0x3f22bf55,0xbf753ec4,0x3f7fbe48
.long 0xbef1bf6d,0x3f223f55,0xbf75bec4,0x3f7f3e48,0x3f7f3ec4,0xbf623e48,0xbf22bf6d,0x3f753f0e,0xbf223ec4,0xbe95bf7b,0xbdc9bf6d,0x3f623f55,0xbe95bf6d,0x3f7f3f0e,0x3ef1bec4,0x3f463f7b
.long 0x3f753f6d,0xbdc93f0e,0x3f623ec4,0x3f223f7b,0xbf46bec4,0xbf75bf7b,0x3f7f3f6d,0x3ef13f55,0xbdc9bec4,0x3ef13e48,0x3f463f6d,0x3e953f0e,0x3f623f6d,0x3f463f55,0x3e953ec4,0x3dc93e48
.long 0x3f803f80,0x3f803f80,0x3f803f80,0x3f803f80,0x3f753f7f,0x3f463f62,0xbe95bdc9,0xbf22bef1,0x3f553f7b,0x3e483f0e,0xbf55bf7b,0xbe48bf0e,0x3f223f75,0xbef13dc9,0x3f463e95,0x3f623f7f
.long 0x3ec43f6d,0xbf6dbec4,0x3ec43f6d,0xbf6dbec4,0x3dc93f62,0xbf75bf46,0xbf7fbef1,0x3e95bf22,0xbe483f55,0xbf0ebf7b,0x3e48bf55,0x3f0e3f7b,0xbef13f46,0x3dc9bf75,0x3f623f22,0xbf7fbe95
.long 0xbf353f35,0x3f35bf35,0xbf353f35,0x3f35bf35,0xbf623f22,0x3f7fbe95,0xbef1bf46,0x3dc93f75,0xbf7b3f0e,0x3f553e48,0x3f7bbf0e,0xbf55be48,0xbf7f3ef1,0x3e953f22,0xbdc93f62,0x3f75bf46
.long 0xbf6d3ec4,0xbec43f6d,0xbf6d3ec4,0xbec43f6d,0xbf463e95,0xbf623f7f,0x3f22bf75,0xbef1bdc9,0xbf0e3e48,0xbf7b3f55,0x3f0ebe48,0x3f7bbf55,0xbe953dc9,0xbf223ef1,0xbf753f7f,0xbf463f62
.long 0xa554248d,0xa5f725b0,0xa754a654,0xa765a60d,0x3e95bdc9,0x3f22bef1,0x3f75bf7f,0x3f46bf62,0x3f0ebe48,0x3f7bbf55,0xbf0e3e48,0xbf7b3f55,0x3f46be95,0x3f62bf7f,0xbf223f75,0x3ef13dc9
.long 0x3f6dbec4,0x3ec4bf6d,0x3f6dbec4,0x3ec4bf6d,0x3f7fbef1,0xbe95bf22,0x3dc9bf62,0xbf753f46,0x3f7bbf0e,0xbf55be48,0xbf7b3f0e,0x3f553e48,0x3f62bf22,0xbf7f3e95,0x3ef13f46,0xbdc9bf75
.long 0x3f35bf35,0xbf353f35,0x3f35bf35,0xbf353f35,0x3ef1bf46,0xbdc93f75,0xbf62bf22,0x3f7f3e95,0x3e48bf55,0x3f0e3f7b,0xbe483f55,0xbf0ebf7b,0xbdc9bf62,0x3f753f46,0x3f7f3ef1,0xbe953f22
.long 0xbec4bf6d,0x3f6d3ec4,0xbec4bf6d,0x3f6d3ec4,0xbf22bf75,0x3ef1bdc9,0xbf46be95,0xbf62bf7f,0xbf55bf7b,0xbe48bf0e,0x3f553f7b,0x3e483f0e,0xbf75bf7f,0xbf46bf62,0x3e953dc9,0x3f223ef1
.long 0x3f803f80,0x3f803f80,0x3f803f80,0x3f803f80,0x3ef13f22,0x3dc93e95,0xbf62bf46,0xbf7fbf75,0xbf0ebe48,0xbf7bbf55,0x3f0e3e48,0x3f7b3f55,0xbf7fbf62,0xbe95bf46,0xbdc93ef1,0xbf75bf22
.long 0xbec4bf6d,0x3f6d3ec4,0xbec4bf6d,0x3f6d3ec4,0x3f22be95,0x3ef13f7f,0x3f463f75,0xbf62bdc9,0x3f7b3f0e,0xbf553e48,0xbf7bbf0e,0x3f55be48,0x3e953f7f,0xbf22bf62,0x3f75bdc9,0xbf463ef1
.long 0xbf353f35,0x3f35bf35,0xbf353f35,0x3f35bf35,0xbf75bdc9,0x3f463ef1,0x3e95bf7f,0xbf223f62,0xbe48bf55,0xbf0e3f7b,0x3e483f55,0x3f0ebf7b,0x3f46bf75,0xbf623dc9,0xbf22be95,0xbef13f7f
.long 0x3f6dbec4,0x3ec4bf6d,0x3f6dbec4,0x3ec4bf6d,0x3dc93ef1,0x3f75bf22,0xbf7f3f62,0xbe953f46,0xbf553f7b,0xbe483f0e,0x3f55bf7b,0x3e48bf0e,0xbf623f46,0xbf7f3f75,0xbef13f22,0xbdc93e95
.long 0xa731261f,0xa742a68d,0xa777a58e,0xa784a137,0x3f62bf46,0x3f7fbf75,0x3ef1bf22,0x3dc9be95,0x3f55bf7b,0x3e48bf0e,0xbf553f7b,0xbe483f0e,0xbdc9bef1,0xbf753f22,0x3f7fbf62,0x3e95bf46
.long 0xbf6d3ec4,0xbec43f6d,0xbf6d3ec4,0xbec43f6d,0xbf463f75,0x3f62bdc9,0x3f223e95,0x3ef1bf7f,0x3e483f55,0x3f0ebf7b,0xbe48bf55,0xbf0e3f7b,0x3f753dc9,0xbf46bef1,0xbe953f7f,0x3f22bf62
.long 0x3f35bf35,0xbf353f35,0x3f35bf35,0xbf353f35,0xbe95bf7f,0x3f223f62,0xbf753dc9,0x3f46bef1,0xbf7bbf0e,0x3f55be48,0x3f7b3f0e,0xbf553e48,0xbf223e95,0xbef1bf7f,0xbf46bf75,0x3f623dc9
.long 0x3ec43f6d,0xbf6dbec4,0x3ec43f6d,0xbf6dbec4,0x3f7f3f62,0x3e953f46,0x3dc9bef1,0x3f753f22,0x3f0e3e48,0x3f7b3f55,0xbf0ebe48,0xbf7bbf55,0xbef1bf22,0xbdc9be95,0x3f623f46,0x3f7f3f75
.long 0x3f803f80,0x3f803f80,0x3f803f80,0x3f803f80,0xbf75bf7f,0xbf46bf62,0x3e953dc9,0x3f223ef1,0x3f553f7b,0x3e483f0e,0xbf55bf7b,0xbe48bf0e,0xbf22bf75,0x3ef1bdc9,0xbf46be95,0xbf62bf7f
.long 0x3ec43f6d,0xbf6dbec4,0x3ec43f6d,0xbf6dbec4,0xbdc9bf62,0x3f753f46,0x3f7f3ef1,0xbe953f22,0xbe483f55,0xbf0ebf7b,0x3e48bf55,0x3f0e3f7b,0x3ef1bf46,0xbdc93f75,0xbf62bf22,0x3f7f3e95
.long 0xbf353f35,0x3f35bf35,0xbf353f35,0x3f35bf35,0x3f62bf22,0xbf7f3e95,0x3ef13f46,0xbdc9bf75,0xbf7b3f0e,0x3f553e48,0x3f7bbf0e,0xbf55be48,0x3f7fbef1,0xbe95bf22,0x3dc9bf62,0xbf753f46
.long 0xbf6d3ec4,0xbec43f6d,0xbf6d3ec4,0xbec43f6d,0x3f46be95,0x3f62bf7f,0xbf223f75,0x3ef13dc9,0xbf0e3e48,0xbf7b3f55,0x3f0ebe48,0x3f7bbf55,0x3e95bdc9,0x3f22bef1,0x3f75bf7f,0x3f46bf62
.long 0xa78d258d,0xa796260d,0xa7b12816,0x270d26d4,0xbe953dc9,0xbf223ef1,0xbf753f7f,0xbf463f62,0x3f0ebe48,0x3f7bbf55,0xbf0e3e48,0xbf7b3f55,0xbf463e95,0xbf623f7f,0x3f22bf75,0xbef1bdc9
.long 0x3f6dbec4,0x3ec4bf6d,0x3f6dbec4,0x3ec4bf6d,0xbf7f3ef1,0x3e953f22,0xbdc93f62,0x3f75bf46,0x3f7bbf0e,0xbf55be48,0xbf7b3f0e,0x3f553e48,0xbf623f22,0x3f7fbe95,0xbef1bf46,0x3dc93f75
.long 0x3f35bf35,0xbf353f35,0x3f35bf35,0xbf353f35,0xbef13f46,0x3dc9bf75,0x3f623f22,0xbf7fbe95,0x3e48bf55,0x3f0e3f7b,0xbe483f55,0xbf0ebf7b,0x3dc93f62,0xbf75bf46,0xbf7fbef1,0x3e95bf22
.long 0xbec4bf6d,0x3f6d3ec4,0xbec4bf6d,0x3f6d3ec4,0x3f223f75,0xbef13dc9,0x3f463e95,0x3f623f7f,0xbf55bf7b,0xbe48bf0e,0x3f553f7b,0x3e483f0e,0x3f753f7f,0x3f463f62,0xbe95bdc9,0xbf22bef1
.long 0x3f803f80,0x3f803f80,0x3f803f80,0x3f803f80,0xbef1bf22,0xbdc9be95,0x3f623f46,0x3f7f3f75,0xbf0ebe48,0xbf7bbf55,0x3f0e3e48,0x3f7b3f55,0x3f7f3f62,0x3e953f46,0x3dc9bef1,0x3f753f22
.long 0xbec4bf6d,0x3f6d3ec4,0xbec4bf6d,0x3f6d3ec4,0xbf223e95,0xbef1bf7f,0xbf46bf75,0x3f623dc9,0x3f7b3f0e,0xbf553e48,0xbf7bbf0e,0x3f55be48,0xbe95bf7f,0x3f223f62,0xbf753dc9,0x3f46bef1
.long 0xbf353f35,0x3f35bf35,0xbf353f35,0x3f35bf35,0x3f753dc9,0xbf46bef1,0xbe953f7f,0x3f22bf62,0xbe48bf55,0xbf0e3f7b,0x3e483f55,0x3f0ebf7b,0xbf463f75,0x3f62bdc9,0x3f223e95,0x3ef1bf7f
.long 0x3f6dbec4,0x3ec4bf6d,0x3f6dbec4,0x3ec4bf6d,0xbdc9bef1,0xbf753f22,0x3f7fbf62,0x3e95bf46,0xbf553f7b,0xbe483f0e,0x3f55bf7b,0x3e48bf0e,0x3f62bf46,0x3f7fbf75,0x3ef1bf22,0x3dc9be95
.long 0xa79f280d,0x2731268d,0xa7c2281f,0x26d4270d,0xbf623f46,0xbf7f3f75,0xbef13f22,0xbdc93e95,0x3f55bf7b,0x3e48bf0e,0xbf553f7b,0xbe483f0e,0x3dc93ef1,0x3f75bf22,0xbf7f3f62,0xbe953f46
.long 0xbf6d3ec4,0xbec43f6d,0xbf6d3ec4,0xbec43f6d,0x3f46bf75,0xbf623dc9,0xbf22be95,0xbef13f7f,0x3e483f55,0x3f0ebf7b,0xbe48bf55,0xbf0e3f7b,0xbf75bdc9,0x3f463ef1,0x3e95bf7f,0xbf223f62
.long 0x3f35bf35,0xbf353f35,0x3f35bf35,0xbf353f35,0x3e953f7f,0xbf22bf62,0x3f75bdc9,0xbf463ef1,0xbf7bbf0e,0x3f55be48,0x3f7b3f0e,0xbf553e48,0x3f22be95,0x3ef13f7f,0x3f463f75,0xbf62bdc9
.long 0x3ec43f6d,0xbf6dbec4,0x3ec43f6d,0xbf6dbec4,0xbf7fbf62,0xbe95bf46,0xbdc93ef1,0xbf75bf22,0x3f0e3e48,0x3f7b3f55,0xbf0ebe48,0xbf7bbf55,0x3ef13f22,0x3dc93e95,0xbf62bf46,0xbf7fbf75
.long 0x0,0x0,0x0,0x0,0x3e953dc9,0x3f223ef1,0x3f753f7f,0x3f463f62,0x3f0e3e48,0x3f7b3f55,0xbf0ebe48,0xbf7bbf55,0x3f463e95,0x3f623f7f,0xbf22bf75,0x3ef1bdc9
.long 0x3f6d3ec4,0x3ec43f6d,0x3f6d3ec4,0x3ec43f6d,0x3f7f3ef1,0xbe953f22,0x3dc93f62,0xbf75bf46,0x3f7b3f0e,0xbf553e48,0xbf7bbf0e,0x3f55be48,0x3f623f22,0xbf7fbe95,0x3ef1bf46,0xbdc93f75
.long 0x3f353f35,0xbf35bf35,0x3f353f35,0xbf35bf35,0x3ef13f46,0xbdc9bf75,0xbf623f22,0x3f7fbe95,0x3e483f55,0x3f0ebf7b,0xbe48bf55,0xbf0e3f7b,0xbdc93f62,0x3f75bf46,0x3f7fbef1,0xbe95bf22
.long 0xbec43f6d,0x3f6dbec4,0xbec43f6d,0x3f6dbec4,0xbf223f75,0x3ef13dc9,0xbf463e95,0xbf623f7f,0xbf553f7b,0xbe483f0e,0x3f55bf7b,0x3e48bf0e,0xbf753f7f,0xbf463f62,0x3e95bdc9,0x3f22bef1
.long 0xbf803f80,0xbf803f80,0xbf803f80,0xbf803f80,0xbf753f7f,0xbf463f62,0x3e95bdc9,0x3f22bef1,0xbf553f7b,0xbe483f0e,0x3f55bf7b,0x3e48bf0e,0xbf223f75,0x3ef13dc9,0xbf463e95,0xbf623f7f
.long 0xbec43f6d,0x3f6dbec4,0xbec43f6d,0x3f6dbec4,0xbdc93f62,0x3f75bf46,0x3f7fbef1,0xbe95bf22,0x3e483f55,0x3f0ebf7b,0xbe48bf55,0xbf0e3f7b,0x3ef13f46,0xbdc9bf75,0xbf623f22,0x3f7fbe95
.long 0x3f353f35,0xbf35bf35,0x3f353f35,0xbf35bf35,0x3f623f22,0xbf7fbe95,0x3ef1bf46,0xbdc93f75,0x3f7b3f0e,0xbf553e48,0xbf7bbf0e,0x3f55be48,0x3f7f3ef1,0xbe953f22,0x3dc93f62,0xbf75bf46
.long 0x3f6d3ec4,0x3ec43f6d,0x3f6d3ec4,0x3ec43f6d,0x3f463e95,0x3f623f7f,0xbf22bf75,0x3ef1bdc9,0x3f0e3e48,0x3f7b3f55,0xbf0ebe48,0xbf7bbf55,0x3e953dc9,0x3f223ef1,0x3f753f7f,0x3f463f62
.long 0x0,0x0,0x0,0x0,0x3f623f46,0x3f7f3f75,0x3ef13f22,0x3dc93e95,0x3f553f7b,0x3e483f0e,0xbf55bf7b,0xbe48bf0e,0xbdc93ef1,0xbf75bf22,0x3f7f3f62,0x3e953f46
.long 0xbf6dbec4,0xbec4bf6d,0xbf6dbec4,0xbec4bf6d,0xbf46bf75,0x3f623dc9,0x3f22be95,0x3ef13f7f,0x3e48bf55,0x3f0e3f7b,0xbe483f55,0xbf0ebf7b,0x3f75bdc9,0xbf463ef1,0xbe95bf7f,0x3f223f62
.long 0x3f353f35,0xbf35bf35,0x3f353f35,0xbf35bf35,0xbe953f7f,0x3f22bf62,0xbf75bdc9,0x3f463ef1,0xbf7b3f0e,0x3f553e48,0x3f7bbf0e,0xbf55be48,0xbf22be95,0xbef13f7f,0xbf463f75,0x3f62bdc9
.long 0x3ec4bf6d,0xbf6d3ec4,0x3ec4bf6d,0xbf6d3ec4,0x3f7fbf62,0x3e95bf46,0x3dc93ef1,0x3f75bf22,0x3f0ebe48,0x3f7bbf55,0xbf0e3e48,0xbf7b3f55,0xbef13f22,0xbdc93e95,0x3f62bf46,0x3f7fbf75
.long 0xbf803f80,0xbf803f80,0xbf803f80,0xbf803f80,0xbef13f22,0xbdc93e95,0x3f62bf46,0x3f7fbf75,0x3f0ebe48,0x3f7bbf55,0xbf0e3e48,0xbf7b3f55,0x3f7fbf62,0x3e95bf46,0x3dc93ef1,0x3f75bf22
.long 0x3ec4bf6d,0xbf6d3ec4,0x3ec4bf6d,0xbf6d3ec4,0xbf22be95,0xbef13f7f,0xbf463f75,0x3f62bdc9,0xbf7b3f0e,0x3f553e48,0x3f7bbf0e,0xbf55be48,0xbe953f7f,0x3f22bf62,0xbf75bdc9,0x3f463ef1
.long 0x3f353f35,0xbf35bf35,0x3f353f35,0xbf35bf35,0x3f75bdc9,0xbf463ef1,0xbe95bf7f,0x3f223f62,0x3e48bf55,0x3f0e3f7b,0xbe483f55,0xbf0ebf7b,0xbf46bf75,0x3f623dc9,0x3f22be95,0x3ef13f7f
.long 0xbf6dbec4,0xbec4bf6d,0xbf6dbec4,0xbec4bf6d,0xbdc93ef1,0xbf75bf22,0x3f7f3f62,0x3e953f46,0x3f553f7b,0x3e483f0e,0xbf55bf7b,0xbe48bf0e,0x3f623f46,0x3f7f3f75,0x3ef13f22,0x3dc93e95
.long 0x0,0x0,0x0,0x0,0xbe95bdc9,0xbf22bef1,0xbf75bf7f,0xbf46bf62,0x3f0e3e48,0x3f7b3f55,0xbf0ebe48,0xbf7bbf55,0xbf46be95,0xbf62bf7f,0x3f223f75,0xbef13dc9
.long 0x3f6d3ec4,0x3ec43f6d,0x3f6d3ec4,0x3ec43f6d,0xbf7fbef1,0x3e95bf22,0xbdc9bf62,0x3f753f46,0x3f7b3f0e,0xbf553e48,0xbf7bbf0e,0x3f55be48,0xbf62bf22,0x3f7f3e95,0xbef13f46,0x3dc9bf75
.long 0x3f353f35,0xbf35bf35,0x3f353f35,0xbf35bf35,0xbef1bf46,0x3dc93f75,0x3f62bf22,0xbf7f3e95,0x3e483f55,0x3f0ebf7b,0xbe48bf55,0xbf0e3f7b,0x3dc9bf62,0xbf753f46,0xbf7f3ef1,0x3e953f22
.long 0xbec43f6d,0x3f6dbec4,0xbec43f6d,0x3f6dbec4,0x3f22bf75,0xbef1bdc9,0x3f46be95,0x3f62bf7f,0xbf553f7b,0xbe483f0e,0x3f55bf7b,0x3e48bf0e,0x3f75bf7f,0x3f46bf62,0xbe953dc9,0xbf223ef1
.long 0xbf803f80,0xbf803f80,0xbf803f80,0xbf803f80,0x3f75bf7f,0x3f46bf62,0xbe953dc9,0xbf223ef1,0xbf553f7b,0xbe483f0e,0x3f55bf7b,0x3e48bf0e,0x3f22bf75,0xbef1bdc9,0x3f46be95,0x3f62bf7f
.long 0xbec43f6d,0x3f6dbec4,0xbec43f6d,0x3f6dbec4,0x3dc9bf62,0xbf753f46,0xbf7f3ef1,0x3e953f22,0x3e483f55,0x3f0ebf7b,0xbe48bf55,0xbf0e3f7b,0xbef1bf46,0x3dc93f75,0x3f62bf22,0xbf7f3e95
.long 0x3f353f35,0xbf35bf35,0x3f353f35,0xbf35bf35,0xbf62bf22,0x3f7f3e95,0xbef13f46,0x3dc9bf75,0x3f7b3f0e,0xbf553e48,0xbf7bbf0e,0x3f55be48,0xbf7fbef1,0x3e95bf22,0xbdc9bf62,0x3f753f46
.long 0x3f6d3ec4,0x3ec43f6d,0x3f6d3ec4,0x3ec43f6d,0xbf46be95,0xbf62bf7f,0x3f223f75,0xbef13dc9,0x3f0e3e48,0x3f7b3f55,0xbf0ebe48,0xbf7bbf55,0xbe95bdc9,0xbf22bef1,0xbf75bf7f,0xbf46bf62
.long 0x0,0x0,0x0,0x0,0xbf62bf46,0xbf7fbf75,0xbef1bf22,0xbdc9be95,0x3f553f7b,0x3e483f0e,0xbf55bf7b,0xbe48bf0e,0x3dc9bef1,0x3f753f22,0xbf7fbf62,0xbe95bf46
.long 0xbf6dbec4,0xbec4bf6d,0xbf6dbec4,0xbec4bf6d,0x3f463f75,0xbf62bdc9,0xbf223e95,0xbef1bf7f,0x3e48bf55,0x3f0e3f7b,0xbe483f55,0xbf0ebf7b,0xbf753dc9,0x3f46bef1,0x3e953f7f,0xbf22bf62
.long 0x3f353f35,0xbf35bf35,0x3f353f35,0xbf35bf35,0x3e95bf7f,0xbf223f62,0x3f753dc9,0xbf46bef1,0xbf7b3f0e,0x3f553e48,0x3f7bbf0e,0xbf55be48,0x3f223e95,0x3ef1bf7f,0x3f46bf75,0xbf623dc9
.long 0x3ec4bf6d,0xbf6d3ec4,0x3ec4bf6d,0xbf6d3ec4,0xbf7f3f62,0xbe953f46,0xbdc9bef1,0xbf753f22,0x3f0ebe48,0x3f7bbf55,0xbf0e3e48,0xbf7b3f55,0x3ef1bf22,0x3dc9be95,0xbf623f46,0xbf7f3f75
.long 0xbf803f80,0xbf803f80,0xbf803f80,0xbf803f80,0x3ef1bf22,0x3dc9be95,0xbf623f46,0xbf7f3f75,0x3f0ebe48,0x3f7bbf55,0xbf0e3e48,0xbf7b3f55,0xbf7f3f62,0xbe953f46,0xbdc9bef1,0xbf753f22
.long 0x3ec4bf6d,0xbf6d3ec4,0x3ec4bf6d,0xbf6d3ec4,0x3f223e95,0x3ef1bf7f,0x3f46bf75,0xbf623dc9,0xbf7b3f0e,0x3f553e48,0x3f7bbf0e,0xbf55be48,0x3e95bf7f,0xbf223f62,0x3f753dc9,0xbf46bef1
.long 0x3f353f35,0xbf35bf35,0x3f353f35,0xbf35bf35,0xbf753dc9,0x3f46bef1,0x3e953f7f,0xbf22bf62,0x3e48bf55,0x3f0e3f7b,0xbe483f55,0xbf0ebf7b,0x3f463f75,0xbf62bdc9,0xbf223e95,0xbef1bf7f
.long 0xbf6dbec4,0xbec4bf6d,0xbf6dbec4,0xbec4bf6d,0x3dc9bef1,0x3f753f22,0xbf7fbf62,0xbe95bf46,0x3f553f7b,0x3e483f0e,0xbf55bf7b,0xbe48bf0e,0xbf62bf46,0xbf7fbf75,0xbef1bf22,0xbdc9be95
.long 0x80008000,0x80008000,0x80008000,0x80008000,0xbe95bdc9,0xbf22bef1,0xbf75bf7f,0xbf46bf62,0xbf0ebe48,0xbf7bbf55,0x3f0e3e48,0x3f7b3f55,0xbf46be95,0xbf62bf7f,0x3f223f75,0xbef13dc9
.long 0xbf6dbec4,0xbec4bf6d,0xbf6dbec4,0xbec4bf6d,0xbf7fbef1,0x3e95bf22,0xbdc9bf62,0x3f753f46,0xbf7bbf0e,0x3f55be48,0x3f7b3f0e,0xbf553e48,0xbf62bf22,0x3f7f3e95,0xbef13f46,0x3dc9bf75
.long 0xbf35bf35,0x3f353f35,0xbf35bf35,0x3f353f35,0xbef1bf46,0x3dc93f75,0x3f62bf22,0xbf7f3e95,0xbe48bf55,0xbf0e3f7b,0x3e483f55,0x3f0ebf7b,0x3dc9bf62,0xbf753f46,0xbf7f3ef1,0x3e953f22
.long 0x3ec4bf6d,0xbf6d3ec4,0x3ec4bf6d,0xbf6d3ec4,0x3f22bf75,0xbef1bdc9,0x3f46be95,0x3f62bf7f,0x3f55bf7b,0x3e48bf0e,0xbf553f7b,0xbe483f0e,0x3f75bf7f,0x3f46bf62,0xbe953dc9,0xbf223ef1
.long 0x3f80bf80,0x3f80bf80,0x3f80bf80,0x3f80bf80,0x3f75bf7f,0x3f46bf62,0xbe953dc9,0xbf223ef1,0x3f55bf7b,0x3e48bf0e,0xbf553f7b,0xbe483f0e,0x3f22bf75,0xbef1bdc9,0x3f46be95,0x3f62bf7f
.long 0x3ec4bf6d,0xbf6d3ec4,0x3ec4bf6d,0xbf6d3ec4,0x3dc9bf62,0xbf753f46,0xbf7f3ef1,0x3e953f22,0xbe48bf55,0xbf0e3f7b,0x3e483f55,0x3f0ebf7b,0xbef1bf46,0x3dc93f75,0x3f62bf22,0xbf7f3e95
.long 0xbf35bf35,0x3f353f35,0xbf35bf35,0x3f353f35,0xbf62bf22,0x3f7f3e95,0xbef13f46,0x3dc9bf75,0xbf7bbf0e,0x3f55be48,0x3f7b3f0e,0xbf553e48,0xbf7fbef1,0x3e95bf22,0xbdc9bf62,0x3f753f46
.long 0xbf6dbec4,0xbec4bf6d,0xbf6dbec4,0xbec4bf6d,0xbf46be95,0xbf62bf7f,0x3f223f75,0xbef13dc9,0xbf0ebe48,0xbf7bbf55,0x3f0e3e48,0x3f7b3f55,0xbe95bdc9,0xbf22bef1,0xbf75bf7f,0xbf46bf62
.long 0x80008000,0x80008000,0x80008000,0x80008000,0xbf62bf46,0xbf7fbf75,0xbef1bf22,0xbdc9be95,0xbf55bf7b,0xbe48bf0e,0x3f553f7b,0x3e483f0e,0x3dc9bef1,0x3f753f22,0xbf7fbf62,0xbe95bf46
.long 0x3f6d3ec4,0x3ec43f6d,0x3f6d3ec4,0x3ec43f6d,0x3f463f75,0xbf62bdc9,0xbf223e95,0xbef1bf7f,0xbe483f55,0xbf0ebf7b,0x3e48bf55,0x3f0e3f7b,0xbf753dc9,0x3f46bef1,0x3e953f7f,0xbf22bf62
.long 0xbf35bf35,0x3f353f35,0xbf35bf35,0x3f353f35,0x3e95bf7f,0xbf223f62,0x3f753dc9,0xbf46bef1,0x3f7bbf0e,0xbf55be48,0xbf7b3f0e,0x3f553e48,0x3f223e95,0x3ef1bf7f,0x3f46bf75,0xbf623dc9
.long 0xbec43f6d,0x3f6dbec4,0xbec43f6d,0x3f6dbec4,0xbf7f3f62,0xbe953f46,0xbdc9bef1,0xbf753f22,0xbf0e3e48,0xbf7b3f55,0x3f0ebe48,0x3f7bbf55,0x3ef1bf22,0x3dc9be95,0xbf623f46,0xbf7f3f75
.long 0x3f80bf80,0x3f80bf80,0x3f80bf80,0x3f80bf80,0x3ef1bf22,0x3dc9be95,0xbf623f46,0xbf7f3f75,0xbf0e3e48,0xbf7b3f55,0x3f0ebe48,0x3f7bbf55,0xbf7f3f62,0xbe953f46,0xbdc9bef1,0xbf753f22
.long 0xbec43f6d,0x3f6dbec4,0xbec43f6d,0x3f6dbec4,0x3f223e95,0x3ef1bf7f,0x3f46bf75,0xbf623dc9,0x3f7bbf0e,0xbf55be48,0xbf7b3f0e,0x3f553e48,0x3e95bf7f,0xbf223f62,0x3f753dc9,0xbf46bef1
.long 0xbf35bf35,0x3f353f35,0xbf35bf35,0x3f353f35,0xbf753dc9,0x3f46bef1,0x3e953f7f,0xbf22bf62,0xbe483f55,0xbf0ebf7b,0x3e48bf55,0x3f0e3f7b,0x3f463f75,0xbf62bdc9,0xbf223e95,0xbef1bf7f
.long 0x3f6d3ec4,0x3ec43f6d,0x3f6d3ec4,0x3ec43f6d,0x3dc9bef1,0x3f753f22,0xbf7fbf62,0xbe95bf46,0xbf55bf7b,0xbe48bf0e,0x3f553f7b,0x3e483f0e,0xbf62bf46,0xbf7fbf75,0xbef1bf22,0xbdc9be95
.long 0x80008000,0x80008000,0x80008000,0x80008000,0x3e953dc9,0x3f223ef1,0x3f753f7f,0x3f463f62,0xbf0ebe48,0xbf7bbf55,0x3f0e3e48,0x3f7b3f55,0x3f463e95,0x3f623f7f,0xbf22bf75,0x3ef1bdc9
.long 0xbf6dbec4,0xbec4bf6d,0xbf6dbec4,0xbec4bf6d,0x3f7f3ef1,0xbe953f22,0x3dc93f62,0xbf75bf46,0xbf7bbf0e,0x3f55be48,0x3f7b3f0e,0xbf553e48,0x3f623f22,0xbf7fbe95,0x3ef1bf46,0xbdc93f75
.long 0xbf35bf35,0x3f353f35,0xbf35bf35,0x3f353f35,0x3ef13f46,0xbdc9bf75,0xbf623f22,0x3f7fbe95,0xbe48bf55,0xbf0e3f7b,0x3e483f55,0x3f0ebf7b,0xbdc93f62,0x3f75bf46,0x3f7fbef1,0xbe95bf22
.long 0x3ec4bf6d,0xbf6d3ec4,0x3ec4bf6d,0xbf6d3ec4,0xbf223f75,0x3ef13dc9,0xbf463e95,0xbf623f7f,0x3f55bf7b,0x3e48bf0e,0xbf553f7b,0xbe483f0e,0xbf753f7f,0xbf463f62,0x3e95bdc9,0x3f22bef1
.long 0x3f80bf80,0x3f80bf80,0x3f80bf80,0x3f80bf80,0xbf753f7f,0xbf463f62,0x3e95bdc9,0x3f22bef1,0x3f55bf7b,0x3e48bf0e,0xbf553f7b,0xbe483f0e,0xbf223f75,0x3ef13dc9,0xbf463e95,0xbf623f7f
.long 0x3ec4bf6d,0xbf6d3ec4,0x3ec4bf6d,0xbf6d3ec4,0xbdc93f62,0x3f75bf46,0x3f7fbef1,0xbe95bf22,0xbe48bf55,0xbf0e3f7b,0x3e483f55,0x3f0ebf7b,0x3ef13f46,0xbdc9bf75,0xbf623f22,0x3f7fbe95
.long 0xbf35bf35,0x3f353f35,0xbf35bf35,0x3f353f35,0x3f623f22,0xbf7fbe95,0x3ef1bf46,0xbdc93f75,0xbf7bbf0e,0x3f55be48,0x3f7b3f0e,0xbf553e48,0x3f7f3ef1,0xbe953f22,0x3dc93f62,0xbf75bf46
.long 0xbf6dbec4,0xbec4bf6d,0xbf6dbec4,0xbec4bf6d,0x3f463e95,0x3f623f7f,0xbf22bf75,0x3ef1bdc9,0xbf0ebe48,0xbf7bbf55,0x3f0e3e48,0x3f7b3f55,0x3e953dc9,0x3f223ef1,0x3f753f7f,0x3f463f62
.long 0x80008000,0x80008000,0x80008000,0x80008000,0x3f623f46,0x3f7f3f75,0x3ef13f22,0x3dc93e95,0xbf55bf7b,0xbe48bf0e,0x3f553f7b,0x3e483f0e,0xbdc93ef1,0xbf75bf22,0x3f7f3f62,0x3e953f46
.long 0x3f6d3ec4,0x3ec43f6d,0x3f6d3ec4,0x3ec43f6d,0xbf46bf75,0x3f623dc9,0x3f22be95,0x3ef13f7f,0xbe483f55,0xbf0ebf7b,0x3e48bf55,0x3f0e3f7b,0x3f75bdc9,0xbf463ef1,0xbe95bf7f,0x3f223f62
.long 0xbf35bf35,0x3f353f35,0xbf35bf35,0x3f353f35,0xbe953f7f,0x3f22bf62,0xbf75bdc9,0x3f463ef1,0x3f7bbf0e,0xbf55be48,0xbf7b3f0e,0x3f553e48,0xbf22be95,0xbef13f7f,0xbf463f75,0x3f62bdc9
.long 0xbec43f6d,0x3f6dbec4,0xbec43f6d,0x3f6dbec4,0x3f7fbf62,0x3e95bf46,0x3dc93ef1,0x3f75bf22,0xbf0e3e48,0xbf7b3f55,0x3f0ebe48,0x3f7bbf55,0xbef13f22,0xbdc93e95,0x3f62bf46,0x3f7fbf75
.long 0x3f80bf80,0x3f80bf80,0x3f80bf80,0x3f80bf80,0xbef13f22,0xbdc93e95,0x3f62bf46,0x3f7fbf75,0xbf0e3e48,0xbf7b3f55,0x3f0ebe48,0x3f7bbf55,0x3f7fbf62,0x3e95bf46,0x3dc93ef1,0x3f75bf22
.long 0xbec43f6d,0x3f6dbec4,0xbec43f6d,0x3f6dbec4,0xbf22be95,0xbef13f7f,0xbf463f75,0x3f62bdc9,0x3f7bbf0e,0xbf55be48,0xbf7b3f0e,0x3f553e48,0xbe953f7f,0x3f22bf62,0xbf75bdc9,0x3f463ef1
.long 0xbf35bf35,0x3f353f35,0xbf35bf35,0x3f353f35,0x3f75bdc9,0xbf463ef1,0xbe95bf7f,0x3f223f62,0xbe483f55,0xbf0ebf7b,0x3e48bf55,0x3f0e3f7b,0xbf46bf75,0x3f623dc9,0x3f22be95,0x3ef13f7f
.long 0x3f6d3ec4,0x3ec43f6d,0x3f6d3ec4,0x3ec43f6d,0xbdc93ef1,0xbf75bf22,0x3f7f3f62,0x3e953f46,0xbf55bf7b,0xbe48bf0e,0x3f553f7b,0x3e483f0e,0x3f623f46,0x3f7f3f75,0x3ef13f22,0x3dc93e95
.long 0x3f800000,0x3f800000,0x3f800000,0x3f800000,0x3f800000,0x3f7fffb1,0x3f7ffec4,0x3f7ffd39,0x3f800000,0x3f7ffec4,0x3f7ffb11,0x3f7ff4e6,0x3f800000,0x3f7ffd39,0x3f7ff4e6,0x3f7fe705
.long 0x3f800000,0x3f7ffb11,0x3f7fec43,0x3f7fd397,0x3f800000,0x3f7ff84a,0x3f7fe129,0x3f7fba9e,0x3f800000,0x3f7ff4e6,0x3f7fd397,0x3f7f9c18,0x3f800000,0x3f7ff0e3,0x3f7fc38f,0x3f7f7808
.long 0x3f800000,0x3f7fec43,0x3f7fb10f,0x3f7f4e6d,0x3f800000,0x3f7fe705,0x3f7f9c18,0x3f7f1f49,0x3f800000,0x3f7fe129,0x3f7f84ab,0x3f7eea9d,0x3f800000,0x3f7fdaaf,0x3f7f6ac7,0x3f7eb069
.long 0x3f800000,0x3f7fd397,0x3f7f4e6d,0x3f7e70b0,0x3f800000,0x3f7fcbe2,0x3f7f2f9d,0x3f7e2b72,0x3f800000,0x3f7fc38f,0x3f7f0e58,0x3f7de0b1,0x3f800000,0x3f7fba9e,0x3f7eea9d,0x3f7d906e
.long 0x3f800000,0x3f7fb10f,0x3f7ec46d,0x3f7d3aac,0x3f800000,0x3f7fa6e3,0x3f7e9bc9,0x3f7cdf6c,0x3f800000,0x3f7f9c18,0x3f7e70b0,0x3f7c7eb0,0x3f800000,0x3f7f90b1,0x3f7e4323,0x3f7c187a
.long 0x3f800000,0x3f7f84ab,0x3f7e1324,0x3f7baccd,0x3f800000,0x3f7f7808,0x3f7de0b1,0x3f7b3bab,0x3f800000,0x3f7f6ac7,0x3f7dabcc,0x3f7ac516,0x3f800000,0x3f7f5ce9,0x3f7d7474,0x3f7a4910
.long 0x3f800000,0x3f7f4e6d,0x3f7d3aac,0x3f79c79d,0x3f800000,0x3f7f3f54,0x3f7cfe73,0x3f7940c0,0x3f800000,0x3f7f2f9d,0x3f7cbfc9,0x3f78b47b,0x3f800000,0x3f7f1f49,0x3f7c7eb0,0x3f7822d1
.long 0x3f800000,0x3f7f0e58,0x3f7c3b28,0x3f778bc5,0x3f800000,0x3f7efcc9,0x3f7bf531,0x3f76ef5b,0x3f800000,0x3f7eea9d,0x3f7baccd,0x3f764d97,0x3f800000,0x3f7ed7d4,0x3f7b61fc,0x3f75a67b
.long 0x3f800000,0x3f800000,0x3f800000,0x3f800000,0x3f7ffb11,0x3f7ff84a,0x3f7ff4e6,0x3f7ff0e3,0x3f7fec43,0x3f7fe129,0x3f7fd397,0x3f7fc38f,0x3f7fd397,0x3f7fba9e,0x3f7f9c18,0x3f7f7808
.long 0x3f7fb10f,0x3f7f84ab,0x3f7f4e6d,0x3f7f0e58,0x3f7f84ab,0x3f7f3f54,0x3f7eea9d,0x3f7e868b,0x3f7f4e6d,0x3f7eea9d,0x3f7e70b0,0x3f7de0b1,0x3f7f0e58,0x3f7e868b,0x3f7de0b1,0x3f7d1cdd
.long 0x3f7ec46d,0x3f7e1324,0x3f7d3aac,0x3f7c3b28,0x3f7e70b0,0x3f7d906e,0x3f7c7eb0,0x3f7b3bab,0x3f7e1324,0x3f7cfe73,0x3f7baccd,0x3f7a1e84,0x3f7dabcc,0x3f7c5d3a,0x3f7ac516,0x3f78e3d6
.long 0x3f7d3aac,0x3f7baccd,0x3f79c79d,0x3f778bc5,0x3f7cbfc9,0x3f7aed37,0x3f78b47b,0x3f76167a,0x3f7c3b28,0x3f7a1e84,0x3f778bc5,0x3f748422,0x3f7baccd,0x3f7940c0,0x3f764d97,0x3f72d4eb
.long 0x3f7b14be,0x3f7853f8,0x3f74fa0b,0x3f710908,0x3f7a7302,0x3f77583a,0x3f73913f,0x3f6f20b0,0x3f79c79d,0x3f764d97,0x3f721352,0x3f6d1c1d,0x3f791298,0x3f75341d,0x3f708066,0x3f6afb8c
.long 0x3f7853f8,0x3f740bdd,0x3f6ed89e,0x3f68bf3c,0x3f778bc5,0x3f72d4eb,0x3f6d1c1d,0x3f666771,0x3f76ba07,0x3f718f57,0x3f6b4b0c,0x3f63f473,0x3f75dec6,0x3f703b37,0x3f696591,0x3f61668a
.long 0x3f74fa0b,0x3f6ed89e,0x3f676bd8,0x3f5ebe05,0x3f740bdd,0x3f6d67a1,0x3f655e0b,0x3f5bfb34,0x3f731447,0x3f6be858,0x3f633c5a,0x3f591e6a,0x3f721352,0x3f6a5ad9,0x3f6106f2,0x3f5627fe
.long 0x3f710908,0x3f68bf3c,0x3f5ebe05,0x3f531849,0x3f6ff573,0x3f671599,0x3f5c61c7,0x3f4fefa8,0x3f6ed89e,0x3f655e0b,0x3f59f26a,0x3f4cae79,0x3f6db293,0x3f6398ac,0x3f577026,0x3f495521
.long 0x3f800000,0x3f800000,0x3f800000,0x3f800000,0x3f7fec43,0x3f7fe705,0x3f7fe129,0x3f7fdaaf,0x3f7fb10f,0x3f7f9c18,0x3f7f84ab,0x3f7f6ac7,0x3f7f4e6d,0x3f7f1f49,0x3f7eea9d,0x3f7eb069
.long 0x3f7ec46d,0x3f7e70b0,0x3f7e1324,0x3f7dabcc,0x3f7e1324,0x3f7d906e,0x3f7cfe73,0x3f7c5d3a,0x3f7d3aac,0x3f7c7eb0,0x3f7baccd,0x3f7ac516,0x3f7c3b28,0x3f7b3bab,0x3f7a1e84,0x3f78e3d6
.long 0x3f7b14be,0x3f79c79d,0x3f7853f8,0x3f76ba07,0x3f79c79d,0x3f7822d1,0x3f764d97,0x3f74484b,0x3f7853f8,0x3f764d97,0x3f740bdd,0x3f718f57,0x3f76ba07,0x3f74484b,0x3f718f57,0x3f6e8ff8
.long 0x3f74fa0b,0x3f721352,0x3f6ed89e,0x3f6b4b0c,0x3f731447,0x3f6faf1b,0x3f6be858,0x3f67c187,0x3f710908,0x3f6d1c1d,0x3f68bf3c,0x3f63f473,0x3f6ed89e,0x3f6a5ad9,0x3f655e0b,0x3f5fe4e9
.long 0x3f6c835e,0x3f676bd8,0x3f61c598,0x3f5b941a,0x3f6a09a7,0x3f644fac,0x3f5df6be,0x3f570348,0x3f676bd8,0x3f6106f2,0x3f59f26a,0x3f5233c6,0x3f64aa59,0x3f5d924d,0x3f55b993,0x3f4d26fd
.long 0x3f61c598,0x3f59f26a,0x3f514d3d,0x3f47de65,0x3f5ebe05,0x3f5627fe,0x3f4cae79,0x3f425b89,0x3f5b941a,0x3f5233c6,0x3f47de65,0x3f3ca003,0x3f584853,0x3f4e1689,0x3f42de29,0x3f36ad7f
.long 0x3f54db31,0x3f49d112,0x3f3daef9,0x3f3085bb,0x3f514d3d,0x3f456439,0x3f385216,0x3f2a2a80,0x3f4d9f02,0x3f40d0da,0x3f32c8c9,0x3f239da9,0x3f49d112,0x3f3c17d9,0x3f2d1469,0x3f1ce11f
.long 0x3f45e403,0x3f373a23,0x3f273656,0x3f15f6d9,0x3f41d870,0x3f3238aa,0x3f212ff9,0x3f0ee0db,0x3f3daef9,0x3f2d1469,0x3f1b02c6,0x3f07a136,0x3f396842,0x3f27ce61,0x3f14b039,0x3f003a06
.long 0x3f800000,0x3f800000,0x3f800000,0x3f800000,0x3f7fd397,0x3f7fcbe2,0x3f7fc38f,0x3f7fba9e,0x3f7f4e6d,0x3f7f2f9d,0x3f7f0e58,0x3f7eea9d,0x3f7e70b0,0x3f7e2b72,0x3f7de0b1,0x3f7d906e
.long 0x3f7d3aac,0x3f7cbfc9,0x3f7c3b28,0x3f7baccd,0x3f7baccd,0x3f7aed37,0x3f7a1e84,0x3f7940c0,0x3f79c79d,0x3f78b47b,0x3f778bc5,0x3f764d97,0x3f778bc5,0x3f76167a,0x3f748422,0x3f72d4eb
.long 0x3f74fa0b,0x3f731447,0x3f710908,0x3f6ed89e,0x3f721352,0x3f6faf1b,0x3f6d1c1d,0x3f6a5ad9,0x3f6ed89e,0x3f6be858,0x3f68bf3c,0x3f655e0b,0x3f6b4b0c,0x3f67c187,0x3f63f473,0x3f5fe4e9
.long 0x3f676bd8,0x3f633c5a,0x3f5ebe05,0x3f59f26a,0x3f633c5a,0x3f5e5aa6,0x3f591e6a,0x3f5389c7,0x3f5ebe05,0x3f591e6a,0x3f531849,0x3f4cae79,0x3f59f26a,0x3f5389c7,0x3f4cae79,0x3f456439
.long 0x3f54db31,0x3f4d9f02,0x3f45e403,0x3f3daef9,0x3f4f7a1f,0x3f476085,0x3f3ebc1b,0x3f3592e7,0x3f49d112,0x3f40d0da,0x3f373a23,0x3f2d1469,0x3f43e200,0x3f39f2ac,0x3f2f61a5,0x3f24381a
.long 0x3f3daef9,0x3f32c8c9,0x3f273656,0x3f1b02c6,0x3f373a23,0x3f2b561b,0x3f1ebc12,0x3f11796b,0x3f3085bb,0x3f239da9,0x3f15f6d9,0x3f07a136,0x3f299415,0x3f1ba299,0x3f0cead0,0x3efafef7
.long 0x3f226799,0x3f13682a,0x3f039c3d,0x3ee63375,0x3f1b02c6,0x3f0af1b7,0x3ef41f07,0x3ed0eb2a,0x3f13682a,0x3f0242b1,0x3ee0924f,0x3ebb31a0,0x3f0b9a6b,0x3ef2bd43,0x3ecc9b8b,0x3ea5129f
.long 0x3f039c3d,0x3ee0924f,0x3eb8442a,0x3e8e9a22,0x3ef6e0cb,0x3ece0bea,0x3ea395c5,0x3e6fa8b2,0x3ee63375,0x3ebb31a0,0x3e8e9a22,0x3e419b37,0x3ed53641,0x3ea80b1f,0x3e72b651,0x3e1324ca
.long 0x3f800000,0x3f800000,0x3f800000,0x3f800000,0x3f7fb10f,0x3f7fa6e3,0x3f7f9c18,0x3f7f90b1,0x3f7ec46d,0x3f7e9bc9,0x3f7e70b0,0x3f7e4323,0x3f7d3aac,0x3f7cdf6c,0x3f7c7eb0,0x3f7c187a
.long 0x3f7b14be,0x3f7a7302,0x3f79c79d,0x3f791298,0x3f7853f8,0x3f77583a,0x3f764d97,0x3f75341d,0x3f74fa0b,0x3f73913f,0x3f721352,0x3f708066,0x3f710908,0x3f6f20b0,0x3f6d1c1d,0x3f6afb8c
.long 0x3f6c835e,0x3f6a09a7,0x3f676bd8,0x3f64aa59,0x3f676bd8,0x3f644fac,0x3f6106f2,0x3f5d924d,0x3f61c598,0x3f5df6be,0x3f59f26a,0x3f55b993,0x3f5b941a,0x3f570348,0x3f5233c6,0x3f4d26fd
.long 0x3f54db31,0x3f4f7a1f,0x3f49d112,0x3f43e200,0x3f4d9f02,0x3f476085,0x3f40d0da,0x3f39f2ac,0x3f45e403,0x3f3ebc1b,0x3f373a23,0x3f2f61a5,0x3f3daef9,0x3f3592e7,0x3f2d1469,0x3f24381a
.long 0x3f3504f3,0x3f2beb4a,0x3f226799,0x3f187fc0,0x3f2beb4a,0x3f21cbfb,0x3f173c07,0x3f0c42c9,0x3f226799,0x3f173c07,0x3f0b9a6b,0x3eff17b2,0x3f187fc0,0x3f0c42c9,0x3eff17b2,0x3ee4cbfe
.long 0x3f0e39da,0x3f00e7e4,0x3ee63375,0x3ec9b953,0x3f039c3d,0x3eea6681,0x3ecc9b8b,0x3eadf73c,0x3ef15aea,0x3ed25a09,0x3eb263ef,0x3e919ddd,0x3edae880,0x3eb9bb1e,0x3e97a117,0x3e698bba
.long 0x3ec3ef15,0x3ea09ae5,0x3e78cfcc,0x3e2f10a2,0x3eac7cd4,0x3e870ada,0x3e419b37,0x3de7fa9a,0x3e94a031,0x3e5a3997,0x3e09cf86,0x3d621469,0x3e78cfcc,0x3e25c58c,0x3da3308c,0xbb490fc6
.long 0x3e47c5c2,0x3de1bc2e,0x3cc90ab0,0xbd7b2b74,0x3e164083,0x3d6ea038,0xbcfb49ba,0xbdf475c0,0x3dc8bd36,0x3bc90f88,0xbdafb680,0xbe354098,0x3d48fb30,0xbd3c6dd5,0xbe1008b7,0xbe6fa8b2
.long 0x3f800000,0x3f800000,0x3f800000,0x3f800000,0x3f7f84ab,0x3f7f7808,0x3f7f6ac7,0x3f7f5ce9,0x3f7e1324,0x3f7de0b1,0x3f7dabcc,0x3f7d7474,0x3f7baccd,0x3f7b3bab,0x3f7ac516,0x3f7a4910
.long 0x3f7853f8,0x3f778bc5,0x3f76ba07,0x3f75dec6,0x3f740bdd,0x3f72d4eb,0x3f718f57,0x3f703b37,0x3f6ed89e,0x3f6d1c1d,0x3f6b4b0c,0x3f696591,0x3f68bf3c,0x3f666771,0x3f63f473,0x3f61668a
.long 0x3f61c598,0x3f5ebe05,0x3f5b941a,0x3f584853,0x3f59f26a,0x3f5627fe,0x3f5233c6,0x3f4e1689,0x3f514d3d,0x3f4cae79,0x3f47de65,0x3f42de29,0x3f47de65,0x3f425b89,0x3f3ca003,0x3f36ad7f
.long 0x3f3daef9,0x3f373a23,0x3f3085bb,0x3f299415,0x3f32c8c9,0x3f2b561b,0x3f239da9,0x3f1ba299,0x3f273656,0x3f1ebc12,0x3f15f6d9,0x3f0cead0,0x3f1b02c6,0x3f11796b,0x3f07a136,0x3efafef7
.long 0x3f0e39da,0x3f039c3d,0x3ef15aea,0x3edae880,0x3f00e7e4,0x3eea6681,0x3ed25a09,0x3eb9bb1e,0x3ee63375,0x3ecc9b8b,0x3eb263ef,0x3e97a117,0x3ec9b953,0x3eadf73c,0x3e919ddd,0x3e698bba
.long 0x3eac7cd4,0x3e8e9a22,0x3e605c13,0x3e22abb6,0x3e8e9a22,0x3e5d4b1a,0x3e1c76de,0x3db5f8da,0x3e605c13,0x3e1c76de,0x3dafb680,0x3c96c9b6,0x3e22abb6,0x3db5f8da,0x3c96c9b6,0xbd55880e
.long 0x3dc8bd36,0x3cc90ab0,0xbd48fb30,0xbdfab273,0x3d16c32c,0xbd2351cb,0xbdee3876,0xbe44b0b9,0xbcc90ab0,0xbdd53db9,0xbe3b6ecf,0xbe8586ce,0xbdafb680,0xbe2bf804,0xbe7ee6e1,0xbea80b1f
.long 0xbe164083,0xbe6c9a7f,0xbea09ae5,0xbec9b953,0xbe541501,0xbe9620d2,0xbec1071e,0xbeea6681,0xbe888e93,0xbeb554ec,0xbee0924f,0xbf04f484,0xbea68f12,0xbed3c867,0xbeff17b2,0xbf140c5f
.long 0x3f800000,0x3f800000,0x3f800000,0x3f800000,0x3f7f4e6d,0x3f7f3f54,0x3f7f2f9d,0x3f7f1f49,0x3f7d3aac,0x3f7cfe73,0x3f7cbfc9,0x3f7c7eb0,0x3f79c79d,0x3f7940c0,0x3f78b47b,0x3f7822d1
.long 0x3f74fa0b,0x3f740bdd,0x3f731447,0x3f721352,0x3f6ed89e,0x3f6d67a1,0x3f6be858,0x3f6a5ad9,0x3f676bd8,0x3f655e0b,0x3f633c5a,0x3f6106f2,0x3f5ebe05,0x3f5bfb34,0x3f591e6a,0x3f5627fe
.long 0x3f54db31,0x3f514d3d,0x3f4d9f02,0x3f49d112,0x3f49d112,0x3f456439,0x3f40d0da,0x3f3c17d9,0x3f3daef9,0x3f385216,0x3f32c8c9,0x3f2d1469,0x3f3085bb,0x3f2a2a80,0x3f239da9,0x3f1ce11f
.long 0x3f226799,0x3f1b02c6,0x3f13682a,0x3f0b9a6b,0x3f13682a,0x3f0af1b7,0x3f0242b1,0x3ef2bd43,0x3f039c3d,0x3ef41f07,0x3ee0924f,0x3ecc9b8b,0x3ee63375,0x3ed0eb2a,0x3ebb31a0,0x3ea5129f
.long 0x3ec3ef15,0x3eac7cd4,0x3e94a031,0x3e78cfcc,0x3ea09ae5,0x3e870ada,0x3e5a3997,0x3e25c58c,0x3e78cfcc,0x3e419b37,0x3e09cf86,0x3da3308c,0x3e2f10a2,0x3de7fa9a,0x3d621469,0xbb490fc6
.long 0x3dc8bd36,0x3d16c32c,0xbcc90ab0,0xbdafb680,0x3cc90ab0,0xbd2351cb,0xbdd53db9,0xbe2bf804,0xbd48fb30,0xbdee3876,0xbe3b6ecf,0xbe7ee6e1,0xbdfab273,0xbe44b0b9,0xbe8586ce,0xbea80b1f
.long 0xbe47c5c2,0xbe888e93,0xbeac7cd4,0xbecf7bca,0xbe888e93,0xbeadf73c,0xbed25a09,0xbef58035,0xbeac7cd4,0xbed25a09,0xbef6e0cb,0xbf0cead0,0xbecf7bca,0xbef58035,0xbf0cead0,0xbf1e1e22
.long 0xbef15aea,0xbf0b9a6b,0xbf1d7fd1,0xbf2e3bde,0xbf08f59b,0xbf1ba299,0xbf2d1469,0xbf3d27b8,0xbf187fc0,0xbf2ac082,0xbf3b8f3b,0xbf4ac77f,0xbf273656,0xbf38dd65,0xbf48d8b3,0xbf570348
.long 0x3f800000,0x3f800000,0x3f800000,0x3f800000,0x3f7f0e58,0x3f7efcc9,0x3f7eea9d,0x3f7ed7d4,0x3f7c3b28,0x3f7bf531,0x3f7baccd,0x3f7b61fc,0x3f778bc5,0x3f76ef5b,0x3f764d97,0x3f75a67b
.long 0x3f710908,0x3f6ff573,0x3f6ed89e,0x3f6db293,0x3f68bf3c,0x3f671599,0x3f655e0b,0x3f6398ac,0x3f5ebe05,0x3f5c61c7,0x3f59f26a,0x3f577026,0x3f531849,0x3f4fefa8,0x3f4cae79,0x3f495521
.long 0x3f45e403,0x3f41d870,0x3f3daef9,0x3f396842,0x3f373a23,0x3f3238aa,0x3f2d1469,0x3f27ce61,0x3f273656,0x3f212ff9,0x3f1b02c6,0x3f14b039,0x3f15f6d9,0x3f0ee0db,0x3f07a136,0x3f003a06
.long 0x3f039c3d,0x3ef6e0cb,0x3ee63375,0x3ed53641,0x3ee0924f,0x3ece0bea,0x3ebb31a0,0x3ea80b1f,0x3eb8442a,0x3ea395c5,0x3e8e9a22,0x3e72b651,0x3e8e9a22,0x3e6fa8b2,0x3e419b37,0x3e1324ca
.long 0x3e47c5c2,0x3e164083,0x3dc8bd36,0x3d48fb30,0x3de1bc2e,0x3d6ea038,0x3bc90f88,0xbd3c6dd5,0x3cc90ab0,0xbcfb49ba,0xbdafb680,0xbe1008b7,0xbd7b2b74,0xbdf475c0,0xbe354098,0xbe6fa8b2
.long 0xbe164083,0xbe541501,0xbe888e93,0xbea68f12,0xbe6c9a7f,0xbe9620d2,0xbeb554ec,0xbed3c867,0xbea09ae5,0xbec1071e,0xbee0924f,0xbeff17b2,0xbec9b953,0xbeea6681,0xbf04f484,0xbf140c5f
.long 0xbef15aea,0xbf08f59b,0xbf187fc0,0xbf273656,0xbf0b9a6b,0xbf1ba299,0xbf2ac082,0xbf38dd65,0xbf1d7fd1,0xbf2d1469,0xbf3b8f3b,0xbf48d8b3,0xbf2e3bde,0xbf3d27b8,0xbf4ac77f,0xbf570348
.long 0xbf3daef9,0xbf4bbbf8,0xbf584853,0xbf633c5a,0xbf4bbbf8,0xbf58b3a1,0xbf63f473,0xbf6d67a1,0xbf584853,0xbf63f473,0xbf6db293,0xbf756d97,0xbf633c5a,0xbf6d67a1,0xbf756d97,0xbf7b3bab
.long 0x0,0x0,0x0,0x0,0x0,0x3b490fc6,0x3bc90f88,0x3c16cb58,0x0,0x3bc90f88,0x3c490e90,0x3c96c9b6,0x0,0x3c16cb58,0x3c96c9b6,0x3ce22a7a
.long 0x0,0x3c490e90,0x3cc90ab0,0x3d16c32c,0x0,0x3c7b514b,0x3cfb49ba,0x3d3c6dd5,0x0,0x3c96c9b6,0x3d16c32c,0x3d621469,0x0,0x3cafea69,0x3d2fe007,0x3d83db0a
.long 0x0,0x3cc90ab0,0x3d48fb30,0x3d96a905,0x0,0x3ce22a7a,0x3d621469,0x3da973ba,0x0,0x3cfb49ba,0x3d7b2b74,0x3dbc3ac3,0x0,0x3d0a342f,0x3d8a200a,0x3dcefdb7
.long 0x0,0x3d16c32c,0x3d96a905,0x3de1bc2e,0x0,0x3d2351cb,0x3da3308c,0x3df475c0,0x0,0x3d2fe007,0x3dafb680,0x3e039502,0x0,0x3d3c6dd5,0x3dbc3ac3,0x3e0cec4a
.long 0x0,0x3d48fb30,0x3dc8bd36,0x3e164083,0x0,0x3d55880e,0x3dd53db9,0x3e1f917b,0x0,0x3d621469,0x3de1bc2e,0x3e28defc,0x0,0x3d6ea038,0x3dee3876,0x3e3228d4
.long 0x0,0x3d7b2b74,0x3dfab273,0x3e3b6ecf,0x0,0x3d83db0a,0x3e039502,0x3e44b0b9,0x0,0x3d8a200a,0x3e09cf86,0x3e4dee60,0x0,0x3d9064b4,0x3e1008b7,0x3e57278f
.long 0x0,0x3d96a905,0x3e164083,0x3e605c13,0x0,0x3d9cecf9,0x3e1c76de,0x3e698bba,0x0,0x3da3308c,0x3e22abb6,0x3e72b651,0x0,0x3da973ba,0x3e28defc,0x3e7bdba4
.long 0x0,0x3dafb680,0x3e2f10a2,0x3e827dc0,0x0,0x3db5f8da,0x3e354098,0x3e870ada,0x0,0x3dbc3ac3,0x3e3b6ecf,0x3e8b9507,0x0,0x3dc27c39,0x3e419b37,0x3e901c2c
.long 0x0,0x0,0x0,0x0,0x3c490e90,0x3c7b514b,0x3c96c9b6,0x3cafea69,0x3cc90ab0,0x3cfb49ba,0x3d16c32c,0x3d2fe007,0x3d16c32c,0x3d3c6dd5,0x3d621469,0x3d83db0a
.long 0x3d48fb30,0x3d7b2b74,0x3d96a905,0x3dafb680,0x3d7b2b74,0x3d9cecf9,0x3dbc3ac3,0x3ddb7d37,0x3d96a905,0x3dbc3ac3,0x3de1bc2e,0x3e039502,0x3dafb680,0x3ddb7d37,0x3e039502,0x3e195be0
.long 0x3dc8bd36,0x3dfab273,0x3e164083,0x3e2f10a2,0x3de1bc2e,0x3e0cec4a,0x3e28defc,0x3e44b0b9,0x3dfab273,0x3e1c76de,0x3e3b6ecf,0x3e5a3997,0x3e09cf86,0x3e2bf804,0x3e4dee60,0x3e6fa8b2
.long 0x3e164083,0x3e3b6ecf,0x3e605c13,0x3e827dc0,0x3e22abb6,0x3e4ada4f,0x3e72b651,0x3e8d17c0,0x3e2f10a2,0x3e5a3997,0x3e827dc0,0x3e97a117,0x3e3b6ecf,0x3e698bba,0x3e8b9507,0x3ea21887
.long 0x3e47c5c2,0x3e78cfcc,0x3e94a031,0x3eac7cd4,0x3e541501,0x3e840270,0x3e9d9e78,0x3eb6ccc3,0x3e605c13,0x3e8b9507,0x3ea68f12,0x3ec1071e,0x3e6c9a7f,0x3e931f35,0x3eaf713a,0x3ecb2aae
.long 0x3e78cfcc,0x3e9aa086,0x3eb8442a,0x3ed53641,0x3e827dc0,0x3ea21887,0x3ec1071e,0x3edf28a9,0x3e888e93,0x3ea986c4,0x3ec9b953,0x3ee900b7,0x3e8e9a22,0x3eb0eacb,0x3ed25a09,0x3ef2bd43
.long 0x3e94a031,0x3eb8442a,0x3edae880,0x3efc5d27,0x3e9aa086,0x3ebf926f,0x3ee363fa,0x3f02ef9f,0x3ea09ae5,0x3ec6d529,0x3eebcbbb,0x3f07a136,0x3ea68f12,0x3ece0bea,0x3ef41f07,0x3f0c42c9
.long 0x3eac7cd4,0x3ed53641,0x3efc5d27,0x3f10d3cd,0x3eb263ef,0x3edc53c1,0x3f0242b1,0x3f1553b7,0x3eb8442a,0x3ee363fa,0x3f064b82,0x3f19c200,0x3ebe1d4a,0x3eea6681,0x3f0a48ad,0x3f1e1e22
.long 0x0,0x0,0x0,0x0,0x3cc90ab0,0x3ce22a7a,0x3cfb49ba,0x3d0a342f,0x3d48fb30,0x3d621469,0x3d7b2b74,0x3d8a200a,0x3d96a905,0x3da973ba,0x3dbc3ac3,0x3dcefdb7
.long 0x3dc8bd36,0x3de1bc2e,0x3dfab273,0x3e09cf86,0x3dfab273,0x3e0cec4a,0x3e1c76de,0x3e2bf804,0x3e164083,0x3e28defc,0x3e3b6ecf,0x3e4dee60,0x3e2f10a2,0x3e44b0b9,0x3e5a3997,0x3e6fa8b2
.long 0x3e47c5c2,0x3e605c13,0x3e78cfcc,0x3e888e93,0x3e605c13,0x3e7bdba4,0x3e8b9507,0x3e9920fe,0x3e78cfcc,0x3e8b9507,0x3e9aa086,0x3ea986c4,0x3e888e93,0x3e9920fe,0x3ea986c4,0x3eb9bb1e
.long 0x3e94a031,0x3ea68f12,0x3eb8442a,0x3ec9b953,0x3ea09ae5,0x3eb3dca5,0x3ec6d529,0x3ed97cb9,0x3eac7cd4,0x3ec1071e,0x3ed53641,0x3ee900b7,0x3eb8442a,0x3ece0bea,0x3ee363fa,0x3ef840c8
.long 0x3ec3ef15,0x3edae880,0x3ef15aea,0x3f039c3d,0x3ecf7bca,0x3ee79a5d,0x3eff17b2,0x3f0af1b7,0x3edae880,0x3ef41f07,0x3f064b82,0x3f121eb0,0x3ee63375,0x3f003a06,0x3f0cead0,0x3f19210f
.long 0x3ef15aea,0x3f064b82,0x3f13682a,0x3f1ff6cb,0x3efc5d27,0x3f0c42c9,0x3f19c200,0x3f269de3,0x3f039c3d,0x3f121eb0,0x3f1ff6cb,0x3f2d1469,0x3f08f59b,0x3f17de12,0x3f26050a,0x3f33587a
.long 0x3f0e39da,0x3f1d7fd1,0x3f2beb4a,0x3f396842,0x3f13682a,0x3f2302d3,0x3f31a81d,0x3f3f41fc,0x3f187fc0,0x3f286605,0x3f373a23,0x3f44e3f5,0x3f1d7fd1,0x3f2da859,0x3f3ca003,0x3f4a4c87
.long 0x3f226799,0x3f32c8c9,0x3f41d870,0x3f4f7a1f,0x3f273656,0x3f37c655,0x3f46e22a,0x3f546b3b,0x3f2beb4a,0x3f3ca003,0x3f4bbbf8,0x3f591e6a,0x3f3085bb,0x3f4154e1,0x3f5064af,0x3f5d924d
.long 0x0,0x0,0x0,0x0,0x3d16c32c,0x3d2351cb,0x3d2fe007,0x3d3c6dd5,0x3d96a905,0x3da3308c,0x3dafb680,0x3dbc3ac3,0x3de1bc2e,0x3df475c0,0x3e039502,0x3e0cec4a
.long 0x3e164083,0x3e22abb6,0x3e2f10a2,0x3e3b6ecf,0x3e3b6ecf,0x3e4ada4f,0x3e5a3997,0x3e698bba,0x3e605c13,0x3e72b651,0x3e827dc0,0x3e8b9507,0x3e827dc0,0x3e8d17c0,0x3e97a117,0x3ea21887
.long 0x3e94a031,0x3ea09ae5,0x3eac7cd4,0x3eb8442a,0x3ea68f12,0x3eb3dca5,0x3ec1071e,0x3ece0bea,0x3eb8442a,0x3ec6d529,0x3ed53641,0x3ee363fa,0x3ec9b953,0x3ed97cb9,0x3ee900b7,0x3ef840c8
.long 0x3edae880,0x3eebcbbb,0x3efc5d27,0x3f064b82,0x3eebcbbb,0x3efdbabb,0x3f07a136,0x3f102dd5,0x3efc5d27,0x3f07a136,0x3f10d3cd,0x3f19c200,0x3f064b82,0x3f102dd5,0x3f19c200,0x3f2302d3
.long 0x3f0e39da,0x3f187fc0,0x3f226799,0x3f2beb4a,0x3f15f6d9,0x3f209393,0x3f2ac082,0x3f34768f,0x3f1d7fd1,0x3f286605,0x3f32c8c9,0x3f3ca003,0x3f24d225,0x3f2ff3e6,0x3f3a7ca4,0x3f446337
.long 0x3f2beb4a,0x3f373a23,0x3f41d870,0x3f4bbbf8,0x3f32c8c9,0x3f3e35c5,0x3f48d8b3,0x3f52a649,0x3f396842,0x3f44e3f5,0x3f4f7a1f,0x3f591e6a,0x3f3fc767,0x3f4b41fa,0x3f55b993,0x3f5f20db
.long 0x3f45e403,0x3f514d3d,0x3f5b941a,0x3f64aa59,0x3f4bbbf8,0x3f570348,0x3f6106f2,0x3f69b7e4,0x3f514d3d,0x3f5c61c7,0x3f660f88,0x3f6e46be,0x3f5695e5,0x3f61668a,0x3f6aab7b,0x3f725470
.long 0x3f5b941a,0x3f660f88,0x3f6ed89e,0x3f75dec6,0x3f604621,0x3f6a5ad9,0x3f7294f8,0x3f78e3d6,0x3f64aa59,0x3f6e46be,0x3f75dec6,0x3f7b61fc,0x3f68bf3c,0x3f71d19f,0x3f78b47b,0x3f7d57de
.long 0x0,0x0,0x0,0x0,0x3d48fb30,0x3d55880e,0x3d621469,0x3d6ea038,0x3dc8bd36,0x3dd53db9,0x3de1bc2e,0x3dee3876,0x3e164083,0x3e1f917b,0x3e28defc,0x3e3228d4
.long 0x3e47c5c2,0x3e541501,0x3e605c13,0x3e6c9a7f,0x3e78cfcc,0x3e840270,0x3e8b9507,0x3e931f35,0x3e94a031,0x3e9d9e78,0x3ea68f12,0x3eaf713a,0x3eac7cd4,0x3eb6ccc3,0x3ec1071e,0x3ecb2aae
.long 0x3ec3ef15,0x3ecf7bca,0x3edae880,0x3ee63375,0x3edae880,0x3ee79a5d,0x3ef41f07,0x3f003a06,0x3ef15aea,0x3eff17b2,0x3f064b82,0x3f0cead0,0x3f039c3d,0x3f0af1b7,0x3f121eb0,0x3f19210f
.long 0x3f0e39da,0x3f15f6d9,0x3f1d7fd1,0x3f24d225,0x3f187fc0,0x3f209393,0x3f286605,0x3f2ff3e6,0x3f226799,0x3f2ac082,0x3f32c8c9,0x3f3a7ca4,0x3f2beb4a,0x3f34768f,0x3f3ca003,0x3f446337
.long 0x3f3504f3,0x3f3daef9,0x3f45e403,0x3f4d9f02,0x3f3daef9,0x3f466354,0x3f4e8d90,0x3f5627fe,0x3f45e403,0x3f4e8d90,0x3f5695e5,0x3f5df6be,0x3f4d9f02,0x3f5627fe,0x3f5df6be,0x3f650479
.long 0x3f54db31,0x3f5d2d53,0x3f64aa59,0x3f6b4b0c,0x3f5b941a,0x3f6398ac,0x3f6aab7b,0x3f70c501,0x3f61c598,0x3f696591,0x3f6ff573,0x3f756d97,0x3f676bd8,0x3f6e8ff8,0x3f748422,0x3f7940c0
.long 0x3f6c835e,0x3f731447,0x3f7853f8,0x3f7c3b28,0x3f710908,0x3f76ef5b,0x3f7b61fc,0x3f7e5a38,0x3f74fa0b,0x3f7a1e84,0x3f7dabcc,0x3f7f9c18,0x3f7853f8,0x3f7c9f8a,0x3f7f2f9d,0x3f7fffb1
.long 0x3f7b14be,0x3f7e70b0,0x3f7fec43,0x3f7f84ab,0x3f7d3aac,0x3f7f90b1,0x3f7fe129,0x3f7e2b72,0x3f7ec46d,0x3f7ffec4,0x3f7f0e58,0x3f7bf531,0x3f7fb10f,0x3f7fba9e,0x3f7d7474,0x3f78e3d6
.long 0x0,0x0,0x0,0x0,0x3d7b2b74,0x3d83db0a,0x3d8a200a,0x3d9064b4,0x3dfab273,0x3e039502,0x3e09cf86,0x3e1008b7,0x3e3b6ecf,0x3e44b0b9,0x3e4dee60,0x3e57278f
.long 0x3e78cfcc,0x3e827dc0,0x3e888e93,0x3e8e9a22,0x3e9aa086,0x3ea21887,0x3ea986c4,0x3eb0eacb,0x3eb8442a,0x3ec1071e,0x3ec9b953,0x3ed25a09,0x3ed53641,0x3edf28a9,0x3ee900b7,0x3ef2bd43
.long 0x3ef15aea,0x3efc5d27,0x3f039c3d,0x3f08f59b,0x3f064b82,0x3f0c42c9,0x3f121eb0,0x3f17de12,0x3f13682a,0x3f19c200,0x3f1ff6cb,0x3f26050a,0x3f1ff6cb,0x3f269de3,0x3f2d1469,0x3f33587a
.long 0x3f2beb4a,0x3f32c8c9,0x3f396842,0x3f3fc767,0x3f373a23,0x3f3e35c5,0x3f44e3f5,0x3f4b41fa,0x3f41d870,0x3f48d8b3,0x3f4f7a1f,0x3f55b993,0x3f4bbbf8,0x3f52a649,0x3f591e6a,0x3f5f20db
.long 0x3f54db31,0x3f5b941a,0x3f61c598,0x3f676bd8,0x3f5d2d53,0x3f6398ac,0x3f696591,0x3f6e8ff8,0x3f64aa59,0x3f6aab7b,0x3f6ff573,0x3f748422,0x3f6b4b0c,0x3f70c501,0x3f756d97,0x3f7940c0
.long 0x3f710908,0x3f75dec6,0x3f79c79d,0x3f7cbfc9,0x3f75dec6,0x3f79f35e,0x3f7cfe73,0x3f7efcc9,0x3f79c79d,0x3f7cfe73,0x3f7f0e58,0x3f7ff4e6,0x3f7cbfc9,0x3f7efcc9,0x3f7ff4e6,0x3f7fa6e3
.long 0x3f7ec46d,0x3f7fec43,0x3f7fb10f,0x3f7e1324,0x3f7fd397,0x3f7fcbe2,0x3f7e4323,0x3f7b3bab,0x3f7fec43,0x3f7e9bc9,0x3f7baccd,0x3f772417,0x3f7f0e58,0x3f7c5d3a,0x3f77f110,0x3f71d19f
.long 0x3f7d3aac,0x3f791298,0x3f731447,0x3f6b4b0c,0x3f7a7302,0x3f74bf62,0x3f6d1c1d,0x3f6398ac,0x3f76ba07,0x3f6f6830,0x3f660f88,0x3f5ac450,0x3f721352,0x3f6912ae,0x3f5df6be,0x3f50d937
.long 0x0,0x0,0x0,0x0,0x3d96a905,0x3d9cecf9,0x3da3308c,0x3da973ba,0x3e164083,0x3e1c76de,0x3e22abb6,0x3e28defc,0x3e605c13,0x3e698bba,0x3e72b651,0x3e7bdba4
.long 0x3e94a031,0x3e9aa086,0x3ea09ae5,0x3ea68f12,0x3eb8442a,0x3ebf926f,0x3ec6d529,0x3ece0bea,0x3edae880,0x3ee363fa,0x3eebcbbb,0x3ef41f07,0x3efc5d27,0x3f02ef9f,0x3f07a136,0x3f0c42c9
.long 0x3f0e39da,0x3f13682a,0x3f187fc0,0x3f1d7fd1,0x3f1d7fd1,0x3f2302d3,0x3f286605,0x3f2da859,0x3f2beb4a,0x3f31a81d,0x3f373a23,0x3f3ca003,0x3f396842,0x3f3f41fc,0x3f44e3f5,0x3f4a4c87
.long 0x3f45e403,0x3f4bbbf8,0x3f514d3d,0x3f5695e5,0x3f514d3d,0x3f570348,0x3f5c61c7,0x3f61668a,0x3f5b941a,0x3f6106f2,0x3f660f88,0x3f6aab7b,0x3f64aa59,0x3f69b7e4,0x3f6e46be,0x3f725470
.long 0x3f6c835e,0x3f710908,0x3f74fa0b,0x3f7853f8,0x3f731447,0x3f76ef5b,0x3f7a1e84,0x3f7c9f8a,0x3f7853f8,0x3f7b61fc,0x3f7dabcc,0x3f7f2f9d,0x3f7c3b28,0x3f7e5a38,0x3f7f9c18,0x3f7fffb1
.long 0x3f7ec46d,0x3f7fd397,0x3f7fec43,0x3f7f0e58,0x3f7fec43,0x3f7fcbe2,0x3f7e9bc9,0x3f7c5d3a,0x3f7fb10f,0x3f7e4323,0x3f7baccd,0x3f77f110,0x3f7e1324,0x3f7b3bab,0x3f772417,0x3f71d19f
.long 0x3f7b14be,0x3f76ba07,0x3f710908,0x3f6a09a7,0x3f76ba07,0x3f70c501,0x3f696591,0x3f60a6cf,0x3f710908,0x3f696591,0x3f604621,0x3f55b993,0x3f6a09a7,0x3f60a6cf,0x3f55b993,0x3f495521
.long 0x3f61c598,0x3f5695e5,0x3f49d112,0x3f3b8f3b,0x3f584853,0x3f4b41fa,0x3f3ca003,0x3f2c800f,0x3f4d9f02,0x3f3ebc1b,0x3f2e3bde,0x3f1c420c,0x3f41d870,0x3f311722,0x3f1ebc12,0x3f0af1b7
.long 0x0,0x0,0x0,0x0,0x3dafb680,0x3db5f8da,0x3dbc3ac3,0x3dc27c39,0x3e2f10a2,0x3e354098,0x3e3b6ecf,0x3e419b37,0x3e827dc0,0x3e870ada,0x3e8b9507,0x3e901c2c
.long 0x3eac7cd4,0x3eb263ef,0x3eb8442a,0x3ebe1d4a,0x3ed53641,0x3edc53c1,0x3ee363fa,0x3eea6681,0x3efc5d27,0x3f0242b1,0x3f064b82,0x3f0a48ad,0x3f10d3cd,0x3f1553b7,0x3f19c200,0x3f1e1e22
.long 0x3f226799,0x3f273656,0x3f2beb4a,0x3f3085bb,0x3f32c8c9,0x3f37c655,0x3f3ca003,0x3f4154e1,0x3f41d870,0x3f46e22a,0x3f4bbbf8,0x3f5064af,0x3f4f7a1f,0x3f546b3b,0x3f591e6a,0x3f5d924d
.long 0x3f5b941a,0x3f604621,0x3f64aa59,0x3f68bf3c,0x3f660f88,0x3f6a5ad9,0x3f6e46be,0x3f71d19f,0x3f6ed89e,0x3f7294f8,0x3f75dec6,0x3f78b47b,0x3f75dec6,0x3f78e3d6,0x3f7b61fc,0x3f7d57de
.long 0x3f7b14be,0x3f7d3aac,0x3f7ec46d,0x3f7fb10f,0x3f7e70b0,0x3f7f90b1,0x3f7ffec4,0x3f7fba9e,0x3f7fec43,0x3f7fe129,0x3f7f0e58,0x3f7d7474,0x3f7f84ab,0x3f7e2b72,0x3f7bf531,0x3f78e3d6
.long 0x3f7d3aac,0x3f7a7302,0x3f76ba07,0x3f721352,0x3f791298,0x3f74bf62,0x3f6f6830,0x3f6912ae,0x3f731447,0x3f6d1c1d,0x3f660f88,0x3f5df6be,0x3f6b4b0c,0x3f6398ac,0x3f5ac450,0x3f50d937
.long 0x3f61c598,0x3f584853,0x3f4d9f02,0x3f41d870,0x3f5695e5,0x3f4b41fa,0x3f3ebc1b,0x3f311722,0x3f49d112,0x3f3ca003,0x3f2e3bde,0x3f1ebc12,0x3f3b8f3b,0x3f2c800f,0x3f1c420c,0x3f0af1b7
.long 0x3f2beb4a,0x3f1b02c6,0x3f08f59b,0x3eebcbbb,0x3f1b02c6,0x3f084b92,0x3ee900b7,0x3ebf926f,0x3f08f59b,0x3ee900b7,0x3ebe1d4a,0x3e919ddd,0x3eebcbbb,0x3ebf926f,0x3e919ddd,0x3e44b0b9
.long 0x3f800000,0x3f800000,0x3f800000,0x3f800000,0x3f7ec46d,0x3f7eb069,0x3f7e9bc9,0x3f7e868b,0x3f7b14be,0x3f7ac516,0x3f7a7302,0x3f7a1e84,0x3f74fa0b,0x3f74484b,0x3f73913f,0x3f72d4eb
.long 0x3f6c835e,0x3f6b4b0c,0x3f6a09a7,0x3f68bf3c,0x3f61c598,0x3f5fe4e9,0x3f5df6be,0x3f5bfb34,0x3f54db31,0x3f5233c6,0x3f4f7a1f,0x3f4cae79,0x3f45e403,0x3f425b89,0x3f3ebc1b,0x3f3b0629
.long 0x3f3504f3,0x3f3085bb,0x3f2beb4a,0x3f273656,0x3f226799,0x3f1ce11f,0x3f173c07,0x3f11796b,0x3f0e39da,0x3f07a136,0x3f00e7e4,0x3ef41f07,0x3ef15aea,0x3ee1fb6a,0x3ed25a09,0x3ec27b55
.long 0x3ec3ef15,0x3eb263ef,0x3ea09ae5,0x3e8e9a22,0x3e94a031,0x3e80f8c0,0x3e5a3997,0x3e3228d4,0x3e47c5c2,0x3e1c76de,0x3de1bc2e,0x3d8a200a,0x3dc8bd36,0x3d55880e,0x3bc90f88,0xbd2351cb
.long 0x248d3132,0xbd48fb30,0xbdc8bd36,0xbe164083,0xbdc8bd36,0xbe195be0,0xbe4dee60,0xbe80f8c0,0xbe47c5c2,0xbe7ee6e1,0xbe9aa086,0xbeb554ec,0xbe94a031,0xbeb0eacb,0xbecc9b8b,0xbee79a5d
.long 0xbec3ef15,0xbee0924f,0xbefc5d27,0xbf0b9a6b,0xbef15aea,0xbf06f686,0xbf14b039,0xbf21cbfb,0xbf0e39da,0xbf1c420c,0xbf299415,0xbf36206c,0xbf226799,0xbf2ff3e6,0xbf3ca003,0xbf485bca
.long 0xbf3504f3,0xbf41d870,0xbf4d9f02,0xbf584853,0xbf45e403,0xbf51c0c2,0xbf5c61c7,0xbf65b710,0xbf54db31,0xbf5f8327,0xbf68bf3c,0xbf708066,0xbf61c598,0xbf6afb8c,0xbf7294f8,0xbf788486
.long 0xbf6c835e,0xbf740bdd,0xbf79c79d,0xbf7dabcc,0xbf74fa0b,0xbf7a9c59,0xbf7e4323,0xbf7fe705,0xbf7b14be,0xbf7e9bc9,0xbf7ffb11,0xbf7f2f9d,0xbf7ec46d,0xbf7fffb1,0xbf7eea9d,0xbf7b87b2
.long 0x3f800000,0x3f800000,0x3f800000,0x3f800000,0x3f7e70b0,0x3f7e5a38,0x3f7e4323,0x3f7e2b72,0x3f79c79d,0x3f796e4e,0x3f791298,0x3f78b47b,0x3f721352,0x3f714c7a,0x3f708066,0x3f6faf1b
.long 0x3f676bd8,0x3f660f88,0x3f64aa59,0x3f633c5a,0x3f59f26a,0x3f57dc7f,0x3f55b993,0x3f5389c7,0x3f49d112,0x3f46e22a,0x3f43e200,0x3f40d0da,0x3f373a23,0x3f33587a,0x3f2f61a5,0x3f2b561b
.long 0x3f226799,0x3f1d7fd1,0x3f187fc0,0x3f13682a,0x3f0b9a6b,0x3f05a02c,0x3eff17b2,0x3ef2bd43,0x3ee63375,0x3ed8106b,0x3ec9b953,0x3ebb31a0,0x3eb263ef,0x3ea21887,0x3e919ddd,0x3e80f8c0
.long 0x3e78cfcc,0x3e541501,0x3e2f10a2,0x3e09cf86,0x3e09cf86,0x3dc27c39,0x3d621469,0x3c7b514b,0x3cc90ab0,0xbc96c9b6,0xbd7b2b74,0xbdd53db9,0xbdafb680,0xbe06b26e,0xbe354098,0xbe636c83
.long 0xbe47c5c2,0xbe78cfcc,0xbe94a031,0xbeac7cd4,0xbe9aa086,0xbeb3dca5,0xbecc9b8b,0xbee4cbfe,0xbecf7bca,0xbee900b7,0xbf00e7e4,0xbf0cead0,0xbf00e7e4,0xbf0d9281,0xbf19c200,0xbf256bcb
.long 0xbf187fc0,0xbf24d225,0xbf3085bb,0xbf3b8f3b,0xbf2e3bde,0xbf39f2ac,0xbf44e3f5,0xbf4f0417,0xbf41d870,0xbf4cae79,0xbf5695e5,0xbf5f8327,0xbf531849,0xbf5cc7d1,0xbf655e0b,0xbf6cd007
.long 0xbf61c598,0xbf6a09a7,0xbf710908,0xbf76ba07,0xbf6db293,0xbf74484b,0xbf796e4e,0xbf7d1cdd,0xbf76ba07,0xbf7b61fc,0xbf7e70b0,0xbf7fe129,0xbf7cbfc9,0xbf7f3f54,0xbf7ffec4,0xbf7efcc9
.long 0xbf7fb10f,0xbf7fd397,0xbf7e1324,0xbf7a7302,0xbf7f84ab,0xbf7d1cdd,0xbf78b47b,0xbf725470,0xbf7c3b28,0xbf772417,0xbf6ff573,0xbf66becc,0xbf75dec6,0xbf6dfcf2,0xbf63f473,0xbf57dc7f
.long 0x3f800000,0x3f800000,0x3f800000,0x3f800000,0x3f7e1324,0x3f7dfa38,0x3f7de0b1,0x3f7dc68c,0x3f7853f8,0x3f77f110,0x3f778bc5,0x3f772417,0x3f6ed89e,0x3f6dfcf2,0x3f6d1c1d,0x3f6c3624
.long 0x3f61c598,0x3f604621,0x3f5ebe05,0x3f5d2d53,0x3f514d3d,0x3f4f0417,0x3f4cae79,0x3f4a4c87,0x3f3daef9,0x3f3a7ca4,0x3f373a23,0x3f33e7bc,0x3f273656,0x3f2302d3,0x3f1ebc12,0x3f1a6293
.long 0x3f0e39da,0x3f08f59b,0x3f039c3d,0x3efc5d27,0x3ee63375,0x3ed97cb9,0x3ecc9b8b,0x3ebf926f,0x3eac7cd4,0x3e9d9e78,0x3e8e9a22,0x3e7ee6e1,0x3e605c13,0x3e3e853e,0x3e1c76de,0x3df475c0
.long 0x3dc8bd36,0x3d7b2b74,0x3cc90ab0,0xbc490e90,0xbcc90ab0,0xbd83db0a,0xbdd53db9,0xbe1324ca,0xbe164083,0xbe419b37,0xbe6c9a7f,0xbe8b9507,0xbe888e93,0xbe9f1cdf,0xbeb554ec,0xbecb2aae
.long 0xbec3ef15,0xbedae880,0xbef15aea,0xbf039c3d,0xbefc5d27,0xbf099f4e,0xbf14b039,0xbf1f599f,0xbf187fc0,0xbf239da9,0xbf2e3bde,0xbf385216,0xbf3085bb,0xbf3b0629,0xbf44e3f5,0xbf4e1689
.long 0xbf45e403,0xbf4f7a1f,0xbf584853,0xbf604621,0xbf584853,0xbf60a6cf,0xbf6816a8,0xbf6e8ff8,0xbf676bd8,0xbf6e46be,0xbf740bdd,0xbf78b47b,0xbf731447,0xbf7822d1,0xbf7bf531,0xbf7e868b
.long 0xbf7b14be,0xbf7e1324,0xbf7fb10f,0xbf7fec43,0xbf7f4e6d,0xbf7fffb1,0xbf7f2f9d,0xbf7cdf6c,0xbf7fb10f,0xbf7de0b1,0xbf7a7302,0xbf756d97,0xbf7c3b28,0xbf77beb7,0xbf718f57,0xbf69b7e4
.long 0xbf74fa0b,0xbf6db293,0xbf64aa59,0xbf59f26a,0xbf6a09a7,0xbf5fe4e9,0xbf53fac3,0xbf466354,0xbf5b941a,0xbf4e8d90,0xbf3fc767,0xbf2f61a5,0xbf49d112,0xbf39f2ac,0xbf286605,0xbf1553b7
.long 0x3f800000,0x3f800000,0x3f800000,0x3f800000,0x3f7dabcc,0x3f7d906e,0x3f7d7474,0x3f7d57de,0x3f76ba07,0x3f764d97,0x3f75dec6,0x3f756d97,0x3f6b4b0c,0x3f6a5ad9,0x3f696591,0x3f686b39
.long 0x3f5b941a,0x3f59f26a,0x3f584853,0x3f5695e5,0x3f47de65,0x3f456439,0x3f42de29,0x3f404c5c,0x3f3085bb,0x3f2d1469,0x3f299415,0x3f26050a,0x3f15f6d9,0x3f11796b,0x3f0cead0,0x3f084b92
.long 0x3ef15aea,0x3ee63375,0x3edae880,0x3ecf7bca,0x3eb263ef,0x3ea5129f,0x3e97a117,0x3e8a11f7,0x3e605c13,0x3e419b37,0x3e22abb6,0x3e039502,0x3dafb680,0x3d55880e,0x3c96c9b6,0xbc7b514b
.long 0xbd48fb30,0xbdafb680,0xbdfab273,0xbe22abb6,0xbe3b6ecf,0xbe636c83,0xbe8586ce,0xbe9920fe,0xbea09ae5,0xbeb554ec,0xbec9b953,0xbeddbe79,0xbee0924f,0xbef58035,0xbf04f484,0xbf0ee0db
.long 0xbf0e39da,0xbf187fc0,0xbf226799,0xbf2beb4a,0xbf299415,0xbf33587a,0xbf3ca003,0xbf456439,0xbf41d870,0xbf4ac77f,0xbf531849,0xbf5ac450,0xbf5695e5,0xbf5e5aa6,0xbf655e0b,0xbf6b99fb
.long 0xbf676bd8,0xbf6db293,0xbf731447,0xbf778bc5,0xbf740bdd,0xbf788486,0xbf7bf531,0xbf7e5a38,0xbf7c3b28,0xbf7e9bc9,0xbf7fd397,0xbf7fe129,0xbf7fd397,0xbf7fdaaf,0xbf7e9bc9,0xbf7c187a
.long 0xbf7ec46d,0xbf7c3b28,0xbf7853f8,0xbf731447,0xbf791298,0xbf73ced9,0xbf6d1c1d,0xbf650479,0xbf6ed89e,0xbf66becc,0xbf5d2d53,0xbf5233c6,0xbf604621,0xbf554aa4,0xbf48d8b3,0xbf3b0629
.long 0xbf4d9f02,0xbf3fc767,0xbf3085bb,0xbf1ff6cb,0xbf373a23,0xbf269de3,0xbf14b039,0xbf019573,0xbf1d7fd1,0xbf0a48ad,0xbeebcbbb,0xbec1071e,0xbf00e7e4,0xbed6a399,0xbea986c4,0xbe75c35a
.long 0x3f800000,0x3f800000,0x3f800000,0x3f800000,0x3f7d3aac,0x3f7d1cdd,0x3f7cfe73,0x3f7cdf6c,0x3f74fa0b,0x3f748422,0x3f740bdd,0x3f73913f,0x3f676bd8,0x3f666771,0x3f655e0b,0x3f644fac
.long 0x3f54db31,0x3f531849,0x3f514d3d,0x3f4f7a1f,0x3f3daef9,0x3f3b0629,0x3f385216,0x3f3592e7,0x3f226799,0x3f1ebc12,0x3f1b02c6,0x3f173c07,0x3f039c3d,0x3efdbabb,0x3ef41f07,0x3eea6681
.long 0x3ec3ef15,0x3eb8442a,0x3eac7cd4,0x3ea09ae5,0x3e78cfcc,0x3e5d4b1a,0x3e419b37,0x3e25c58c,0x3dc8bd36,0x3d8a200a,0x3d16c32c,0x3bc90f88,0xbd48fb30,0xbda973ba,0xbdee3876,0xbe195be0
.long 0xbe47c5c2,0xbe6c9a7f,0xbe888e93,0xbe9aa086,0xbeac7cd4,0xbebf926f,0xbed25a09,0xbee4cbfe,0xbef15aea,0xbf0242b1,0xbf0b9a6b,0xbf14b039,0xbf187fc0,0xbf21cbfb,0xbf2ac082,0xbf33587a
.long 0xbf3504f3,0xbf3daef9,0xbf45e403,0xbf4d9f02,0xbf4d9f02,0xbf554aa4,0xbf5c61c7,0xbf62df7b,0xbf61c598,0xbf6816a8,0xbf6db293,0xbf7294f8,0xbf710908,0xbf75a67b,0xbf796e4e,0xbf7c5d3a
.long 0xbf7b14be,0xbf7dabcc,0xbf7f4e6d,0xbf7ffb11,0xbf7fb10f,0xbf7ff84a,0xbf7f2f9d,0xbf7d57de,0xbf7ec46d,0xbf7c7eb0,0xbf791298,0xbf748422,0xbf7853f8,0xbf73530e,0xbf6d1c1d,0xbf65b710
.long 0xbf6c835e,0xbf64aa59,0xbf5b941a,0xbf514d3d,0xbf5b941a,0xbf50d937,0xbf44e3f5,0xbf37c655,0xbf45e403,0xbf385216,0xbf299415,0xbf19c200,0xbf2beb4a,0xbf1ba299,0xbf0a48ad,0xbeeff7fb
.long 0xbf0e39da,0xbef6e0cb,0xbecf7bca,0xbea68f12,0xbedae880,0xbeb0eacb,0xbe8586ce,0xbe3228d4,0xbe94a031,0xbe4dee60,0xbde1bc2e,0xbc96c9b6,0xbe164083,0xbd55880e,0x3d2fe007,0x3e0cec4a
.long 0x3f800000,0x3f800000,0x3f800000,0x3f800000,0x3f7cbfc9,0x3f7c9f8a,0x3f7c7eb0,0x3f7c5d3a,0x3f731447,0x3f7294f8,0x3f721352,0x3f718f57,0x3f633c5a,0x3f62241a,0x3f6106f2,0x3f5fe4e9
.long 0x3f4d9f02,0x3f4bbbf8,0x3f49d112,0x3f47de65,0x3f32c8c9,0x3f2ff3e6,0x3f2d1469,0x3f2a2a80,0x3f13682a,0x3f0f8784,0x3f0b9a6b,0x3f07a136,0x3ee0924f,0x3ed6a399,0x3ecc9b8b,0x3ec27b55
.long 0x3e94a031,0x3e888e93,0x3e78cfcc,0x3e605c13,0x3e09cf86,0x3ddb7d37,0x3da3308c,0x3d55880e,0xbcc90ab0,0xbd621469,0xbdafb680,0xbdee3876,0xbe3b6ecf,0xbe5d4b1a,0xbe7ee6e1,0xbe901c2c
.long 0xbeac7cd4,0xbebe1d4a,0xbecf7bca,0xbee0924f,0xbef6e0cb,0xbf044889,0xbf0cead0,0xbf1553b7,0xbf1d7fd1,0xbf26050a,0xbf2e3bde,0xbf36206c,0xbf3b8f3b,0xbf436051,0xbf4ac77f,0xbf51c0c2
.long 0xbf54db31,0xbf5b941a,0xbf61c598,0xbf676bd8,0xbf68bf3c,0xbf6dfcf2,0xbf7294f8,0xbf76841b,0xbf76ba07,0xbf7a1e84,0xbf7cbfc9,0xbf7e9bc9,0xbf7e70b0,0xbf7fa6e3,0xbf7ffec4,0xbf7f7808
.long 0xbf7fb10f,0xbf7e70b0,0xbf7c3b28,0xbf791298,0xbf7a7302,0xbf76841b,0xbf718f57,0xbf6b99fb,0xbf6ed89e,0xbf6816a8,0xbf604621,0xbf577026,0xbf5d2d53,0xbf5389c7,0xbf48d8b3,0xbf3d27b8
.long 0xbf45e403,0xbf396842,0xbf2beb4a,0xbf1d7fd1,0xbf299415,0xbf1a6293,0xbf0a48ad,0xbef2bd43,0xbf08f59b,0xbeee9479,0xbec9b953,0xbea395c5,0xbec9b953,0xbea21887,0xbe72b651,0xbe1f917b
.long 0xbe78cfcc,0xbe22abb6,0xbd96a905,0x3c490e90,0xbdafb680,0x3b490fc6,0x3dbc3ac3,0x3e3857ec,0x3d96a905,0x3e28defc,0x3e827dc0,0x3eaf713a,0x3e6c9a7f,0x3ea5129f,0x3ed25a09,0x3efdbabb
.long 0x3f800000,0x3f800000,0x3f800000,0x3f800000,0x3f7c3b28,0x3f7c187a,0x3f7bf531,0x3f7bd14d,0x3f710908,0x3f708066,0x3f6ff573,0x3f6f6830,0x3f5ebe05,0x3f5d924d,0x3f5c61c7,0x3f5b2c79
.long 0x3f45e403,0x3f43e200,0x3f41d870,0x3f3fc767,0x3f273656,0x3f24381a,0x3f212ff9,0x3f1e1e22,0x3f039c3d,0x3eff17b2,0x3ef6e0cb,0x3eee9479,0x3eb8442a,0x3eadf73c,0x3ea395c5,0x3e9920fe
.long 0x3e47c5c2,0x3e2f10a2,0x3e164083,0x3dfab273,0x3cc90ab0,0xbb490fc6,0xbcfb49ba,0xbd6ea038,0xbe164083,0xbe354098,0xbe541501,0xbe72b651,0xbea09ae5,0xbeb0eacb,0xbec1071e,0xbed0eb2a
.long 0xbef15aea,0xbf00e7e4,0xbf08f59b,0xbf10d3cd,0xbf1d7fd1,0xbf256bcb,0xbf2d1469,0xbf34768f,0xbf3daef9,0xbf44e3f5,0xbf4bbbf8,0xbf5233c6,0xbf584853,0xbf5e5aa6,0xbf63f473,0xbf6912ae
.long 0xbf6c835e,0xbf710908,0xbf74fa0b,0xbf7853f8,0xbf79c79d,0xbf7c5d3a,0xbf7e4323,0xbf7f7808,0xbf7fb10f,0xbf7ffec4,0xbf7f84ab,0xbf7e4323,0xbf7e1324,0xbf7bd14d,0xbf78b47b,0xbf74bf62
.long 0xbf74fa0b,0xbf6ff573,0xbf6a09a7,0xbf633c5a,0xbf64aa59,0xbf5cc7d1,0xbf53fac3,0xbf4a4c87,0xbf4d9f02,0xbf42de29,0xbf373a23,0xbf2ac082,0xbf3085bb,0xbf2302d3,0xbf14b039,0xbf05a02c
.long 0xbf0e39da,0xbefc5d27,0xbedae880,0xbeb8442a,0xbecf7bca,0xbeab0201,0xbe8586ce,0xbe3e853e,0xbe78cfcc,0xbe28defc,0xbdafb680,0xbbc90f88,0xbd96a905,0x3c16cb58,0x3dbc3ac3,0x3e3228d4
.long 0x3dc8bd36,0x3e3b6ecf,0x3e888e93,0x3eb263ef,0x3e888e93,0x3eb3dca5,0x3eddbe79,0x3f02ef9f,0x3edae880,0x3f0242b1,0x3f15f6d9,0x3f286605,0x3f13682a,0x3f269de3,0x3f385216,0x3f485bca
.long 0x3f800000,0x3f800000,0x3f800000,0x3f800000,0x3f7baccd,0x3f7b87b2,0x3f7b61fc,0x3f7b3bab,0x3f6ed89e,0x3f6e46be,0x3f6db293,0x3f6d1c1d,0x3f59f26a,0x3f58b3a1,0x3f577026,0x3f5627fe
.long 0x3f3daef9,0x3f3b8f3b,0x3f396842,0x3f373a23,0x3f1b02c6,0x3f17de12,0x3f14b039,0x3f11796b,0x3ee63375,0x3eddbe79,0x3ed53641,0x3ecc9b8b,0x3e8e9a22,0x3e840270,0x3e72b651,0x3e5d4b1a
.long 0x3dc8bd36,0x3d96a905,0x3d48fb30,0x3cc90ab0,0xbdafb680,0xbde7fa9a,0xbe1008b7,0xbe2bf804,0xbe888e93,0xbe97a117,0xbea68f12,0xbeb554ec,0xbee0924f,0xbeeff7fb,0xbeff17b2,0xbf06f686
.long 0xbf187fc0,0xbf1ff6cb,0xbf273656,0xbf2e3bde,0xbf3b8f3b,0xbf425b89,0xbf48d8b3,0xbf4f0417,0xbf584853,0xbf5df6be,0xbf633c5a,0xbf6816a8,0xbf6db293,0xbf71d19f,0xbf756d97,0xbf788486
.long 0xbf7b14be,0xbf7d3aac,0xbf7ec46d,0xbf7fb10f,0xbf7ffb11,0xbf7fcbe2,0xbf7eea9d,0xbf7d57de,0xbf7c3b28,0xbf796e4e,0xbf75dec6,0xbf718f57,0xbf6ff573,0xbf6a5ad9,0xbf63f473,0xbf5cc7d1
.long 0xbf5b941a,0xbf531849,0xbf49d112,0xbf3fc767,0xbf3fc767,0xbf34768f,0xbf286605,0xbf1ba299,0xbf1d7fd1,0xbf0f8784,0xbf00e7e4,0xbee363fa,0xbeebcbbb,0xbecb2aae,0xbea986c4,0xbe870ada
.long 0xbe94a031,0xbe605c13,0xbe164083,0xbd96a905,0xbde1bc2e,0xbd0a342f,0x3d2fe007,0x3df475c0,0x3d96a905,0x3e1c76de,0x3e6c9a7f,0x3e9d9e78,0x3e827dc0,0x3eab0201,0x3ed25a09,0x3ef840c8
.long 0x3edae880,0x3f00e7e4,0x3f13682a,0x3f24d225,0x3f15f6d9,0x3f27ce61,0x3f385216,0x3f476085,0x3f396842,0x3f48d8b3,0x3f5695e5,0x3f628210,0x3f5695e5,0x3f62df7b,0x3f6d1c1d,0x3f75341d
.long 0x0,0x0,0x0,0x0,0x3dc8bd36,0x3dcefdb7,0x3dd53db9,0x3ddb7d37,0x3e47c5c2,0x3e4dee60,0x3e541501,0x3e5a3997,0x3e94a031,0x3e9920fe,0x3e9d9e78,0x3ea21887
.long 0x3ec3ef15,0x3ec9b953,0x3ecf7bca,0x3ed53641,0x3ef15aea,0x3ef840c8,0x3eff17b2,0x3f02ef9f,0x3f0e39da,0x3f121eb0,0x3f15f6d9,0x3f19c200,0x3f226799,0x3f269de3,0x3f2ac082,0x3f2ecef7
.long 0x3f3504f3,0x3f396842,0x3f3daef9,0x3f41d870,0x3f45e403,0x3f4a4c87,0x3f4e8d90,0x3f52a649,0x3f54db31,0x3f591e6a,0x3f5d2d53,0x3f6106f2,0x3f61c598,0x3f65b710,0x3f696591,0x3f6cd007
.long 0x3f6c835e,0x3f6ff573,0x3f731447,0x3f75dec6,0x3f74fa0b,0x3f77beb7,0x3f7a1e84,0x3f7c187a,0x3f7b14be,0x3f7cfe73,0x3f7e70b0,0x3f7f6ac7,0x3f7ec46d,0x3f7fa6e3,0x3f7ffec4,0x3f7fcbe2
.long 0x3f800000,0x3f7fb10f,0x3f7ec46d,0x3f7d3aac,0x3f7ec46d,0x3f7d1cdd,0x3f7ac516,0x3f77beb7,0x3f7b14be,0x3f77f110,0x3f740bdd,0x3f6f6830,0x3f74fa0b,0x3f703b37,0x3f6aab7b,0x3f644fac
.long 0x3f6c835e,0x3f660f88,0x3f5ebe05,0x3f5695e5,0x3f61c598,0x3f5988ad,0x3f5064af,0x3f466354,0x3f54db31,0x3f4ac77f,0x3f3fc767,0x3f33e7bc,0x3f45e403,0x3f39f2ac,0x3f2d1469,0x3f1f599f
.long 0x3f3504f3,0x3f273656,0x3f187fc0,0x3f08f59b,0x3f226799,0x3f12c39a,0x3f0242b1,0x3ee1fb6a,0x3f0e39da,0x3ef9a02d,0x3ed53641,0x3eaf713a,0x3ef15aea,0x3ecb2aae,0x3ea395c5,0x3e75c35a
.long 0x3ec3ef15,0x3e9aa086,0x3e605c13,0x3e09cf86,0x3e94a031,0x3e5101f1,0x3dee3876,0x3ce22a7a,0x3e47c5c2,0x3dd53db9,0x3c490e90,0xbda3308c,0x3dc8bd36,0x3b490fc6,0xbdbc3ac3,0xbe3e853e
.long 0x0,0x0,0x0,0x0,0x3de1bc2e,0x3de7fa9a,0x3dee3876,0x3df475c0,0x3e605c13,0x3e667c66,0x3e6c9a7f,0x3e72b651,0x3ea68f12,0x3eab0201,0x3eaf713a,0x3eb3dca5
.long 0x3edae880,0x3ee0924f,0x3ee63375,0x3eebcbbb,0x3f064b82,0x3f099f4e,0x3f0cead0,0x3f102dd5,0x3f1d7fd1,0x3f212ff9,0x3f24d225,0x3f286605,0x3f32c8c9,0x3f36ad7f,0x3f3a7ca4,0x3f3e35c5
.long 0x3f45e403,0x3f49d112,0x3f4d9f02,0x3f514d3d,0x3f5695e5,0x3f5a5ba0,0x3f5df6be,0x3f61668a,0x3f64aa59,0x3f6816a8,0x3f6b4b0c,0x3f6e46be,0x3f6ff573,0x3f72d4eb,0x3f756d97,0x3f77beb7
.long 0x3f7853f8,0x3f7a7302,0x3f7c3b28,0x3f7dabcc,0x3f7dabcc,0x3f7ed7d4,0x3f7f9c18,0x3f7ff84a,0x3f7fec43,0x3f7ff4e6,0x3f7f84ab,0x3f7e9bc9,0x3f7f0e58,0x3f7dc68c,0x3f7bf531,0x3f799b43
.long 0x3f7b14be,0x3f7853f8,0x3f74fa0b,0x3f710908,0x3f740bdd,0x3f6faf1b,0x3f6aab7b,0x3f650479,0x3f6a09a7,0x3f63f473,0x3f5d2d53,0x3f55b993,0x3f5d2d53,0x3f554aa4,0x3f4cae79,0x3f436051
.long 0x3f4d9f02,0x3f43e200,0x3f396842,0x3f2e3bde,0x3f3b8f3b,0x3f2ff3e6,0x3f239da9,0x3f16999f,0x3f273656,0x3f19c200,0x3f0b9a6b,0x3ef9a02d,0x3f10d3cd,0x3f019573,0x3ee363fa,0x3ec27b55
.long 0x3ef15aea,0x3ecf7bca,0x3eac7cd4,0x3e888e93,0x3ebe1d4a,0x3e9920fe,0x3e667c66,0x3e195be0,0x3e888e93,0x3e419b37,0x3de1bc2e,0x3cfb49ba,0x3e22abb6,0x3d9cecf9,0xbbc90f88,0xbdb5f8da
.long 0x3d48fb30,0xbd16c32c,0xbdfab273,0xbe541501,0xbd7b2b74,0xbe195be0,0xbe72b651,0xbea5129f,0xbe2f10a2,0xbe8586ce,0xbeb263ef,0xbeddbe79,0xbe8e9a22,0xbebca7af,0xbee900b7,0xbf099f4e
.long 0x0,0x0,0x0,0x0,0x3dfab273,0x3e007745,0x3e039502,0x3e06b26e,0x3e78cfcc,0x3e7ee6e1,0x3e827dc0,0x3e8586ce,0x3eb8442a,0x3ebca7af,0x3ec1071e,0x3ec5625c
.long 0x3ef15aea,0x3ef6e0cb,0x3efc5d27,0x3f00e7e4,0x3f13682a,0x3f16999f,0x3f19c200,0x3f1ce11f,0x3f2beb4a,0x3f2f61a5,0x3f32c8c9,0x3f36206c,0x3f41d870,0x3f456439,0x3f48d8b3,0x3f4c3578
.long 0x3f54db31,0x3f584853,0x3f5b941a,0x3f5ebe05,0x3f64aa59,0x3f67c187,0x3f6aab7b,0x3f6d67a1,0x3f710908,0x3f73913f,0x3f75dec6,0x3f77f110,0x3f79c79d,0x3f7b87b2,0x3f7cfe73,0x3f7e2b72
.long 0x3f7ec46d,0x3f7f84ab,0x3f7fec43,0x3f7ffb11,0x3f7fec43,0x3f7f7808,0x3f7e9bc9,0x3f7d57de,0x3f7d3aac,0x3f7b61fc,0x3f791298,0x3f764d97,0x3f76ba07,0x3f73530e,0x3f6f6830,0x3f6afb8c
.long 0x3f6c835e,0x3f676bd8,0x3f61c598,0x3f5b941a,0x3f5ebe05,0x3f57dc7f,0x3f5064af,0x3f485bca,0x3f4d9f02,0x3f44e3f5,0x3f3b8f3b,0x3f31a81d,0x3f396842,0x3f2ecef7,0x3f239da9,0x3f17de12
.long 0x3f226799,0x3f15f6d9,0x3f08f59b,0x3ef6e0cb,0x3f08f59b,0x3ef58035,0x3ed8106b,0x3eb9bb1e,0x3edae880,0x3ebb31a0,0x3e9aa086,0x3e72b651,0x3ea09ae5,0x3e7bdba4,0x3e354098,0x3ddb7d37
.long 0x3e47c5c2,0x3dfab273,0x3d48fb30,0xbcc90ab0,0x3d96a905,0xbb490fc6,0xbda3308c,0xbe1f917b,0xbd48fb30,0xbe039502,0xbe541501,0xbe919ddd,0xbe2f10a2,0xbe80f8c0,0xbea986c4,0xbed0eb2a
.long 0xbe94a031,0xbebe1d4a,0xbee63375,0xbf064b82,0xbecf7bca,0xbef840c8,0xbf0f8784,0xbf21cbfb,0xbf039c3d,0xbf173c07,0xbf299415,0xbf3a7ca4,0xbf1d7fd1,0xbf2ff3e6,0xbf40d0da,0xbf4fefa8
.long 0x0,0x0,0x0,0x0,0x3e09cf86,0x3e0cec4a,0x3e1008b7,0x3e1324ca,0x3e888e93,0x3e8b9507,0x3e8e9a22,0x3e919ddd,0x3ec9b953,0x3ece0bea,0x3ed25a09,0x3ed6a399
.long 0x3f039c3d,0x3f064b82,0x3f08f59b,0x3f0b9a6b,0x3f1ff6cb,0x3f2302d3,0x3f26050a,0x3f28fd41,0x3f396842,0x3f3ca003,0x3f3fc767,0x3f42de29,0x3f4f7a1f,0x3f52a649,0x3f55b993,0x3f58b3a1
.long 0x3f61c598,0x3f64aa59,0x3f676bd8,0x3f6a09a7,0x3f6ff573,0x3f725470,0x3f748422,0x3f76841b,0x3f79c79d,0x3f7b61fc,0x3f7cbfc9,0x3f7de0b1,0x3f7f0e58,0x3f7fa6e3,0x3f7ff4e6,0x3f7ff84a
.long 0x3f7fb10f,0x3f7f0e58,0x3f7e1324,0x3f7cbfc9,0x3f7baccd,0x3f799b43,0x3f772417,0x3f74484b,0x3f731447,0x3f6f6830,0x3f6b4b0c,0x3f66becc,0x3f660f88,0x3f60a6cf,0x3f5ac450,0x3f546b3b
.long 0x3f54db31,0x3f4d9f02,0x3f45e403,0x3f3daef9,0x3f3fc767,0x3f36ad7f,0x3f2d1469,0x3f2302d3,0x3f273656,0x3f1c420c,0x3f10d3cd,0x3f04f484,0x3f0b9a6b,0x3efdbabb,0x3ee363fa,0x3ec8477c
.long 0x3edae880,0x3ebe1d4a,0x3ea09ae5,0x3e827dc0,0x3e9aa086,0x3e75c35a,0x3e354098,0x3de7fa9a,0x3e2f10a2,0x3dd53db9,0x3d16c32c,0xbcfb49ba,0x3d16c32c,0xbd0a342f,0xbdd53db9,0xbe3228d4
.long 0xbdc8bd36,0xbe2f10a2,0xbe78cfcc,0xbea09ae5,0xbe6c9a7f,0xbe9c1faf,0xbec1071e,0xbee4cbfe,0xbeb8442a,0xbeddbe79,0xbf00e7e4,0xbf121eb0,0xbef6e0cb,0xbf0d9281,0xbf1ebc12,0xbf2ecef7
.long 0xbf187fc0,0xbf299415,0xbf396842,0xbf47de65,0xbf32c8c9,0xbf425b89,0xbf5064af,0xbf5cc7d1,0xbf49d112,0xbf577026,0xbf633c5a,0xbf6d1c1d,0xbf5d2d53,0xbf686b39,0xbf718f57,0xbf788486
.long 0x0,0x0,0x0,0x0,0x3e164083,0x3e195be0,0x3e1c76de,0x3e1f917b,0x3e94a031,0x3e97a117,0x3e9aa086,0x3e9d9e78,0x3edae880,0x3edf28a9,0x3ee363fa,0x3ee79a5d
.long 0x3f0e39da,0x3f10d3cd,0x3f13682a,0x3f15f6d9,0x3f2beb4a,0x3f2ecef7,0x3f31a81d,0x3f34768f,0x3f45e403,0x3f48d8b3,0x3f4bbbf8,0x3f4e8d90,0x3f5b941a,0x3f5e5aa6,0x3f6106f2,0x3f6398ac
.long 0x3f6c835e,0x3f6ed89e,0x3f710908,0x3f731447,0x3f7853f8,0x3f79f35e,0x3f7b61fc,0x3f7c9f8a,0x3f7ec46d,0x3f7f6ac7,0x3f7fd397,0x3f7ffec4,0x3f7fb10f,0x3f7f1f49,0x3f7e4323,0x3f7d1cdd
.long 0x3f7b14be,0x3f791298,0x3f76ba07,0x3f740bdd,0x3f710908,0x3f6d67a1,0x3f696591,0x3f650479,0x3f61c598,0x3f5c61c7,0x3f5695e5,0x3f5064af,0x3f4d9f02,0x3f466354,0x3f3ebc1b,0x3f36ad7f
.long 0x3f3504f3,0x3f2beb4a,0x3f226799,0x3f187fc0,0x3f187fc0,0x3f0d9281,0x3f0242b1,0x3eed3063,0x3ef15aea,0x3ed8106b,0x3ebe1d4a,0x3ea395c5,0x3eac7cd4,0x3e901c2c,0x3e667c66,0x3e2bf804
.long 0x3e47c5c2,0x3e09cf86,0x3d96a905,0x3c490e90,0x3d48fb30,0xbc7b514b,0xbda3308c,0xbe1324ca,0xbdc8bd36,0xbe28defc,0xbe6c9a7f,0xbe97a117,0xbe78cfcc,0xbe9f1cdf,0xbec1071e,0xbee1fb6a
.long 0xbec3ef15,0xbee63375,0xbf039c3d,0xbf13682a,0xbf039c3d,0xbf140c5f,0xbf239da9,0xbf3238aa,0xbf226799,0xbf31a81d,0xbf3fc767,0xbf4cae79,0xbf3daef9,0xbf4b41fa,0xbf577026,0xbf62241a
.long 0xbf54db31,0xbf604621,0xbf6a09a7,0xbf721352,0xbf676bd8,0xbf703b37,0xbf772417,0xbf7c187a,0xbf74fa0b,0xbf7ac516,0xbf7e70b0,0xbf7ff4e6,0xbf7d3aac,0xbf7fa6e3,0xbf7fc38f,0xbf7d906e
.long 0x0,0x0,0x0,0x0,0x3e22abb6,0x3e25c58c,0x3e28defc,0x3e2bf804,0x3ea09ae5,0x3ea395c5,0x3ea68f12,0x3ea986c4,0x3eebcbbb,0x3eeff7fb,0x3ef41f07,0x3ef840c8
.long 0x3f187fc0,0x3f1b02c6,0x3f1d7fd1,0x3f1ff6cb,0x3f373a23,0x3f39f2ac,0x3f3ca003,0x3f3f41fc,0x3f514d3d,0x3f53fac3,0x3f5695e5,0x3f591e6a,0x3f660f88,0x3f686b39,0x3f6aab7b,0x3f6cd007
.long 0x3f74fa0b,0x3f76ba07,0x3f7853f8,0x3f79c79d,0x3f7dabcc,0x3f7e868b,0x3f7f2f9d,0x3f7fa6e3,0x3f7fec43,0x3f7f9c18,0x3f7f0e58,0x3f7e4323,0x3f7baccd,0x3f79f35e,0x3f77f110,0x3f75a67b
.long 0x3f710908,0x3f6db293,0x3f6a09a7,0x3f660f88,0x3f604621,0x3f5b2c79,0x3f55b993,0x3f4fefa8,0x3f49d112,0x3f42de29,0x3f3b8f3b,0x3f33e7bc,0x3f2e3bde,0x3f256bcb,0x3f1c420c,0x3f12c39a
.long 0x3f0e39da,0x3f039c3d,0x3ef15aea,0x3edae880,0x3ed53641,0x3ebca7af,0x3ea395c5,0x3e8a11f7,0x3e888e93,0x3e5a3997,0x3e22abb6,0x3dd53db9,0x3de1bc2e,0x3d55880e,0xbbc90f88,0xbd83db0a
.long 0xbd48fb30,0xbde1bc2e,0xbe2f10a2,0xbe6c9a7f,0xbe541501,0xbe8a11f7,0xbea986c4,0xbec8477c,0xbeb8442a,0xbed8106b,0xbef6e0cb,0xbf0a48ad,0xbf00e7e4,0xbf102dd5,0xbf1ebc12,0xbf2c800f
.long 0xbf226799,0xbf3085bb,0xbf3daef9,0xbf49d112,0xbf3fc767,0xbf4c3578,0xbf577026,0xbf61668a,0xbf584853,0xbf628210,0xbf6b4b0c,0xbf7294f8,0xbf6b4b0c,0xbf72d4eb,0xbf78b47b,0xbf7cdf6c
.long 0xbf7853f8,0xbf7cbfc9,0xbf7f4e6d,0xbf7ffb11,0xbf7f0e58,0xbf7fffb1,0xbf7eea9d,0xbf7bd14d,0xbf7f4e6d,0xbf7c7eb0,0xbf778bc5,0xbf708066,0xbf791298,0xbf725470,0xbf696591,0xbf5e5aa6
.long 0x0,0x0,0x0,0x0,0x3e2f10a2,0x3e3228d4,0x3e354098,0x3e3857ec,0x3eac7cd4,0x3eaf713a,0x3eb263ef,0x3eb554ec,0x3efc5d27,0x3f003a06,0x3f0242b1,0x3f044889
.long 0x3f226799,0x3f24d225,0x3f273656,0x3f299415,0x3f41d870,0x3f446337,0x3f46e22a,0x3f495521,0x3f5b941a,0x3f5df6be,0x3f604621,0x3f628210,0x3f6ed89e,0x3f70c501,0x3f7294f8,0x3f74484b
.long 0x3f7b14be,0x3f7c3b28,0x3f7d3aac,0x3f7e1324,0x3f7fec43,0x3f7fffb1,0x3f7fe129,0x3f7f90b1,0x3f7d3aac,0x3f7bf531,0x3f7a7302,0x3f78b47b,0x3f731447,0x3f703b37,0x3f6d1c1d,0x3f69b7e4
.long 0x3f61c598,0x3f5d2d53,0x3f584853,0x3f531849,0x3f49d112,0x3f436051,0x3f3ca003,0x3f3592e7,0x3f2beb4a,0x3f239da9,0x3f1b02c6,0x3f121eb0,0x3f08f59b,0x3efdbabb,0x3ee900b7,0x3ed3c867
.long 0x3ec3ef15,0x3eac7cd4,0x3e94a031,0x3e78cfcc,0x3e605c13,0x3e2bf804,0x3dee3876,0x3d83db0a,0x3d48fb30,0xbbc90f88,0xbd7b2b74,0xbdee3876,0xbdfab273,0xbe3857ec,0xbe72b651,0xbe9620d2
.long 0xbe94a031,0xbeb263ef,0xbecf7bca,0xbeebcbbb,0xbee63375,0xbf019573,0xbf0f8784,0xbf1ce11f,0xbf187fc0,0xbf26050a,0xbf32c8c9,0xbf3ebc1b,0xbf396842,0xbf456439,0xbf5064af,0xbf5a5ba0
.long 0xbf54db31,0xbf5ebe05,0xbf676bd8,0xbf6ed89e,0xbf6a09a7,0xbf714c7a,0xbf772417,0xbf7b87b2,0xbf7853f8,0xbf7c7eb0,0xbf7f0e58,0xbf7ffec4,0xbf7f4e6d,0xbf7ffd39,0xbf7eea9d,0xbf7c187a
.long 0xbf7ec46d,0xbf7baccd,0xbf76ba07,0xbf6ff573,0xbf76ba07,0xbf6faf1b,0xbf66becc,0xbf5bfb34,0xbf676bd8,0xbf5c61c7,0xbf4f7a1f,0xbf40d0da,0xbf514d3d,0xbf425b89,0xbf31a81d,0xbf1f599f
.long 0x0,0x0,0x0,0x0,0x3e3b6ecf,0x3e3e853e,0x3e419b37,0x3e44b0b9,0x3eb8442a,0x3ebb31a0,0x3ebe1d4a,0x3ec1071e,0x3f064b82,0x3f084b92,0x3f0a48ad,0x3f0c42c9
.long 0x3f2beb4a,0x3f2e3bde,0x3f3085bb,0x3f32c8c9,0x3f4bbbf8,0x3f4e1689,0x3f5064af,0x3f52a649,0x3f64aa59,0x3f66becc,0x3f68bf3c,0x3f6aab7b,0x3f75dec6,0x3f77583a,0x3f78b47b,0x3f79f35e
.long 0x3f7ec46d,0x3f7f4e6d,0x3f7fb10f,0x3f7fec43,0x3f7f0e58,0x3f7e5a38,0x3f7d7474,0x3f7c5d3a,0x3f76ba07,0x3f748422,0x3f721352,0x3f6f6830,0x3f660f88,0x3f62241a,0x3f5df6be,0x3f5988ad
.long 0x3f4d9f02,0x3f47de65,0x3f41d870,0x3f3b8f3b,0x3f2e3bde,0x3f269de3,0x3f1ebc12,0x3f16999f,0x3f08f59b,0x3eff17b2,0x3eebcbbb,0x3ed8106b,0x3ebe1d4a,0x3ea80b1f,0x3e919ddd,0x3e75c35a
.long 0x3e47c5c2,0x3e164083,0x3dc8bd36,0x3d48fb30,0x3c490e90,0xbd2351cb,0xbdbc3ac3,0xbe1324ca,0xbe2f10a2,0xbe667c66,0xbe8e9a22,0xbea986c4,0xbeb263ef,0xbece0bea,0xbee900b7,0xbf019573
.long 0xbf039c3d,0xbf10d3cd,0xbf1d7fd1,0xbf299415,0xbf299415,0xbf3592e7,0xbf40d0da,0xbf4b41fa,0xbf49d112,0xbf53fac3,0xbf5d2d53,0xbf655e0b,0xbf633c5a,0xbf6afb8c,0xbf718f57,0xbf76ef5b
.long 0xbf74fa0b,0xbf79c79d,0xbf7d3aac,0xbf7f4e6d,0xbf7e70b0,0xbf7fdaaf,0xbf7fc38f,0xbf7e2b72,0xbf7f4e6d,0xbf7cfe73,0xbf791298,0xbf73913f,0xbf778bc5,0xbf714c7a,0xbf696591,0xbf5fe4e9
.long 0xbf676bd8,0xbf5d2d53,0xbf514d3d,0xbf43e200,0xbf4f7a1f,0xbf4154e1,0xbf31a81d,0xbf209393,0xbf3085bb,0xbf1ebc12,0xbf0b9a6b,0xbeee9479,0xbf0b9a6b,0xbeed3063,0xbec1071e,0xbe931f35
.long 0x3f800000,0x3f7ec46d,0x3f7b14be,0x3f74fa0b,0x3f800000,0x3f7eb069,0x3f7ac516,0x3f74484b,0x3f800000,0x3f7e9bc9,0x3f7a7302,0x3f73913f,0x3f800000,0x3f7e868b,0x3f7a1e84,0x3f72d4eb
.long 0x3f800000,0x3f7e70b0,0x3f79c79d,0x3f721352,0x3f800000,0x3f7e5a38,0x3f796e4e,0x3f714c7a,0x3f800000,0x3f7e4323,0x3f791298,0x3f708066,0x3f800000,0x3f7e2b72,0x3f78b47b,0x3f6faf1b
.long 0x3f800000,0x3f7e1324,0x3f7853f8,0x3f6ed89e,0x3f800000,0x3f7dfa38,0x3f77f110,0x3f6dfcf2,0x3f800000,0x3f7de0b1,0x3f778bc5,0x3f6d1c1d,0x3f800000,0x3f7dc68c,0x3f772417,0x3f6c3624
.long 0x3f800000,0x3f7dabcc,0x3f76ba07,0x3f6b4b0c,0x3f800000,0x3f7d906e,0x3f764d97,0x3f6a5ad9,0x3f800000,0x3f7d7474,0x3f75dec6,0x3f696591,0x3f800000,0x3f7d57de,0x3f756d97,0x3f686b39
.long 0x3f800000,0x3f7d3aac,0x3f74fa0b,0x3f676bd8,0x3f800000,0x3f7d1cdd,0x3f748422,0x3f666771,0x3f800000,0x3f7cfe73,0x3f740bdd,0x3f655e0b,0x3f800000,0x3f7cdf6c,0x3f73913f,0x3f644fac
.long 0x3f800000,0x3f7cbfc9,0x3f731447,0x3f633c5a,0x3f800000,0x3f7c9f8a,0x3f7294f8,0x3f62241a,0x3f800000,0x3f7c7eb0,0x3f721352,0x3f6106f2,0x3f800000,0x3f7c5d3a,0x3f718f57,0x3f5fe4e9
.long 0x3f800000,0x3f7c3b28,0x3f710908,0x3f5ebe05,0x3f800000,0x3f7c187a,0x3f708066,0x3f5d924d,0x3f800000,0x3f7bf531,0x3f6ff573,0x3f5c61c7,0x3f800000,0x3f7bd14d,0x3f6f6830,0x3f5b2c79
.long 0x3f800000,0x3f7baccd,0x3f6ed89e,0x3f59f26a,0x3f800000,0x3f7b87b2,0x3f6e46be,0x3f58b3a1,0x3f800000,0x3f7b61fc,0x3f6db293,0x3f577026,0x3f800000,0x3f7b3bab,0x3f6d1c1d,0x3f5627fe
.long 0x3f6c835e,0x3f61c598,0x3f54db31,0x3f45e403,0x3f6b4b0c,0x3f5fe4e9,0x3f5233c6,0x3f425b89,0x3f6a09a7,0x3f5df6be,0x3f4f7a1f,0x3f3ebc1b,0x3f68bf3c,0x3f5bfb34,0x3f4cae79,0x3f3b0629
.long 0x3f676bd8,0x3f59f26a,0x3f49d112,0x3f373a23,0x3f660f88,0x3f57dc7f,0x3f46e22a,0x3f33587a,0x3f64aa59,0x3f55b993,0x3f43e200,0x3f2f61a5,0x3f633c5a,0x3f5389c7,0x3f40d0da,0x3f2b561b
.long 0x3f61c598,0x3f514d3d,0x3f3daef9,0x3f273656,0x3f604621,0x3f4f0417,0x3f3a7ca4,0x3f2302d3,0x3f5ebe05,0x3f4cae79,0x3f373a23,0x3f1ebc12,0x3f5d2d53,0x3f4a4c87,0x3f33e7bc,0x3f1a6293
.long 0x3f5b941a,0x3f47de65,0x3f3085bb,0x3f15f6d9,0x3f59f26a,0x3f456439,0x3f2d1469,0x3f11796b,0x3f584853,0x3f42de29,0x3f299415,0x3f0cead0,0x3f5695e5,0x3f404c5c,0x3f26050a,0x3f084b92
.long 0x3f54db31,0x3f3daef9,0x3f226799,0x3f039c3d,0x3f531849,0x3f3b0629,0x3f1ebc12,0x3efdbabb,0x3f514d3d,0x3f385216,0x3f1b02c6,0x3ef41f07,0x3f4f7a1f,0x3f3592e7,0x3f173c07,0x3eea6681
.long 0x3f4d9f02,0x3f32c8c9,0x3f13682a,0x3ee0924f,0x3f4bbbf8,0x3f2ff3e6,0x3f0f8784,0x3ed6a399,0x3f49d112,0x3f2d1469,0x3f0b9a6b,0x3ecc9b8b,0x3f47de65,0x3f2a2a80,0x3f07a136,0x3ec27b55
.long 0x3f45e403,0x3f273656,0x3f039c3d,0x3eb8442a,0x3f43e200,0x3f24381a,0x3eff17b2,0x3eadf73c,0x3f41d870,0x3f212ff9,0x3ef6e0cb,0x3ea395c5,0x3f3fc767,0x3f1e1e22,0x3eee9479,0x3e9920fe
.long 0x3f3daef9,0x3f1b02c6,0x3ee63375,0x3e8e9a22,0x3f3b8f3b,0x3f17de12,0x3eddbe79,0x3e840270,0x3f396842,0x3f14b039,0x3ed53641,0x3e72b651,0x3f373a23,0x3f11796b,0x3ecc9b8b,0x3e5d4b1a
.long 0x3f3504f3,0x3f226799,0x3f0e39da,0x3ef15aea,0x3f3085bb,0x3f1ce11f,0x3f07a136,0x3ee1fb6a,0x3f2beb4a,0x3f173c07,0x3f00e7e4,0x3ed25a09,0x3f273656,0x3f11796b,0x3ef41f07,0x3ec27b55
.long 0x3f226799,0x3f0b9a6b,0x3ee63375,0x3eb263ef,0x3f1d7fd1,0x3f05a02c,0x3ed8106b,0x3ea21887,0x3f187fc0,0x3eff17b2,0x3ec9b953,0x3e919ddd,0x3f13682a,0x3ef2bd43,0x3ebb31a0,0x3e80f8c0
.long 0x3f0e39da,0x3ee63375,0x3eac7cd4,0x3e605c13,0x3f08f59b,0x3ed97cb9,0x3e9d9e78,0x3e3e853e,0x3f039c3d,0x3ecc9b8b,0x3e8e9a22,0x3e1c76de,0x3efc5d27,0x3ebf926f,0x3e7ee6e1,0x3df475c0
.long 0x3ef15aea,0x3eb263ef,0x3e605c13,0x3dafb680,0x3ee63375,0x3ea5129f,0x3e419b37,0x3d55880e,0x3edae880,0x3e97a117,0x3e22abb6,0x3c96c9b6,0x3ecf7bca,0x3e8a11f7,0x3e039502,0xbc7b514b
.long 0x3ec3ef15,0x3e78cfcc,0x3dc8bd36,0xbd48fb30,0x3eb8442a,0x3e5d4b1a,0x3d8a200a,0xbda973ba,0x3eac7cd4,0x3e419b37,0x3d16c32c,0xbdee3876,0x3ea09ae5,0x3e25c58c,0x3bc90f88,0xbe195be0
.long 0x3e94a031,0x3e09cf86,0xbcc90ab0,0xbe3b6ecf,0x3e888e93,0x3ddb7d37,0xbd621469,0xbe5d4b1a,0x3e78cfcc,0x3da3308c,0xbdafb680,0xbe7ee6e1,0x3e605c13,0x3d55880e,0xbdee3876,0xbe901c2c
.long 0x3e47c5c2,0x3cc90ab0,0xbe164083,0xbea09ae5,0x3e2f10a2,0xbb490fc6,0xbe354098,0xbeb0eacb,0x3e164083,0xbcfb49ba,0xbe541501,0xbec1071e,0x3dfab273,0xbd6ea038,0xbe72b651,0xbed0eb2a
.long 0x3dc8bd36,0xbdafb680,0xbe888e93,0xbee0924f,0x3d96a905,0xbde7fa9a,0xbe97a117,0xbeeff7fb,0x3d48fb30,0xbe1008b7,0xbea68f12,0xbeff17b2,0x3cc90ab0,0xbe2bf804,0xbeb554ec,0xbf06f686
.long 0x3ec3ef15,0x3e94a031,0x3e47c5c2,0x3dc8bd36,0x3eb263ef,0x3e80f8c0,0x3e1c76de,0x3d55880e,0x3ea09ae5,0x3e5a3997,0x3de1bc2e,0x3bc90f88,0x3e8e9a22,0x3e3228d4,0x3d8a200a,0xbd2351cb
.long 0x3e78cfcc,0x3e09cf86,0x3cc90ab0,0xbdafb680,0x3e541501,0x3dc27c39,0xbc96c9b6,0xbe06b26e,0x3e2f10a2,0x3d621469,0xbd7b2b74,0xbe354098,0x3e09cf86,0x3c7b514b,0xbdd53db9,0xbe636c83
.long 0x3dc8bd36,0xbcc90ab0,0xbe164083,0xbe888e93,0x3d7b2b74,0xbd83db0a,0xbe419b37,0xbe9f1cdf,0x3cc90ab0,0xbdd53db9,0xbe6c9a7f,0xbeb554ec,0xbc490e90,0xbe1324ca,0xbe8b9507,0xbecb2aae
.long 0xbd48fb30,0xbe3b6ecf,0xbea09ae5,0xbee0924f,0xbdafb680,0xbe636c83,0xbeb554ec,0xbef58035,0xbdfab273,0xbe8586ce,0xbec9b953,0xbf04f484,0xbe22abb6,0xbe9920fe,0xbeddbe79,0xbf0ee0db
.long 0xbe47c5c2,0xbeac7cd4,0xbef15aea,0xbf187fc0,0xbe6c9a7f,0xbebf926f,0xbf0242b1,0xbf21cbfb,0xbe888e93,0xbed25a09,0xbf0b9a6b,0xbf2ac082,0xbe9aa086,0xbee4cbfe,0xbf14b039,0xbf33587a
.long 0xbeac7cd4,0xbef6e0cb,0xbf1d7fd1,0xbf3b8f3b,0xbebe1d4a,0xbf044889,0xbf26050a,0xbf436051,0xbecf7bca,0xbf0cead0,0xbf2e3bde,0xbf4ac77f,0xbee0924f,0xbf1553b7,0xbf36206c,0xbf51c0c2
.long 0xbef15aea,0xbf1d7fd1,0xbf3daef9,0xbf584853,0xbf00e7e4,0xbf256bcb,0xbf44e3f5,0xbf5e5aa6,0xbf08f59b,0xbf2d1469,0xbf4bbbf8,0xbf63f473,0xbf10d3cd,0xbf34768f,0xbf5233c6,0xbf6912ae
.long 0xbf187fc0,0xbf3b8f3b,0xbf584853,0xbf6db293,0xbf1ff6cb,0xbf425b89,0xbf5df6be,0xbf71d19f,0xbf273656,0xbf48d8b3,0xbf633c5a,0xbf756d97,0xbf2e3bde,0xbf4f0417,0xbf6816a8,0xbf788486
.long 0x248d3132,0xbdc8bd36,0xbe47c5c2,0xbe94a031,0xbd48fb30,0xbe195be0,0xbe7ee6e1,0xbeb0eacb,0xbdc8bd36,0xbe4dee60,0xbe9aa086,0xbecc9b8b,0xbe164083,0xbe80f8c0,0xbeb554ec,0xbee79a5d
.long 0xbe47c5c2,0xbe9aa086,0xbecf7bca,0xbf00e7e4,0xbe78cfcc,0xbeb3dca5,0xbee900b7,0xbf0d9281,0xbe94a031,0xbecc9b8b,0xbf00e7e4,0xbf19c200,0xbeac7cd4,0xbee4cbfe,0xbf0cead0,0xbf256bcb
.long 0xbec3ef15,0xbefc5d27,0xbf187fc0,0xbf3085bb,0xbedae880,0xbf099f4e,0xbf239da9,0xbf3b0629,0xbef15aea,0xbf14b039,0xbf2e3bde,0xbf44e3f5,0xbf039c3d,0xbf1f599f,0xbf385216,0xbf4e1689
.long 0xbf0e39da,0xbf299415,0xbf41d870,0xbf5695e5,0xbf187fc0,0xbf33587a,0xbf4ac77f,0xbf5e5aa6,0xbf226799,0xbf3ca003,0xbf531849,0xbf655e0b,0xbf2beb4a,0xbf456439,0xbf5ac450,0xbf6b99fb
.long 0xbf3504f3,0xbf4d9f02,0xbf61c598,0xbf710908,0xbf3daef9,0xbf554aa4,0xbf6816a8,0xbf75a67b,0xbf45e403,0xbf5c61c7,0xbf6db293,0xbf796e4e,0xbf4d9f02,0xbf62df7b,0xbf7294f8,0xbf7c5d3a
.long 0xbf54db31,0xbf68bf3c,0xbf76ba07,0xbf7e70b0,0xbf5b941a,0xbf6dfcf2,0xbf7a1e84,0xbf7fa6e3,0xbf61c598,0xbf7294f8,0xbf7cbfc9,0xbf7ffec4,0xbf676bd8,0xbf76841b,0xbf7e9bc9,0xbf7f7808
.long 0xbf6c835e,0xbf79c79d,0xbf7fb10f,0xbf7e1324,0xbf710908,0xbf7c5d3a,0xbf7ffec4,0xbf7bd14d,0xbf74fa0b,0xbf7e4323,0xbf7f84ab,0xbf78b47b,0xbf7853f8,0xbf7f7808,0xbf7e4323,0xbf74bf62
.long 0xbf7b14be,0xbf7ffb11,0xbf7c3b28,0xbf6ff573,0xbf7d3aac,0xbf7fcbe2,0xbf796e4e,0xbf6a5ad9,0xbf7ec46d,0xbf7eea9d,0xbf75dec6,0xbf63f473,0xbf7fb10f,0xbf7d57de,0xbf718f57,0xbf5cc7d1
.long 0xbec3ef15,0xbef15aea,0xbf0e39da,0xbf226799,0xbee0924f,0xbf06f686,0xbf1c420c,0xbf2ff3e6,0xbefc5d27,0xbf14b039,0xbf299415,0xbf3ca003,0xbf0b9a6b,0xbf21cbfb,0xbf36206c,0xbf485bca
.long 0xbf187fc0,0xbf2e3bde,0xbf41d870,0xbf531849,0xbf24d225,0xbf39f2ac,0xbf4cae79,0xbf5cc7d1,0xbf3085bb,0xbf44e3f5,0xbf5695e5,0xbf655e0b,0xbf3b8f3b,0xbf4f0417,0xbf5f8327,0xbf6cd007
.long 0xbf45e403,0xbf584853,0xbf676bd8,0xbf731447,0xbf4f7a1f,0xbf60a6cf,0xbf6e46be,0xbf7822d1,0xbf584853,0xbf6816a8,0xbf740bdd,0xbf7bf531,0xbf604621,0xbf6e8ff8,0xbf78b47b,0xbf7e868b
.long 0xbf676bd8,0xbf740bdd,0xbf7c3b28,0xbf7fd397,0xbf6db293,0xbf788486,0xbf7e9bc9,0xbf7fdaaf,0xbf731447,0xbf7bf531,0xbf7fd397,0xbf7e9bc9,0xbf778bc5,0xbf7e5a38,0xbf7fe129,0xbf7c187a
.long 0xbf7b14be,0xbf7fb10f,0xbf7ec46d,0xbf7853f8,0xbf7dabcc,0xbf7ff84a,0xbf7c7eb0,0xbf73530e,0xbf7f4e6d,0xbf7f2f9d,0xbf791298,0xbf6d1c1d,0xbf7ffb11,0xbf7d57de,0xbf748422,0xbf65b710
.long 0xbf7fb10f,0xbf7a7302,0xbf6ed89e,0xbf5d2d53,0xbf7e70b0,0xbf76841b,0xbf6816a8,0xbf5389c7,0xbf7c3b28,0xbf718f57,0xbf604621,0xbf48d8b3,0xbf791298,0xbf6b99fb,0xbf577026,0xbf3d27b8
.long 0xbf74fa0b,0xbf64aa59,0xbf4d9f02,0xbf3085bb,0xbf6ff573,0xbf5cc7d1,0xbf42de29,0xbf2302d3,0xbf6a09a7,0xbf53fac3,0xbf373a23,0xbf14b039,0xbf633c5a,0xbf4a4c87,0xbf2ac082,0xbf05a02c
.long 0xbf5b941a,0xbf3fc767,0xbf1d7fd1,0xbeebcbbb,0xbf531849,0xbf34768f,0xbf0f8784,0xbecb2aae,0xbf49d112,0xbf286605,0xbf00e7e4,0xbea986c4,0xbf3fc767,0xbf1ba299,0xbee363fa,0xbe870ada
.long 0xbf3504f3,0xbf45e403,0xbf54db31,0xbf61c598,0xbf41d870,0xbf51c0c2,0xbf5f8327,0xbf6afb8c,0xbf4d9f02,0xbf5c61c7,0xbf68bf3c,0xbf7294f8,0xbf584853,0xbf65b710,0xbf708066,0xbf788486
.long 0xbf61c598,0xbf6db293,0xbf76ba07,0xbf7cbfc9,0xbf6a09a7,0xbf74484b,0xbf7b61fc,0xbf7f3f54,0xbf710908,0xbf796e4e,0xbf7e70b0,0xbf7ffec4,0xbf76ba07,0xbf7d1cdd,0xbf7fe129,0xbf7efcc9
.long 0xbf7b14be,0xbf7f4e6d,0xbf7fb10f,0xbf7c3b28,0xbf7e1324,0xbf7fffb1,0xbf7de0b1,0xbf77beb7,0xbf7fb10f,0xbf7f2f9d,0xbf7a7302,0xbf718f57,0xbf7fec43,0xbf7cdf6c,0xbf756d97,0xbf69b7e4
.long 0xbf7ec46d,0xbf791298,0xbf6ed89e,0xbf604621,0xbf7c3b28,0xbf73ced9,0xbf66becc,0xbf554aa4,0xbf7853f8,0xbf6d1c1d,0xbf5d2d53,0xbf48d8b3,0xbf731447,0xbf650479,0xbf5233c6,0xbf3b0629
.long 0xbf6c835e,0xbf5b941a,0xbf45e403,0xbf2beb4a,0xbf64aa59,0xbf50d937,0xbf385216,0xbf1ba299,0xbf5b941a,0xbf44e3f5,0xbf299415,0xbf0a48ad,0xbf514d3d,0xbf37c655,0xbf19c200,0xbeeff7fb
.long 0xbf45e403,0xbf299415,0xbf08f59b,0xbec9b953,0xbf396842,0xbf1a6293,0xbeee9479,0xbea21887,0xbf2beb4a,0xbf0a48ad,0xbec9b953,0xbe72b651,0xbf1d7fd1,0xbef2bd43,0xbea395c5,0xbe1f917b
.long 0xbf0e39da,0xbecf7bca,0xbe78cfcc,0xbd96a905,0xbefc5d27,0xbeab0201,0xbe28defc,0x3c16cb58,0xbedae880,0xbe8586ce,0xbdafb680,0x3dbc3ac3,0xbeb8442a,0xbe3e853e,0xbbc90f88,0x3e3228d4
.long 0xbe94a031,0xbde1bc2e,0x3d96a905,0x3e827dc0,0xbe605c13,0xbd0a342f,0x3e1c76de,0x3eab0201,0xbe164083,0x3d2fe007,0x3e6c9a7f,0x3ed25a09,0xbd96a905,0x3df475c0,0x3e9d9e78,0x3ef840c8
.long 0xbf6c835e,0xbf74fa0b,0xbf7b14be,0xbf7ec46d,0xbf740bdd,0xbf7a9c59,0xbf7e9bc9,0xbf7fffb1,0xbf79c79d,0xbf7e4323,0xbf7ffb11,0xbf7eea9d,0xbf7dabcc,0xbf7fe705,0xbf7f2f9d,0xbf7b87b2
.long 0xbf7fb10f,0xbf7f84ab,0xbf7c3b28,0xbf75dec6,0xbf7fd397,0xbf7d1cdd,0xbf772417,0xbf6dfcf2,0xbf7e1324,0xbf78b47b,0xbf6ff573,0xbf63f473,0xbf7a7302,0xbf725470,0xbf66becc,0xbf57dc7f
.long 0xbf74fa0b,0xbf6a09a7,0xbf5b941a,0xbf49d112,0xbf6db293,0xbf5fe4e9,0xbf4e8d90,0xbf39f2ac,0xbf64aa59,0xbf53fac3,0xbf3fc767,0xbf286605,0xbf59f26a,0xbf466354,0xbf2f61a5,0xbf1553b7
.long 0xbf4d9f02,0xbf373a23,0xbf1d7fd1,0xbf00e7e4,0xbf3fc767,0xbf269de3,0xbf0a48ad,0xbed6a399,0xbf3085bb,0xbf14b039,0xbeebcbbb,0xbea986c4,0xbf1ff6cb,0xbf019573,0xbec1071e,0xbe75c35a
.long 0xbf0e39da,0xbedae880,0xbe94a031,0xbe164083,0xbef6e0cb,0xbeb0eacb,0xbe4dee60,0xbd55880e,0xbecf7bca,0xbe8586ce,0xbde1bc2e,0x3d2fe007,0xbea68f12,0xbe3228d4,0xbc96c9b6,0x3e0cec4a
.long 0xbe78cfcc,0xbdafb680,0x3d96a905,0x3e6c9a7f,0xbe22abb6,0x3b490fc6,0x3e28defc,0x3ea5129f,0xbd96a905,0x3dbc3ac3,0x3e827dc0,0x3ed25a09,0x3c490e90,0x3e3857ec,0x3eaf713a,0x3efdbabb
.long 0x3dc8bd36,0x3e888e93,0x3edae880,0x3f13682a,0x3e3b6ecf,0x3eb3dca5,0x3f0242b1,0x3f269de3,0x3e888e93,0x3eddbe79,0x3f15f6d9,0x3f385216,0x3eb263ef,0x3f02ef9f,0x3f286605,0x3f485bca
.long 0x3edae880,0x3f15f6d9,0x3f396842,0x3f5695e5,0x3f00e7e4,0x3f27ce61,0x3f48d8b3,0x3f62df7b,0x3f13682a,0x3f385216,0x3f5695e5,0x3f6d1c1d,0x3f24d225,0x3f476085,0x3f628210,0x3f75341d
.long 0x0,0x3dc8bd36,0x3e47c5c2,0x3e94a031,0x0,0x3dcefdb7,0x3e4dee60,0x3e9920fe,0x0,0x3dd53db9,0x3e541501,0x3e9d9e78,0x0,0x3ddb7d37,0x3e5a3997,0x3ea21887
.long 0x0,0x3de1bc2e,0x3e605c13,0x3ea68f12,0x0,0x3de7fa9a,0x3e667c66,0x3eab0201,0x0,0x3dee3876,0x3e6c9a7f,0x3eaf713a,0x0,0x3df475c0,0x3e72b651,0x3eb3dca5
.long 0x0,0x3dfab273,0x3e78cfcc,0x3eb8442a,0x0,0x3e007745,0x3e7ee6e1,0x3ebca7af,0x0,0x3e039502,0x3e827dc0,0x3ec1071e,0x0,0x3e06b26e,0x3e8586ce,0x3ec5625c
.long 0x0,0x3e09cf86,0x3e888e93,0x3ec9b953,0x0,0x3e0cec4a,0x3e8b9507,0x3ece0bea,0x0,0x3e1008b7,0x3e8e9a22,0x3ed25a09,0x0,0x3e1324ca,0x3e919ddd,0x3ed6a399
.long 0x0,0x3e164083,0x3e94a031,0x3edae880,0x0,0x3e195be0,0x3e97a117,0x3edf28a9,0x0,0x3e1c76de,0x3e9aa086,0x3ee363fa,0x0,0x3e1f917b,0x3e9d9e78,0x3ee79a5d
.long 0x0,0x3e22abb6,0x3ea09ae5,0x3eebcbbb,0x0,0x3e25c58c,0x3ea395c5,0x3eeff7fb,0x0,0x3e28defc,0x3ea68f12,0x3ef41f07,0x0,0x3e2bf804,0x3ea986c4,0x3ef840c8
.long 0x0,0x3e2f10a2,0x3eac7cd4,0x3efc5d27,0x0,0x3e3228d4,0x3eaf713a,0x3f003a06,0x0,0x3e354098,0x3eb263ef,0x3f0242b1,0x0,0x3e3857ec,0x3eb554ec,0x3f044889
.long 0x0,0x3e3b6ecf,0x3eb8442a,0x3f064b82,0x0,0x3e3e853e,0x3ebb31a0,0x3f084b92,0x0,0x3e419b37,0x3ebe1d4a,0x3f0a48ad,0x0,0x3e44b0b9,0x3ec1071e,0x3f0c42c9
.long 0x3ec3ef15,0x3ef15aea,0x3f0e39da,0x3f226799,0x3ec9b953,0x3ef840c8,0x3f121eb0,0x3f269de3,0x3ecf7bca,0x3eff17b2,0x3f15f6d9,0x3f2ac082,0x3ed53641,0x3f02ef9f,0x3f19c200,0x3f2ecef7
.long 0x3edae880,0x3f064b82,0x3f1d7fd1,0x3f32c8c9,0x3ee0924f,0x3f099f4e,0x3f212ff9,0x3f36ad7f,0x3ee63375,0x3f0cead0,0x3f24d225,0x3f3a7ca4,0x3eebcbbb,0x3f102dd5,0x3f286605,0x3f3e35c5
.long 0x3ef15aea,0x3f13682a,0x3f2beb4a,0x3f41d870,0x3ef6e0cb,0x3f16999f,0x3f2f61a5,0x3f456439,0x3efc5d27,0x3f19c200,0x3f32c8c9,0x3f48d8b3,0x3f00e7e4,0x3f1ce11f,0x3f36206c,0x3f4c3578
.long 0x3f039c3d,0x3f1ff6cb,0x3f396842,0x3f4f7a1f,0x3f064b82,0x3f2302d3,0x3f3ca003,0x3f52a649,0x3f08f59b,0x3f26050a,0x3f3fc767,0x3f55b993,0x3f0b9a6b,0x3f28fd41,0x3f42de29,0x3f58b3a1
.long 0x3f0e39da,0x3f2beb4a,0x3f45e403,0x3f5b941a,0x3f10d3cd,0x3f2ecef7,0x3f48d8b3,0x3f5e5aa6,0x3f13682a,0x3f31a81d,0x3f4bbbf8,0x3f6106f2,0x3f15f6d9,0x3f34768f,0x3f4e8d90,0x3f6398ac
.long 0x3f187fc0,0x3f373a23,0x3f514d3d,0x3f660f88,0x3f1b02c6,0x3f39f2ac,0x3f53fac3,0x3f686b39,0x3f1d7fd1,0x3f3ca003,0x3f5695e5,0x3f6aab7b,0x3f1ff6cb,0x3f3f41fc,0x3f591e6a,0x3f6cd007
.long 0x3f226799,0x3f41d870,0x3f5b941a,0x3f6ed89e,0x3f24d225,0x3f446337,0x3f5df6be,0x3f70c501,0x3f273656,0x3f46e22a,0x3f604621,0x3f7294f8,0x3f299415,0x3f495521,0x3f628210,0x3f74484b
.long 0x3f2beb4a,0x3f4bbbf8,0x3f64aa59,0x3f75dec6,0x3f2e3bde,0x3f4e1689,0x3f66becc,0x3f77583a,0x3f3085bb,0x3f5064af,0x3f68bf3c,0x3f78b47b,0x3f32c8c9,0x3f52a649,0x3f6aab7b,0x3f79f35e
.long 0x3f3504f3,0x3f45e403,0x3f54db31,0x3f61c598,0x3f396842,0x3f4a4c87,0x3f591e6a,0x3f65b710,0x3f3daef9,0x3f4e8d90,0x3f5d2d53,0x3f696591,0x3f41d870,0x3f52a649,0x3f6106f2,0x3f6cd007
.long 0x3f45e403,0x3f5695e5,0x3f64aa59,0x3f6ff573,0x3f49d112,0x3f5a5ba0,0x3f6816a8,0x3f72d4eb,0x3f4d9f02,0x3f5df6be,0x3f6b4b0c,0x3f756d97,0x3f514d3d,0x3f61668a,0x3f6e46be,0x3f77beb7
.long 0x3f54db31,0x3f64aa59,0x3f710908,0x3f79c79d,0x3f584853,0x3f67c187,0x3f73913f,0x3f7b87b2,0x3f5b941a,0x3f6aab7b,0x3f75dec6,0x3f7cfe73,0x3f5ebe05,0x3f6d67a1,0x3f77f110,0x3f7e2b72
.long 0x3f61c598,0x3f6ff573,0x3f79c79d,0x3f7f0e58,0x3f64aa59,0x3f725470,0x3f7b61fc,0x3f7fa6e3,0x3f676bd8,0x3f748422,0x3f7cbfc9,0x3f7ff4e6,0x3f6a09a7,0x3f76841b,0x3f7de0b1,0x3f7ff84a
.long 0x3f6c835e,0x3f7853f8,0x3f7ec46d,0x3f7fb10f,0x3f6ed89e,0x3f79f35e,0x3f7f6ac7,0x3f7f1f49,0x3f710908,0x3f7b61fc,0x3f7fd397,0x3f7e4323,0x3f731447,0x3f7c9f8a,0x3f7ffec4,0x3f7d1cdd
.long 0x3f74fa0b,0x3f7dabcc,0x3f7fec43,0x3f7baccd,0x3f76ba07,0x3f7e868b,0x3f7f9c18,0x3f79f35e,0x3f7853f8,0x3f7f2f9d,0x3f7f0e58,0x3f77f110,0x3f79c79d,0x3f7fa6e3,0x3f7e4323,0x3f75a67b
.long 0x3f7b14be,0x3f7fec43,0x3f7d3aac,0x3f731447,0x3f7c3b28,0x3f7fffb1,0x3f7bf531,0x3f703b37,0x3f7d3aac,0x3f7fe129,0x3f7a7302,0x3f6d1c1d,0x3f7e1324,0x3f7f90b1,0x3f78b47b,0x3f69b7e4
.long 0x3f7ec46d,0x3f7f0e58,0x3f76ba07,0x3f660f88,0x3f7f4e6d,0x3f7e5a38,0x3f748422,0x3f62241a,0x3f7fb10f,0x3f7d7474,0x3f721352,0x3f5df6be,0x3f7fec43,0x3f7c5d3a,0x3f6f6830,0x3f5988ad
.long 0x3f6c835e,0x3f74fa0b,0x3f7b14be,0x3f7ec46d,0x3f6ff573,0x3f77beb7,0x3f7cfe73,0x3f7fa6e3,0x3f731447,0x3f7a1e84,0x3f7e70b0,0x3f7ffec4,0x3f75dec6,0x3f7c187a,0x3f7f6ac7,0x3f7fcbe2
.long 0x3f7853f8,0x3f7dabcc,0x3f7fec43,0x3f7f0e58,0x3f7a7302,0x3f7ed7d4,0x3f7ff4e6,0x3f7dc68c,0x3f7c3b28,0x3f7f9c18,0x3f7f84ab,0x3f7bf531,0x3f7dabcc,0x3f7ff84a,0x3f7e9bc9,0x3f799b43
.long 0x3f7ec46d,0x3f7fec43,0x3f7d3aac,0x3f76ba07,0x3f7f84ab,0x3f7f7808,0x3f7b61fc,0x3f73530e,0x3f7fec43,0x3f7e9bc9,0x3f791298,0x3f6f6830,0x3f7ffb11,0x3f7d57de,0x3f764d97,0x3f6afb8c
.long 0x3f7fb10f,0x3f7baccd,0x3f731447,0x3f660f88,0x3f7f0e58,0x3f799b43,0x3f6f6830,0x3f60a6cf,0x3f7e1324,0x3f772417,0x3f6b4b0c,0x3f5ac450,0x3f7cbfc9,0x3f74484b,0x3f66becc,0x3f546b3b
.long 0x3f7b14be,0x3f710908,0x3f61c598,0x3f4d9f02,0x3f791298,0x3f6d67a1,0x3f5c61c7,0x3f466354,0x3f76ba07,0x3f696591,0x3f5695e5,0x3f3ebc1b,0x3f740bdd,0x3f650479,0x3f5064af,0x3f36ad7f
.long 0x3f710908,0x3f604621,0x3f49d112,0x3f2e3bde,0x3f6db293,0x3f5b2c79,0x3f42de29,0x3f256bcb,0x3f6a09a7,0x3f55b993,0x3f3b8f3b,0x3f1c420c,0x3f660f88,0x3f4fefa8,0x3f33e7bc,0x3f12c39a
.long 0x3f61c598,0x3f49d112,0x3f2beb4a,0x3f08f59b,0x3f5d2d53,0x3f436051,0x3f239da9,0x3efdbabb,0x3f584853,0x3f3ca003,0x3f1b02c6,0x3ee900b7,0x3f531849,0x3f3592e7,0x3f121eb0,0x3ed3c867
.long 0x3f4d9f02,0x3f2e3bde,0x3f08f59b,0x3ebe1d4a,0x3f47de65,0x3f269de3,0x3eff17b2,0x3ea80b1f,0x3f41d870,0x3f1ebc12,0x3eebcbbb,0x3e919ddd,0x3f3b8f3b,0x3f16999f,0x3ed8106b,0x3e75c35a
.long 0x3f800000,0x3f7ec46d,0x3f7b14be,0x3f74fa0b,0x3f7fb10f,0x3f7d1cdd,0x3f77f110,0x3f703b37,0x3f7ec46d,0x3f7ac516,0x3f740bdd,0x3f6aab7b,0x3f7d3aac,0x3f77beb7,0x3f6f6830,0x3f644fac
.long 0x3f7b14be,0x3f740bdd,0x3f6a09a7,0x3f5d2d53,0x3f7853f8,0x3f6faf1b,0x3f63f473,0x3f554aa4,0x3f74fa0b,0x3f6aab7b,0x3f5d2d53,0x3f4cae79,0x3f710908,0x3f650479,0x3f55b993,0x3f436051
.long 0x3f6c835e,0x3f5ebe05,0x3f4d9f02,0x3f396842,0x3f676bd8,0x3f57dc7f,0x3f44e3f5,0x3f2ecef7,0x3f61c598,0x3f5064af,0x3f3b8f3b,0x3f239da9,0x3f5b941a,0x3f485bca,0x3f31a81d,0x3f17de12
.long 0x3f54db31,0x3f3fc767,0x3f273656,0x3f0b9a6b,0x3f4d9f02,0x3f36ad7f,0x3f1c420c,0x3efdbabb,0x3f45e403,0x3f2d1469,0x3f10d3cd,0x3ee363fa,0x3f3daef9,0x3f2302d3,0x3f04f484,0x3ec8477c
.long 0x3f3504f3,0x3f187fc0,0x3ef15aea,0x3eac7cd4,0x3f2beb4a,0x3f0d9281,0x3ed8106b,0x3e901c2c,0x3f226799,0x3f0242b1,0x3ebe1d4a,0x3e667c66,0x3f187fc0,0x3eed3063,0x3ea395c5,0x3e2bf804
.long 0x3f0e39da,0x3ed53641,0x3e888e93,0x3de1bc2e,0x3f039c3d,0x3ebca7af,0x3e5a3997,0x3d55880e,0x3ef15aea,0x3ea395c5,0x3e22abb6,0xbbc90f88,0x3edae880,0x3e8a11f7,0x3dd53db9,0xbd83db0a
.long 0x3ec3ef15,0x3e605c13,0x3d48fb30,0xbdfab273,0x3eac7cd4,0x3e2bf804,0xbbc90f88,0xbe3857ec,0x3e94a031,0x3dee3876,0xbd7b2b74,0xbe72b651,0x3e78cfcc,0x3d83db0a,0xbdee3876,0xbe9620d2
.long 0x3e47c5c2,0x3c490e90,0xbe2f10a2,0xbeb263ef,0x3e164083,0xbd2351cb,0xbe667c66,0xbece0bea,0x3dc8bd36,0xbdbc3ac3,0xbe8e9a22,0xbee900b7,0x3d48fb30,0xbe1324ca,0xbea986c4,0xbf019573
.long 0x3f6c835e,0x3f61c598,0x3f54db31,0x3f45e403,0x3f660f88,0x3f5988ad,0x3f4ac77f,0x3f39f2ac,0x3f5ebe05,0x3f5064af,0x3f3fc767,0x3f2d1469,0x3f5695e5,0x3f466354,0x3f33e7bc,0x3f1f599f
.long 0x3f4d9f02,0x3f3b8f3b,0x3f273656,0x3f10d3cd,0x3f43e200,0x3f2ff3e6,0x3f19c200,0x3f019573,0x3f396842,0x3f239da9,0x3f0b9a6b,0x3ee363fa,0x3f2e3bde,0x3f16999f,0x3ef9a02d,0x3ec27b55
.long 0x3f226799,0x3f08f59b,0x3edae880,0x3ea09ae5,0x3f15f6d9,0x3ef58035,0x3ebb31a0,0x3e7bdba4,0x3f08f59b,0x3ed8106b,0x3e9aa086,0x3e354098,0x3ef6e0cb,0x3eb9bb1e,0x3e72b651,0x3ddb7d37
.long 0x3edae880,0x3e9aa086,0x3e2f10a2,0x3d16c32c,0x3ebe1d4a,0x3e75c35a,0x3dd53db9,0xbd0a342f,0x3ea09ae5,0x3e354098,0x3d16c32c,0xbdd53db9,0x3e827dc0,0x3de7fa9a,0xbcfb49ba,0xbe3228d4
.long 0x3e47c5c2,0x3d48fb30,0xbdc8bd36,0xbe78cfcc,0x3e09cf86,0xbc7b514b,0xbe28defc,0xbe9f1cdf,0x3d96a905,0xbda3308c,0xbe6c9a7f,0xbec1071e,0x3c490e90,0xbe1324ca,0xbe97a117,0xbee1fb6a
.long 0xbd48fb30,0xbe541501,0xbeb8442a,0xbf00e7e4,0xbde1bc2e,0xbe8a11f7,0xbed8106b,0xbf102dd5,0xbe2f10a2,0xbea986c4,0xbef6e0cb,0xbf1ebc12,0xbe6c9a7f,0xbec8477c,0xbf0a48ad,0xbf2c800f
.long 0xbe94a031,0xbee63375,0xbf187fc0,0xbf396842,0xbeb263ef,0xbf019573,0xbf26050a,0xbf456439,0xbecf7bca,0xbf0f8784,0xbf32c8c9,0xbf5064af,0xbeebcbbb,0xbf1ce11f,0xbf3ebc1b,0xbf5a5ba0
.long 0xbf039c3d,0xbf299415,0xbf49d112,0xbf633c5a,0xbf10d3cd,0xbf3592e7,0xbf53fac3,0xbf6afb8c,0xbf1d7fd1,0xbf40d0da,0xbf5d2d53,0xbf718f57,0xbf299415,0xbf4b41fa,0xbf655e0b,0xbf76ef5b
.long 0x3f3504f3,0x3f226799,0x3f0e39da,0x3ef15aea,0x3f273656,0x3f12c39a,0x3ef9a02d,0x3ecb2aae,0x3f187fc0,0x3f0242b1,0x3ed53641,0x3ea395c5,0x3f08f59b,0x3ee1fb6a,0x3eaf713a,0x3e75c35a
.long 0x3ef15aea,0x3ebe1d4a,0x3e888e93,0x3e22abb6,0x3ecf7bca,0x3e9920fe,0x3e419b37,0x3d9cecf9,0x3eac7cd4,0x3e667c66,0x3de1bc2e,0xbbc90f88,0x3e888e93,0x3e195be0,0x3cfb49ba,0xbdb5f8da
.long 0x3e47c5c2,0x3d96a905,0xbd48fb30,0xbe2f10a2,0x3dfab273,0xbb490fc6,0xbe039502,0xbe80f8c0,0x3d48fb30,0xbda3308c,0xbe541501,0xbea986c4,0xbcc90ab0,0xbe1f917b,0xbe919ddd,0xbed0eb2a
.long 0xbdc8bd36,0xbe6c9a7f,0xbeb8442a,0xbef6e0cb,0xbe2f10a2,0xbe9c1faf,0xbeddbe79,0xbf0d9281,0xbe78cfcc,0xbec1071e,0xbf00e7e4,0xbf1ebc12,0xbea09ae5,0xbee4cbfe,0xbf121eb0,0xbf2ecef7
.long 0xbec3ef15,0xbf039c3d,0xbf226799,0xbf3daef9,0xbee63375,0xbf140c5f,0xbf31a81d,0xbf4b41fa,0xbf039c3d,0xbf239da9,0xbf3fc767,0xbf577026,0xbf13682a,0xbf3238aa,0xbf4cae79,0xbf62241a
.long 0xbf226799,0xbf3fc767,0xbf584853,0xbf6b4b0c,0xbf3085bb,0xbf4c3578,0xbf628210,0xbf72d4eb,0xbf3daef9,0xbf577026,0xbf6b4b0c,0xbf78b47b,0xbf49d112,0xbf61668a,0xbf7294f8,0xbf7cdf6c
.long 0xbf54db31,0xbf6a09a7,0xbf7853f8,0xbf7f4e6d,0xbf5ebe05,0xbf714c7a,0xbf7c7eb0,0xbf7ffd39,0xbf676bd8,0xbf772417,0xbf7f0e58,0xbf7eea9d,0xbf6ed89e,0xbf7b87b2,0xbf7ffec4,0xbf7c187a
.long 0xbf74fa0b,0xbf7e70b0,0xbf7f4e6d,0xbf778bc5,0xbf79c79d,0xbf7fdaaf,0xbf7cfe73,0xbf714c7a,0xbf7d3aac,0xbf7fc38f,0xbf791298,0xbf696591,0xbf7f4e6d,0xbf7e2b72,0xbf73913f,0xbf5fe4e9
.long 0x3ec3ef15,0x3e94a031,0x3e47c5c2,0x3dc8bd36,0x3e9aa086,0x3e5101f1,0x3dd53db9,0x3b490fc6,0x3e605c13,0x3dee3876,0x3c490e90,0xbdbc3ac3,0x3e09cf86,0x3ce22a7a,0xbda3308c,0xbe3e853e
.long 0x3d48fb30,0xbd7b2b74,0xbe2f10a2,0xbe8e9a22,0xbd16c32c,0xbe195be0,0xbe8586ce,0xbebca7af,0xbdfab273,0xbe72b651,0xbeb263ef,0xbee900b7,0xbe541501,0xbea5129f,0xbeddbe79,0xbf099f4e
.long 0xbe94a031,0xbecf7bca,0xbf039c3d,0xbf1d7fd1,0xbebe1d4a,0xbef840c8,0xbf173c07,0xbf2ff3e6,0xbee63375,0xbf0f8784,0xbf299415,0xbf40d0da,0xbf064b82,0xbf21cbfb,0xbf3a7ca4,0xbf4fefa8
.long 0xbf187fc0,0xbf32c8c9,0xbf49d112,0xbf5d2d53,0xbf299415,0xbf425b89,0xbf577026,0xbf686b39,0xbf396842,0xbf5064af,0xbf633c5a,0xbf718f57,0xbf47de65,0xbf5cc7d1,0xbf6d1c1d,0xbf788486
.long 0xbf54db31,0xbf676bd8,0xbf74fa0b,0xbf7d3aac,0xbf604621,0xbf703b37,0xbf7ac516,0xbf7fa6e3,0xbf6a09a7,0xbf772417,0xbf7e70b0,0xbf7fc38f,0xbf721352,0xbf7c187a,0xbf7ff4e6,0xbf7d906e
.long 0xbf7853f8,0xbf7f0e58,0xbf7f4e6d,0xbf791298,0xbf7cbfc9,0xbf7fffb1,0xbf7c7eb0,0xbf725470,0xbf7f4e6d,0xbf7eea9d,0xbf778bc5,0xbf696591,0xbf7ffb11,0xbf7bd14d,0xbf708066,0xbf5e5aa6
.long 0xbf7ec46d,0xbf76ba07,0xbf676bd8,0xbf514d3d,0xbf7baccd,0xbf6faf1b,0xbf5c61c7,0xbf425b89,0xbf76ba07,0xbf66becc,0xbf4f7a1f,0xbf31a81d,0xbf6ff573,0xbf5bfb34,0xbf40d0da,0xbf1f599f
.long 0xbf676bd8,0xbf4f7a1f,0xbf3085bb,0xbf0b9a6b,0xbf5d2d53,0xbf4154e1,0xbf1ebc12,0xbeed3063,0xbf514d3d,0xbf31a81d,0xbf0b9a6b,0xbec1071e,0xbf43e200,0xbf209393,0xbeee9479,0xbe931f35
.p2align 8
tbl_tw640:
.long 0x3f800000,0x0,0x3f800000,0x0,0x3f800000,0x0,0x0,0x0,0x3f7ffcd7,0x3c20d8d2,0x3f7ff35e,0x3ca0d6d6,0x3f7fe394,0x3cf13d4c,0x0,0x0
.long 0x3f7ff35e,0x3ca0d6d6,0x3f7fcd79,0x3d20cee7,0x3f7f8e56,0x3d712283,0x0,0x0,0x3f7fe394,0x3cf13d4c,0x3f7f8e56,0x3d712283,0x3f7f0059,0x3db4b86a,0x0,0x0
.long 0x3f7fcd79,0x3d20cee7,0x3f7f35f9,0x3da0af2a,0x3f7e39bc,0x3df0b772,0x0,0x0,0x3f7fb10f,0x3d48fb30,0x3f7ec46d,0x3dc8bd36,0x3f7d3aac,0x3e164083,0x0,0x0
.long 0x3f7f8e56,0x3d712283,0x3f7e39bc,0x3df0b772,0x3f7c0361,0x3e3403f1,0x0,0x0,0x3f7f654e,0x3d8ca1f2,0x3f7d95f4,0x3e0c4cf7,0x3f7a9421,0x3e519f65,0x0,0x0
.long 0x3f7f35f9,0x3da0af2a,0x3f7cd925,0x3e20305b,0x3f78ed3c,0x3e6f0c4d,0x0,0x0,0x3f7f0059,0x3db4b86a,0x3f7c0361,0x3e3403f1,0x3f770f11,0x3e862210,0x0,0x0
.long 0x3f7ec46d,0x3dc8bd36,0x3f7b14be,0x3e47c5c2,0x3f74fa0b,0x3e94a031,0x0,0x0,0x3f7e8238,0x3ddcbd0d,0x3f7a0d54,0x3e5b73dc,0x3f72ae9e,0x3ea2fd52,0x0,0x0
.long 0x3f7e39bc,0x3df0b772,0x3f78ed3c,0x3e6f0c4d,0x3f702d4f,0x3eb13641,0x0,0x0,0x3f7deafa,0x3e0255f4,0x3f77b493,0x3e814693,0x3f6d76aa,0x3ebf47d7,0x0,0x0
.long 0x3f7d95f4,0x3e0c4cf7,0x3f766377,0x3e8afa3e,0x3f6a8b4b,0x3ecd2ef3,0x0,0x0,0x3f7d3aac,0x3e164083,0x3f74fa0b,0x3e94a031,0x3f676bd8,0x3edae880,0x0,0x0
.long 0x3f7cd925,0x3e20305b,0x3f737871,0x3e9e377a,0x3f641901,0x3ee87171,0x0,0x0,0x3f7c7160,0x3e2a1c3f,0x3f71decf,0x3ea7bf25,0x3f609384,0x3ef5c6c5,0x0,0x0
.long 0x3f7c0361,0x3e3403f1,0x3f702d4f,0x3eb13641,0x3f5cdc29,0x3f0172c3,0x0,0x0,0x3f7b8f2a,0x3e3de731,0x3f6e641a,0x3eba9be1,0x3f58f3c4,0x3f07e565,0x0,0x0
.long 0x3f7b14be,0x3e47c5c2,0x3f6c835e,0x3ec3ef15,0x3f54db31,0x3f0e39da,0x0,0x0,0x3f7a9421,0x3e519f65,0x3f6a8b4b,0x3ecd2ef3,0x3f50935b,0x3f146eba,0x0,0x0
.long 0x3f7a0d54,0x3e5b73dc,0x3f687c12,0x3ed65a92,0x3f4c1d35,0x3f1a82a4,0x0,0x0,0x3f79805c,0x3e6542e9,0x3f6655e7,0x3edf7108,0x3f4779bc,0x3f207440,0x0,0x0
.long 0x3f78ed3c,0x3e6f0c4d,0x3f641901,0x3ee87171,0x3f42a9f7,0x3f26423a,0x0,0x0,0x3f7853f8,0x3e78cfcc,0x3f61c598,0x3ef15aea,0x3f3daef9,0x3f2beb4a,0x0,0x0
.long 0x3f77b493,0x3e814693,0x3f5f5be6,0x3efa2c90,0x3f3889dc,0x3f316e2c,0x0,0x0,0x3f770f11,0x3e862210,0x3f5cdc29,0x3f0172c3,0x3f333bc6,0x3f36c9a9,0x0,0x0
.long 0x3f766377,0x3e8afa3e,0x3f5a46a0,0x3f05c277,0x3f2dc5e3,0x3f3bfc8f,0x0,0x0,0x3f75b1c9,0x3e8fcefe,0x3f579b8c,0x3f0a04f8,0x3f28296a,0x3f4105b8,0x0,0x0
.long 0x3f74fa0b,0x3e94a031,0x3f54db31,0x3f0e39da,0x3f226799,0x3f45e403,0x0,0x0,0x3f743c41,0x3e996dba,0x3f5205d4,0x3f1260b2,0x3f1c81b9,0x3f4a965e,0x0,0x0
.long 0x3f737871,0x3e9e377a,0x3f4f1bbd,0x3f167918,0x3f167918,0x3f4f1bbd,0x0,0x0,0x3f72ae9e,0x3ea2fd52,0x3f4c1d35,0x3f1a82a4,0x3f104f0e,0x3f53731f,0x0,0x0
.long 0x3f71decf,0x3ea7bf25,0x3f490a88,0x3f1e7cf1,0x3f0a04f8,0x3f579b8c,0x0,0x0,0x3f710908,0x3eac7cd4,0x3f45e403,0x3f226799,0x3f039c3d,0x3f5b941a,0x0,0x0
.long 0x3f702d4f,0x3eb13641,0x3f42a9f7,0x3f26423a,0x3efa2c90,0x3f5f5be6,0x0,0x0,0x3f6f4ba8,0x3eb5eb4f,0x3f3f5cb5,0x3f2a0c73,0x3eece91a,0x3f62f219,0x0,0x0
.long 0x3f6e641a,0x3eba9be1,0x3f3bfc8f,0x3f2dc5e3,0x3edf7108,0x3f6655e7,0x0,0x0,0x3f6d76aa,0x3ebf47d7,0x3f3889dc,0x3f316e2c,0x3ed1c759,0x3f698690,0x0,0x0
.long 0x3f6c835e,0x3ec3ef15,0x3f3504f3,0x3f3504f3,0x3ec3ef15,0x3f6c835e,0x0,0x0,0x3f6b8a3d,0x3ec8917e,0x3f316e2c,0x3f3889dc,0x3eb5eb4f,0x3f6f4ba8,0x0,0x0
.long 0x3f6a8b4b,0x3ecd2ef3,0x3f2dc5e3,0x3f3bfc8f,0x3ea7bf25,0x3f71decf,0x0,0x0,0x3f698690,0x3ed1c759,0x3f2a0c73,0x3f3f5cb5,0x3e996dba,0x3f743c41,0x0,0x0
.long 0x3f687c12,0x3ed65a92,0x3f26423a,0x3f42a9f7,0x3e8afa3e,0x3f766377,0x0,0x0,0x3f676bd8,0x3edae880,0x3f226799,0x3f45e403,0x3e78cfcc,0x3f7853f8,0x0,0x0
.long 0x3f6655e7,0x3edf7108,0x3f1e7cf1,0x3f490a88,0x3e5b73dc,0x3f7a0d54,0x0,0x0,0x3f653a48,0x3ee3f40d,0x3f1a82a4,0x3f4c1d35,0x3e3de731,0x3f7b8f2a,0x0,0x0
.long 0x3f641901,0x3ee87171,0x3f167918,0x3f4f1bbd,0x3e20305b,0x3f7cd925,0x0,0x0,0x3f62f219,0x3eece91a,0x3f1260b2,0x3f5205d4,0x3e0255f4,0x3f7deafa,0x0,0x0
.long 0x3f61c598,0x3ef15aea,0x3f0e39da,0x3f54db31,0x3dc8bd36,0x3f7ec46d,0x0,0x0,0x3f609384,0x3ef5c6c5,0x3f0a04f8,0x3f579b8c,0x3d8ca1f2,0x3f7f654e,0x0,0x0
.long 0x3f5f5be6,0x3efa2c90,0x3f05c277,0x3f5a46a0,0x3d20cee7,0x3f7fcd79,0x0,0x0,0x3f5e1ec5,0x3efe8c2f,0x3f0172c3,0x3f5cdc29,0x3c20d8d2,0x3f7ffcd7,0x0,0x0
.long 0x3f5cdc29,0x3f0172c3,0x3efa2c90,0x3f5f5be6,0xbca0d6d6,0x3f7ff35e,0x0,0x0,0x3f5b941a,0x3f039c3d,0x3ef15aea,0x3f61c598,0xbd48fb30,0x3f7fb10f,0x0,0x0
.long 0x3f5a46a0,0x3f05c277,0x3ee87171,0x3f641901,0xbda0af2a,0x3f7f35f9,0x0,0x0,0x3f58f3c4,0x3f07e565,0x3edf7108,0x3f6655e7,0xbddcbd0d,0x3f7e8238,0x0,0x0
.long 0x3f579b8c,0x3f0a04f8,0x3ed65a92,0x3f687c12,0xbe0c4cf7,0x3f7d95f4,0x0,0x0,0x3f563e03,0x3f0c2124,0x3ecd2ef3,0x3f6a8b4b,0xbe2a1c3f,0x3f7c7160,0x0,0x0
.long 0x3f54db31,0x3f0e39da,0x3ec3ef15,0x3f6c835e,0xbe47c5c2,0x3f7b14be,0x0,0x0,0x3f53731f,0x3f104f0e,0x3eba9be1,0x3f6e641a,0xbe6542e9,0x3f79805c,0x0,0x0
.long 0x3f5205d4,0x3f1260b2,0x3eb13641,0x3f702d4f,0xbe814693,0x3f77b493,0x0,0x0,0x3f50935b,0x3f146eba,0x3ea7bf25,0x3f71decf,0xbe8fcefe,0x3f75b1c9,0x0,0x0
.long 0x3f4f1bbd,0x3f167918,0x3e9e377a,0x3f737871,0xbe9e377a,0x3f737871,0x0,0x0,0x3f4d9f02,0x3f187fc0,0x3e94a031,0x3f74fa0b,0xbeac7cd4,0x3f710908,0x0,0x0
.long 0x3f4c1d35,0x3f1a82a4,0x3e8afa3e,0x3f766377,0xbeba9be1,0x3f6e641a,0x0,0x0,0x3f4a965e,0x3f1c81b9,0x3e814693,0x3f77b493,0xbec8917e,0x3f6b8a3d,0x0,0x0
.long 0x3f490a88,0x3f1e7cf1,0x3e6f0c4d,0x3f78ed3c,0xbed65a92,0x3f687c12,0x0,0x0,0x3f4779bc,0x3f207440,0x3e5b73dc,0x3f7a0d54,0xbee3f40d,0x3f653a48,0x0,0x0
.long 0x3f45e403,0x3f226799,0x3e47c5c2,0x3f7b14be,0xbef15aea,0x3f61c598,0x0,0x0,0x3f444969,0x3f2456f1,0x3e3403f1,0x3f7c0361,0xbefe8c2f,0x3f5e1ec5,0x0,0x0
.long 0x3f42a9f7,0x3f26423a,0x3e20305b,0x3f7cd925,0xbf05c277,0x3f5a46a0,0x0,0x0,0x3f4105b8,0x3f28296a,0x3e0c4cf7,0x3f7d95f4,0xbf0c2124,0x3f563e03,0x0,0x0
.long 0x3f3f5cb5,0x3f2a0c73,0x3df0b772,0x3f7e39bc,0xbf1260b2,0x3f5205d4,0x0,0x0,0x3f3daef9,0x3f2beb4a,0x3dc8bd36,0x3f7ec46d,0xbf187fc0,0x3f4d9f02,0x0,0x0
.long 0x3f3bfc8f,0x3f2dc5e3,0x3da0af2a,0x3f7f35f9,0xbf1e7cf1,0x3f490a88,0x0,0x0,0x3f3a4582,0x3f2f9c32,0x3d712283,0x3f7f8e56,0xbf2456f1,0x3f444969,0x0,0x0
.long 0x3f3889dc,0x3f316e2c,0x3d20cee7,0x3f7fcd79,0xbf2a0c73,0x3f3f5cb5,0x0,0x0,0x3f36c9a9,0x3f333bc6,0x3ca0d6d6,0x3f7ff35e,0xbf2f9c32,0x3f3a4582,0x0,0x0
.long 0x3f3504f3,0x3f3504f3,0x248d3132,0x3f800000,0xbf3504f3,0x3f3504f3,0x0,0x0,0x3f333bc6,0x3f36c9a9,0xbca0d6d6,0x3f7ff35e,0xbf3a4582,0x3f2f9c32,0x0,0x0
.long 0x3f316e2c,0x3f3889dc,0xbd20cee7,0x3f7fcd79,0xbf3f5cb5,0x3f2a0c73,0x0,0x0,0x3f2f9c32,0x3f3a4582,0xbd712283,0x3f7f8e56,0xbf444969,0x3f2456f1,0x0,0x0
.long 0x3f2dc5e3,0x3f3bfc8f,0xbda0af2a,0x3f7f35f9,0xbf490a88,0x3f1e7cf1,0x0,0x0,0x3f2beb4a,0x3f3daef9,0xbdc8bd36,0x3f7ec46d,0xbf4d9f02,0x3f187fc0,0x0,0x0
.long 0x3f2a0c73,0x3f3f5cb5,0xbdf0b772,0x3f7e39bc,0xbf5205d4,0x3f1260b2,0x0,0x0,0x3f28296a,0x3f4105b8,0xbe0c4cf7,0x3f7d95f4,0xbf563e03,0x3f0c2124,0x0,0x0
.long 0x3f26423a,0x3f42a9f7,0xbe20305b,0x3f7cd925,0xbf5a46a0,0x3f05c277,0x0,0x0,0x3f2456f1,0x3f444969,0xbe3403f1,0x3f7c0361,0xbf5e1ec5,0x3efe8c2f,0x0,0x0
.long 0x3f226799,0x3f45e403,0xbe47c5c2,0x3f7b14be,0xbf61c598,0x3ef15aea,0x0,0x0,0x3f207440,0x3f4779bc,0xbe5b73dc,0x3f7a0d54,0xbf653a48,0x3ee3f40d,0x0,0x0
.long 0x3f1e7cf1,0x3f490a88,0xbe6f0c4d,0x3f78ed3c,0xbf687c12,0x3ed65a92,0x0,0x0,0x3f1c81b9,0x3f4a965e,0xbe814693,0x3f77b493,0xbf6b8a3d,0x3ec8917e,0x0,0x0
.long 0x3f1a82a4,0x3f4c1d35,0xbe8afa3e,0x3f766377,0xbf6e641a,0x3eba9be1,0x0,0x0,0x3f187fc0,0x3f4d9f02,0xbe94a031,0x3f74fa0b,0xbf710908,0x3eac7cd4,0x0,0x0
.set Cx0, 16256
.set Cx1, 16256
.set Cx2, 16255
.set Cx3, 16254
.set Cx4, 16253
.set Cx5, 16251
.set Cx6, 16249
.set Cx7, 16246
.set Cx8, 16243
.set Cx9, 16240
.set Cx10, 16237
.set Cx11, 16232
.set Cx12, 16228
.set Cx13, 16223
.set Cx14, 16218
.set Cx15, 16213
.set Cx16, 16207
.set Cx17, 16201
.set Cx18, 16195
.set Cx19, 16188
.set Cx20, 16181
.set Cx21, 16174
.set Cx22, 16166
.set Cx23, 16158
.set Cx24, 16150
.set Cx25, 16142
.set Cx26, 16134
.set Cx27, 16122
.set Cx28, 16104
.set Cx29, 16086
.set Cx30, 16068
.set Cx31, 16049
.set Cx32, 16030
.set Cx33, 16011
.set Cx34, 15983
.set Cx35, 15944
.set Cx36, 15904
.set Cx37, 15857
.set Cx38, 15777
.set Cx39, 15649
.set Cx40, 0
.set Cx41, 48417
.set Cx42, 48545
.set Cx43, 48625
.set Cx44, 48672
.set Cx45, 48712
.set Cx46, 48751
.set Cx47, 48779
.set Cx48, 48798
.set Cx49, 48817
.set Cx50, 48836
.set Cx51, 48854
.set Cx52, 48872
.set Cx53, 48890
.set Cx54, 48902
.set Cx55, 48910
.set Cx56, 48918
.set Cx57, 48926
.set Cx58, 48934
.set Cx59, 48942
.set Cx60, 48949
.set Cx61, 48956
.set Cx62, 48963
.set Cx63, 48969
.set Cx64, 48975
.set Cx65, 48981
.set Cx66, 48986
.set Cx67, 48991
.set Cx68, 48996
.set Cx69, 49000
.set Cx70, 49005
.set Cx71, 49008
.set Cx72, 49011
.set Cx73, 49014
.set Cx74, 49017
.set Cx75, 49019
.set Cx76, 49021
.set Cx77, 49022
.set Cx78, 49023
.set Cx79, 49024
.set Cx80, 49024
.set Cx81, 49024
.set Cx82, 49023
.set Cx83, 49022
.set Cx84, 49021
.set Cx85, 49019
.set Cx86, 49017
.set Cx87, 49014
.set Cx88, 49011
.set Cx89, 49008
.set Cx90, 49005
.set Cx91, 49000
.set Cx92, 48996
.set Cx93, 48991
.set Cx94, 48986
.set Cx95, 48981
.set Cx96, 48975
.set Cx97, 48969
.set Cx98, 48963
.set Cx99, 48956
.set Cx100, 48949
.set Cx101, 48942
.set Cx102, 48934
.set Cx103, 48926
.set Cx104, 48918
.set Cx105, 48910
.set Cx106, 48902
.set Cx107, 48890
.set Cx108, 48872
.set Cx109, 48854
.set Cx110, 48836
.set Cx111, 48817
.set Cx112, 48798
.set Cx113, 48779
.set Cx114, 48751
.set Cx115, 48712
.set Cx116, 48672
.set Cx117, 48625
.set Cx118, 48545
.set Cx119, 48417
.set Cx120, 0
.set Cx121, 15649
.set Cx122, 15777
.set Cx123, 15857
.set Cx124, 15904
.set Cx125, 15944
.set Cx126, 15983
.set Cx127, 16011
.set Cx128, 16030
.set Cx129, 16049
.set Cx130, 16068
.set Cx131, 16086
.set Cx132, 16104
.set Cx133, 16122
.set Cx134, 16134
.set Cx135, 16142
.set Cx136, 16150
.set Cx137, 16158
.set Cx138, 16166
.set Cx139, 16174
.set Cx140, 16181
.set Cx141, 16188
.set Cx142, 16195
.set Cx143, 16201
.set Cx144, 16207
.set Cx145, 16213
.set Cx146, 16218
.set Cx147, 16223
.set Cx148, 16228
.set Cx149, 16232
.set Cx150, 16237
.set Cx151, 16240
.set Cx152, 16243
.set Cx153, 16246
.set Cx154, 16249
.set Cx155, 16251
.set Cx156, 16253
.set Cx157, 16254
.set Cx158, 16255
.set Cx159, 16256
.set Cx160, 16384
.set Cx161, 16384
.set Cx162, 16383
.set Cx163, 16382
.set Cx164, 16381
.set Cx165, 16379
.set Cx166, 16377
.set Cx167, 16374
.set Cx168, 16371
.set Cx169, 16368
.set Cx170, 16365
.set Cx171, 16360
.set Cx172, 16356
.set Cx173, 16351
.set Cx174, 16346
.set Cx175, 16341
.set Cx176, 16335
.set Cx177, 16329
.set Cx178, 16323
.set Cx179, 16316
.set Cx180, 16309
.set Cx181, 16302
.set Cx182, 16294
.set Cx183, 16286
.set Cx184, 16278
.set Cx185, 16270
.set Cx186, 16262
.set Cx187, 16250
.set Cx188, 16232
.set Cx189, 16214
.set Cx190, 16196
.set Cx191, 16177
.set Cx192, 16158
.set Cx193, 16139
.set Cx194, 16111
.set Cx195, 16072
.set Cx196, 16032
.set Cx197, 15985
.set Cx198, 15905
.set Cx199, 15777
.set Cx200, 0
.set Cx201, 48545
.set Cx202, 48673
.set Cx203, 48753
.set Cx204, 48800
.set Cx205, 48840
.set Cx206, 48879
.set Cx207, 48907
.set Cx208, 48926
.set Cx209, 48945
.set Cx210, 48964
.set Cx211, 48982
.set Cx212, 49000
.set Cx213, 49018
.set Cx214, 49030
.set Cx215, 49038
.set Cx216, 49046
.set Cx217, 49054
.set Cx218, 49062
.set Cx219, 49070
.set Cx220, 49077
.set Cx221, 49084
.set Cx222, 49091
.set Cx223, 49097
.set Cx224, 49103
.set Cx225, 49109
.set Cx226, 49114
.set Cx227, 49119
.set Cx228, 49124
.set Cx229, 49128
.set Cx230, 49133
.set Cx231, 49136
.set Cx232, 49139
.set Cx233, 49142
.set Cx234, 49145
.set Cx235, 49147
.set Cx236, 49149
.set Cx237, 49150
.set Cx238, 49151
.set Cx239, 49152
.set Cx240, 49152
.set Cx241, 49152
.set Cx242, 49151
.set Cx243, 49150
.set Cx244, 49149
.set Cx245, 49147
.set Cx246, 49145
.set Cx247, 49142
.set Cx248, 49139
.set Cx249, 49136
.set Cx250, 49133
.set Cx251, 49128
.set Cx252, 49124
.set Cx253, 49119
.set Cx254, 49114
.set Cx255, 49109
.set Cx256, 49103
.set Cx257, 49097
.set Cx258, 49091
.set Cx259, 49084
.set Cx260, 49077
.set Cx261, 49070
.set Cx262, 49062
.set Cx263, 49054
.set Cx264, 49046
.set Cx265, 49038
.set Cx266, 49030
.set Cx267, 49018
.set Cx268, 49000
.set Cx269, 48982
.set Cx270, 48964
.set Cx271, 48945
.set Cx272, 48926
.set Cx273, 48907
.set Cx274, 48879
.set Cx275, 48840
.set Cx276, 48800
.set Cx277, 48753
.set Cx278, 48673
.set Cx279, 48545
.set Cx280, 0
.set Cx281, 15777
.set Cx282, 15905
.set Cx283, 15985
.set Cx284, 16032
.set Cx285, 16072
.set Cx286, 16111
.set Cx287, 16139
.set Cx288, 16158
.set Cx289, 16177
.set Cx290, 16196
.set Cx291, 16214
.set Cx292, 16232
.set Cx293, 16250
.set Cx294, 16262
.set Cx295, 16270
.set Cx296, 16278
.set Cx297, 16286
.set Cx298, 16294
.set Cx299, 16302
.set Cx300, 16309
.set Cx301, 16316
.set Cx302, 16323
.set Cx303, 16329
.set Cx304, 16335
.set Cx305, 16341
.set Cx306, 16346
.set Cx307, 16351
.set Cx308, 16356
.set Cx309, 16360
.set Cx310, 16365
.set Cx311, 16368
.set Cx312, 16371
.set Cx313, 16374
.set Cx314, 16377
.set Cx315, 16379
.set Cx316, 16381
.set Cx317, 16382
.set Cx318, 16383
.set Cx319, 16384
.set Cx320, 0

.altmacro
.macro E2 Z1, Z2
.long Cx\Z1 | (Cx\Z2 << 16)
.endm
.p2align 8
tbl_t160f:
.set q_kt, 0
.rept 3
.set q_ty, 0
.rept 2
.set q_ks, 0
.rept 10
.set q_l, 0
.rept 64
.set q_kap, 32*q_kt + (q_l % 32)
.set q_inv, (q_kap + 47) / 128
.set q_m, 16*q_ks + 8*(q_l / 32)
.rept 4
E2 %((1-q_inv)*((q_m*q_kap + 40*q_ty) % 160) + q_inv*320), %((1-q_inv)*(((q_m+1)*q_kap + 40*q_ty) % 160) + q_inv*320)
.set q_m, q_m + 2
.endr
.set q_l, q_l + 1
.endr
.set q_ks, q_ks + 1
.endr
.set q_ty, q_ty + 1
.endr
.set q_kt, q_kt + 1
.endr
.macro IDX ZK
.set q_im, (\ZK + 47) / 128
.set q_kap, \ZK - 80*q_im
.set q_w1, (1 - q_im) * ((1 - (q_kap + 127) / 128) + q_kap / 80)
.set q_ix, (1-q_inv)*(((q_m*q_kap + 40*q_im) % 160) + 160*(1-q_w1)) + q_inv*320
.endm
.p2align 8
tbl_t160i:
.set q_db, 0
.rept 8
.set q_dh, 0
.rept 2
.set q_ks, 0
.rept 5
.set q_l, 0
.rept 64
.set q_rp, q_l % 4
.set q_m, 20*q_db + 4*(3*q_dh + q_rp) + (q_l % 16) / 4
.set q_inv, (q_rp + 1 + q_dh) / 4
.set q_k, 32*q_ks + 8*(q_l / 16)
.rept 4
IDX q_k
.set q_i0, q_ix
IDX (q_k+1)
E2 %(q_i0), %(q_ix)
.set q_k, q_k + 2
.endr
.set q_l, q_l + 1
.endr
.set q_ks, q_ks + 1
.endr
.set q_dh, q_dh + 1
.endr
.set q_db, q_db + 1
.endr
.noaltmacro
tbl_end:
```
